```python
import torch

def _softmax(x, axis=-1):
    return torch.softmax(x, dim=axis)
def _gelu(x):
    return torch.nn.functional.gelu(x, approximate="tanh")
def _silu(x):
    return torch.nn.functional.silu(x)
def _sigmoid(x):
    return torch.sigmoid(x)
def _layernorm(x, axis=-1, eps=1e-5):
    m = x.mean(dim=axis, keepdim=True)
    v = x.var(dim=axis, keepdim=True, unbiased=False)
    return (x - m) / torch.sqrt(v + eps)
def _scatter_add(tgt, idx, src, axis=0):
    return tgt.clone().index_add_(axis, idx, src)
def _segment_sum(src, seg, n):
    out = torch.zeros((n,) + src.shape[1:], dtype=src.dtype)
    return out.index_add_(0, seg, src)
def _pad(x, pw):
    flat = tuple(v for pair in reversed(pw) for v in pair)
    return torch.nn.functional.pad(x, flat)

kernel_name = 'concat_heads__linear_kernel_hedgehog__sliding_block__prompt'

def setup_inputs():

    _w = (lambda a: (lambda t: t.to(torch.bfloat16) if t.is_floating_point() else t)(torch.as_tensor(a)))
    def _A_setup():
        B, S, D, H = 1, 2048, 640, 32
        Dh = D // H
        return {
            "x": _w((lambda *s: torch.randn(*s, dtype=torch.bfloat16) * 0.4)(B, S, D)),
            "wqkv": _w((lambda *s: torch.randn(*s, dtype=torch.bfloat16) * 1.6)(D, 3 * D)),
            "w_phi": _w((lambda *s: torch.randn(*s, dtype=torch.bfloat16) * 1.6)(H, Dh, Dh) * (Dh ** -0.5)),
            "wo": _w((lambda *s: torch.randn(*s, dtype=torch.bfloat16) * 0.2)(D, D)),
        }
    _A_in = _A_setup()

    def _B_setup():
        B, S, D = 1, 2048, 640
        return {
            "x": _w((lambda *s: torch.randn(*s, dtype=torch.bfloat16) * 0.2)(B, S, D)),
            "wqkv": _w((lambda *s: torch.randn(*s, dtype=torch.bfloat16) * 0.4)(D, 3 * D)),
            "wo": _w((lambda *s: torch.randn(*s, dtype=torch.bfloat16) * 0.2)(D, D)),
        }
    _B_in = _B_setup()

    return {
        "A_x": _A_in["x"],
        "A_wqkv": _A_in["wqkv"],
        "A_w_phi": _A_in["w_phi"],
        "A_wo": _A_in["wo"],
        "B_x": _B_in["x"],
        "B_wqkv": _B_in["wqkv"],
        "B_wo": _B_in["wo"],
    }

def reference(A_x, A_wqkv, A_w_phi, A_wo, B_x, B_wqkv, B_wo):
    def _A_ref(x, wqkv, w_phi, wo):
        B, S, D = x.shape
        H = 32; Dh = D // H
        qkv = (lambda x, *d: x.permute(*d))((x @ wqkv).reshape(B, S, 3, H, Dh), 2, 0, 3, 1, 4)
        q, k, v = qkv[0], qkv[1], qkv[2]
        pq = torch.einsum("bhsd,hdf->bhsf", q, w_phi)
        pk = torch.einsum("bhsd,hdf->bhsf", k, w_phi)
        phi_q = torch.concatenate([_softmax(pq, axis=-1), _softmax(-pq, axis=-1)], axis=-1)
        phi_k = torch.concatenate([_softmax(pk, axis=-1), _softmax(-pk, axis=-1)], axis=-1)
        kv = torch.einsum("bhsf,bhsd->bhfd", phi_k, v)
        z  = torch.einsum("bhsf->bhf", phi_k)
        num = torch.einsum("bhqf,bhfd->bhqd", phi_q, kv)
        den = torch.einsum("bhqf,bhf->bhq", phi_q, z)[..., None] + 1e-6
        o = num / den
        return (lambda x, *d: x.permute(*d))(o, 0, 2, 1, 3).reshape(B, S, D) @ wo

    def _B_ref(x, wqkv, wo):
        B, S, D = x.shape
        H = 32; Dh = D // H; W = 256
        qkv = (lambda x, *d: x.permute(*d))((x @ wqkv).reshape(B, S, 3, H, Dh), 2, 0, 3, 1, 4)
        q, k, v = qkv[0], qkv[1], qkv[2]
        scores = torch.einsum("bhqd,bhkd->bhqk", q, k) * (Dh ** -0.5)
        idx = torch.arange(S)
        mask = (idx[:, None] - idx[None, :] >= 0) & (idx[:, None] - idx[None, :] < W)
        scores = torch.where(mask[None, None], scores, -1e9)
        p = _softmax(scores, axis=-1)
        o = torch.einsum("bhqk,bhkd->bhqd", p, v)
        return (lambda x, *d: x.permute(*d))(o, 0, 2, 1, 3).reshape(B, S, D) @ wo

    a = _A_ref(A_x, A_wqkv, A_w_phi, A_wo)
    b = _B_ref(B_x, B_wqkv, B_wo)
    return torch.concatenate([a, b], axis=-1)
```

```asm
; @launch grid=(256,1,1) block=(512,1,1) lds=163840
.amdgcn_target "amdgcn-amd-amdhsa--gfx950"
.text
.globl concat_heads__linear_kernel_hedgehog__sliding_block__prompt_kernel
.p2align 8
.type concat_heads__linear_kernel_hedgehog__sliding_block__prompt_kernel,@function
concat_heads__linear_kernel_hedgehog__sliding_block__prompt_kernel:
    s_load_dwordx8 s[48:55], s[0:1], 0
    s_load_dwordx8 s[56:63], s[0:1], 32
    s_load_dwordx4 s[64:67], s[0:1], 64
    v_lshrrev_b32 v1, 6, v0
    s_cmp_ge_u32 s2, 256
    s_nop 0
    s_cbranch_scc1 L_end
    v_readfirstlane_b32 s31, v1
    v_and_b32 v0, 63, v0
    s_and_b32 s28, s2, 1
    s_bfe_u32 s30, s2, 0x30003
    s_lshr_b32 s29, s2, 6
    s_bfe_u32 s38, s2, 0x20001
    s_lshl_b32 s38, s38, 2
    s_add_u32 s29, s29, s38
    s_and_b32 s37, s31, 3
    s_cmp_lt_u32 s31, 4
    s_cbranch_scc1 L_compute
    v_lshrrev_b32 v16, 3, v0
    v_and_b32 v17, 7, v0
    v_lshrrev_b32 v18, 4, v0
    v_xor_b32 v17, v17, v18
    s_lshl_b32 s40, s29, 2
    s_add_u32 s40, s40, s37
    s_mul_i32 s40, s40, 40960
    v_mul_u32_u24 v16, 1280, v16
    v_add_u32 v16, s40, v16
    v_lshl_add_u32 v1, v17, 4, v16
    v_xor_b32 v2, 64, v1
    s_lshl_b32 s69, s37, 12
    s_mul_i32 s40, s29, 3
    s_mul_i32 s41, s30, 1
    s_add_u32 s40, s40, s41
    s_mul_i32 s41, s40, 6554
    s_lshr_b32 s41, s41, 16
    s_mul_i32 s41, s41, 10
    s_sub_u32 s72, s40, s41
    s_lshl_b32 s73, s72, 7
    s_mov_b32 s6, 2621440
    s_mov_b32 s7, 0x00020000
    s_mov_b32 s10, 2457600
    s_mov_b32 s11, 0x00020000
    s_mul_i32 s42, s30, 160
    v_add_u32 v16, 0, v0
    v_mul_u32_u24 v17, 6554, v16
    v_lshrrev_b32 v17, 16, v17
    v_mul_u32_u24 v18, 10, v17
    v_sub_u32 v19, v16, v18
    v_bfe_u32 v18, v17, 2, 2
    v_and_b32 v16, 3, v17
    v_lshl_add_u32 v18, v18, 3, v16
    v_lshrrev_b32 v16, 4, v17
    v_lshl_add_u32 v18, v16, 2, v18
    v_mul_u32_u24 v18, 3840, v18
    v_lshl_add_u32 v18, v19, 4, v18
    v_add_u32 v240, s42, v18
    v_add_u32 v16, 64, v0
    v_mul_u32_u24 v17, 6554, v16
    v_lshrrev_b32 v17, 16, v17
    v_mul_u32_u24 v18, 10, v17
    v_sub_u32 v19, v16, v18
    v_bfe_u32 v18, v17, 2, 2
    v_and_b32 v16, 3, v17
    v_lshl_add_u32 v18, v18, 3, v16
    v_lshrrev_b32 v16, 4, v17
    v_lshl_add_u32 v18, v16, 2, v18
    v_mul_u32_u24 v18, 3840, v18
    v_lshl_add_u32 v18, v19, 4, v18
    v_add_u32 v241, s42, v18
    s_cmp_eq_u32 s28, 0
    s_waitcnt lgkmcnt(0)
    s_cselect_b32 s4, s48, s56
    s_cselect_b32 s5, s49, s57
    s_cselect_b32 s8, s50, s58
    s_cselect_b32 s9, s51, s59
    s_add_u32 m0, s69, 57344
    s_add_u32 s40, s73, 0
    buffer_load_dwordx4 v1, s[4:7], s40 offen lds
    s_add_u32 m0, s69, 58368
    s_add_u32 s40, s73, 10240
    buffer_load_dwordx4 v2, s[4:7], s40 offen lds
    s_add_u32 m0, s69, 59392
    s_add_u32 s40, s73, 20480
    buffer_load_dwordx4 v1, s[4:7], s40 offen lds
    s_add_u32 m0, s69, 60416
    s_add_u32 s40, s73, 30720
    buffer_load_dwordx4 v2, s[4:7], s40 offen lds
    s_add_u32 s73, s73, 128
    s_cmp_eq_u32 s73, 1280
    s_cselect_b32 s73, 0, s73
    v_add_u32 v16, 128, v0
    v_mul_u32_u24 v17, 6554, v16
    v_lshrrev_b32 v17, 16, v17
    v_mul_u32_u24 v18, 10, v17
    v_sub_u32 v19, v16, v18
    v_bfe_u32 v18, v17, 2, 2
    v_and_b32 v16, 3, v17
    v_lshl_add_u32 v18, v18, 3, v16
    v_lshrrev_b32 v16, 4, v17
    v_lshl_add_u32 v18, v16, 2, v18
    v_mul_u32_u24 v18, 3840, v18
    v_lshl_add_u32 v18, v19, 4, v18
    v_add_u32 v242, s42, v18
    v_add_u32 v16, 192, v0
    v_mul_u32_u24 v17, 6554, v16
    v_lshrrev_b32 v17, 16, v17
    v_mul_u32_u24 v18, 10, v17
    v_sub_u32 v19, v16, v18
    v_bfe_u32 v18, v17, 2, 2
    v_and_b32 v16, 3, v17
    v_lshl_add_u32 v18, v18, 3, v16
    v_lshrrev_b32 v16, 4, v17
    v_lshl_add_u32 v18, v16, 2, v18
    v_mul_u32_u24 v18, 3840, v18
    v_lshl_add_u32 v18, v19, 4, v18
    v_add_u32 v243, s42, v18
    v_add_u32 v16, 256, v0
    v_mul_u32_u24 v17, 6554, v16
    v_lshrrev_b32 v17, 16, v17
    v_mul_u32_u24 v18, 10, v17
    v_sub_u32 v19, v16, v18
    v_bfe_u32 v18, v17, 2, 2
    v_and_b32 v16, 3, v17
    v_lshl_add_u32 v18, v18, 3, v16
    v_lshrrev_b32 v16, 4, v17
    v_lshl_add_u32 v18, v16, 2, v18
    v_mul_u32_u24 v18, 3840, v18
    v_lshl_add_u32 v18, v19, 4, v18
    v_add_u32 v244, s42, v18
    s_lshl_b32 s70, s37, 3
    s_or_b32 s70, s70, 0x80000
    s_lshl_b32 s40, s72, 1
    s_lshr_b32 s41, s37, 1
    s_add_u32 s71, s40, s41
    s_mul_i32 s71, s71, 122880
    s_and_b32 s41, s37, 1
    s_mul_i32 s41, s41, 1280
    s_add_u32 s71, s71, s41
    s_xor_b32 s41, s37, 2
    s_add_u32 s75, s40, s41
    s_mul_i32 s75, s75, 122880
    s_add_u32 s75, s75, 0
    s_cmp_ge_u32 s75, 2457600
    s_cselect_b32 s40, 2457600, 0
    s_sub_u32 s75, s75, s40
    s_add_u32 s71, s71, 2336000
    s_cmp_ge_u32 s71, 2457600
    s_cselect_b32 s40, 2457600, 0
    s_sub_u32 s71, s71, s40
    s_cmp_lt_u32 s37, 2
    s_cbranch_scc1 L_now0
    s_bfe_u32 s41, 0x67620500, s70
    s_lshl_b32 s41, s41, 10
    s_add_u32 m0, s41, 0
    s_nop 0
    buffer_load_dwordx4 v240, s[8:11], s71 offen lds
    s_add_u32 m0, s41, 1024
    s_nop 0
    buffer_load_dwordx4 v241, s[8:11], s71 offen lds
    s_add_u32 m0, s41, 2048
    s_nop 0
    buffer_load_dwordx4 v242, s[8:11], s71 offen lds
    s_add_u32 m0, s41, 3072
    s_nop 0
    buffer_load_dwordx4 v243, s[8:11], s71 offen lds
    s_add_u32 m0, s41, 4096
    s_nop 0
    buffer_load_dwordx4 v244, s[8:11], s71 offen lds
L_now0:
    s_add_u32 s71, s71, 245760
    s_cmp_ge_u32 s71, 2457600
    s_cselect_b32 s40, 2457600, 0
    s_sub_u32 s71, s71, s40
    s_add_u32 m0, s69, 40960
    s_add_u32 s40, s73, 0
    buffer_load_dwordx4 v1, s[4:7], s40 offen lds
    s_add_u32 m0, s69, 41984
    s_add_u32 s40, s73, 10240
    buffer_load_dwordx4 v2, s[4:7], s40 offen lds
    s_add_u32 m0, s69, 43008
    s_add_u32 s40, s73, 20480
    buffer_load_dwordx4 v1, s[4:7], s40 offen lds
    s_add_u32 m0, s69, 44032
    s_add_u32 s40, s73, 30720
    buffer_load_dwordx4 v2, s[4:7], s40 offen lds
    s_add_u32 s73, s73, 128
    s_cmp_eq_u32 s73, 1280
    s_cselect_b32 s73, 0, s73
    s_bfe_u32 s41, 0x5005d58, s70
    s_lshl_b32 s41, s41, 10
    s_add_u32 m0, s41, 0
    s_nop 0
    buffer_load_dwordx4 v240, s[8:11], s71 offen lds
    s_add_u32 m0, s41, 1024
    s_nop 0
    buffer_load_dwordx4 v241, s[8:11], s71 offen lds
    s_add_u32 m0, s41, 2048
    s_nop 0
    buffer_load_dwordx4 v242, s[8:11], s71 offen lds
    s_add_u32 m0, s41, 3072
    s_nop 0
    buffer_load_dwordx4 v243, s[8:11], s71 offen lds
    s_add_u32 m0, s41, 4096
    s_nop 0
    buffer_load_dwordx4 v244, s[8:11], s71 offen lds
    v_mov_b32 v4, 161792
    s_mul_i32 s74, s37, 5120
    s_lshl_b32 s39, s28, 4
    s_add_u32 s39, s39, s29
    s_lshl_b32 s35, s39, 3
    s_add_u32 s35, s35, s30
    s_mov_b32 s80, 0
    s_mov_b32 s81, -1
    s_cmp_eq_u32 s28, 0
    s_cselect_b32 s38, 0x358637bd, 0
    s_mov_b32 s12, s66
    s_mov_b32 s13, s67
    s_mov_b32 s14, 0x10000000
    s_mov_b32 s15, 0x00020000
    s_cselect_b32 s16, s54, s60
    s_cselect_b32 s17, s55, s61
    s_mov_b32 s18, 819200
    s_mov_b32 s19, 0x00020000
    s_mov_b32 s20, s62
    s_mov_b32 s21, s63
    s_mov_b32 s22, 5242880
    s_mov_b32 s23, 0x00020000
    s_mov_b32 s24, s64
    s_mov_b32 s25, s65
    s_mov_b32 s26, 256
    s_mov_b32 s27, 0x00020000
    s_barrier
    s_waitcnt vmcnt(9)
    s_mov_b64 exec, 1
    ds_add_u32 v4, v4 offset:80
    s_mov_b64 exec, -1
    s_add_u32 s71, s71, 245760
    s_cmp_ge_u32 s71, 2457600
    s_cselect_b32 s40, 2457600, 0
    s_sub_u32 s71, s71, s40
    s_add_u32 m0, s69, 73728
    s_add_u32 s40, s73, 0
    buffer_load_dwordx4 v1, s[4:7], s40 offen lds
    s_add_u32 m0, s69, 74752
    s_add_u32 s40, s73, 10240
    buffer_load_dwordx4 v2, s[4:7], s40 offen lds
    s_add_u32 m0, s69, 75776
    s_add_u32 s40, s73, 20480
    buffer_load_dwordx4 v1, s[4:7], s40 offen lds
    s_add_u32 m0, s69, 76800
    s_add_u32 s40, s73, 30720
    buffer_load_dwordx4 v2, s[4:7], s40 offen lds
    s_add_u32 s73, s73, 128
    s_cmp_eq_u32 s73, 1280
    s_cselect_b32 s73, 0, s73
    s_bfe_u32 s41, 0x19140f0a, s70
    s_lshl_b32 s41, s41, 10
    s_add_u32 m0, s41, 0
    s_nop 0
    buffer_load_dwordx4 v240, s[8:11], s71 offen lds
    s_add_u32 m0, s41, 1024
    s_nop 0
    buffer_load_dwordx4 v241, s[8:11], s71 offen lds
    s_add_u32 m0, s41, 2048
    s_nop 0
    buffer_load_dwordx4 v242, s[8:11], s71 offen lds
    s_add_u32 m0, s41, 3072
    s_nop 0
    buffer_load_dwordx4 v243, s[8:11], s71 offen lds
    s_add_u32 m0, s41, 4096
    s_nop 0
    buffer_load_dwordx4 v244, s[8:11], s71 offen lds
    ds_read_b32 v5, v4 offset:208
    s_waitcnt vmcnt(9)
    s_mov_b64 exec, 1
    ds_add_u32 v4, v4 offset:84
    s_mov_b64 exec, -1
    s_waitcnt lgkmcnt(1)
    v_cmp_ne_u32 vcc, 0x9e000, v5
    s_cbranch_vccnz L_cs_1
L_cb_2:
    s_add_u32 s71, s71, 245760
    s_cmp_ge_u32 s71, 2457600
    s_cselect_b32 s40, 2457600, 0
    s_sub_u32 s71, s71, s40
    s_add_u32 m0, s69, 57344
    s_add_u32 s40, s73, 0
    buffer_load_dwordx4 v1, s[4:7], s40 offen lds
    s_add_u32 m0, s69, 58368
    s_add_u32 s40, s73, 10240
    buffer_load_dwordx4 v2, s[4:7], s40 offen lds
    s_add_u32 m0, s69, 59392
    s_add_u32 s40, s73, 20480
    buffer_load_dwordx4 v1, s[4:7], s40 offen lds
    s_add_u32 m0, s69, 60416
    s_add_u32 s40, s73, 30720
    buffer_load_dwordx4 v2, s[4:7], s40 offen lds
    s_add_u32 s73, s73, 128
    s_cmp_eq_u32 s73, 1280
    s_cselect_b32 s73, 0, s73
    s_bfe_u32 s41, 0x6762231e, s70
    s_lshl_b32 s41, s41, 10
    s_add_u32 m0, s41, 0
    s_nop 0
    buffer_load_dwordx4 v240, s[8:11], s71 offen lds
    s_add_u32 m0, s41, 1024
    s_nop 0
    buffer_load_dwordx4 v241, s[8:11], s71 offen lds
    s_add_u32 m0, s41, 2048
    s_nop 0
    buffer_load_dwordx4 v242, s[8:11], s71 offen lds
    s_add_u32 m0, s41, 3072
    s_nop 0
    buffer_load_dwordx4 v243, s[8:11], s71 offen lds
    s_add_u32 m0, s41, 4096
    s_nop 0
    buffer_load_dwordx4 v244, s[8:11], s71 offen lds
    ds_read_b32 v5, v4 offset:212
    s_waitcnt vmcnt(9)
    s_mov_b64 exec, 1
    ds_add_u32 v4, v4 offset:88
    s_mov_b64 exec, -1
    s_waitcnt lgkmcnt(1)
    v_cmp_ne_u32 vcc, 0x9e000, v5
    s_cbranch_vccnz L_cs_3
L_cb_4:
    s_add_u32 s71, s71, 245760
    s_cmp_ge_u32 s71, 2457600
    s_cselect_b32 s40, 2457600, 0
    s_sub_u32 s71, s71, s40
    s_add_u32 m0, s69, 40960
    s_add_u32 s40, s73, 0
    buffer_load_dwordx4 v1, s[4:7], s40 offen lds
    s_add_u32 m0, s69, 41984
    s_add_u32 s40, s73, 10240
    buffer_load_dwordx4 v2, s[4:7], s40 offen lds
    s_add_u32 m0, s69, 43008
    s_add_u32 s40, s73, 20480
    buffer_load_dwordx4 v1, s[4:7], s40 offen lds
    s_add_u32 m0, s69, 44032
    s_add_u32 s40, s73, 30720
    buffer_load_dwordx4 v2, s[4:7], s40 offen lds
    s_add_u32 s73, s73, 128
    s_cmp_eq_u32 s73, 1280
    s_cselect_b32 s73, 0, s73
    s_bfe_u32 s41, 0x5005d58, s70
    s_lshl_b32 s41, s41, 10
    s_add_u32 m0, s41, 0
    s_nop 0
    buffer_load_dwordx4 v240, s[8:11], s71 offen lds
    s_add_u32 m0, s41, 1024
    s_nop 0
    buffer_load_dwordx4 v241, s[8:11], s71 offen lds
    s_add_u32 m0, s41, 2048
    s_nop 0
    buffer_load_dwordx4 v242, s[8:11], s71 offen lds
    s_add_u32 m0, s41, 3072
    s_nop 0
    buffer_load_dwordx4 v243, s[8:11], s71 offen lds
    s_add_u32 m0, s41, 4096
    s_nop 0
    buffer_load_dwordx4 v244, s[8:11], s71 offen lds
    buffer_load_dwordx2 v[246:247], off, s[24:27], 0 sc1
    ds_read_b32 v5, v4 offset:216
    s_waitcnt vmcnt(10)
    s_mov_b64 exec, 1
    ds_add_u32 v4, v4 offset:92
    s_mov_b64 exec, -1
    s_waitcnt lgkmcnt(1)
    v_cmp_ne_u32 vcc, 0x9e000, v5
    s_cbranch_vccnz L_cs_5
L_cb_6:
    s_add_u32 s71, s71, 245760
    s_cmp_ge_u32 s71, 2457600
    s_cselect_b32 s40, 2457600, 0
    s_sub_u32 s71, s71, s40
    s_add_u32 m0, s69, 73728
    s_add_u32 s40, s73, 0
    buffer_load_dwordx4 v1, s[4:7], s40 offen lds
    s_add_u32 m0, s69, 74752
    s_add_u32 s40, s73, 10240
    buffer_load_dwordx4 v2, s[4:7], s40 offen lds
    s_add_u32 m0, s69, 75776
    s_add_u32 s40, s73, 20480
    buffer_load_dwordx4 v1, s[4:7], s40 offen lds
    s_add_u32 m0, s69, 76800
    s_add_u32 s40, s73, 30720
    buffer_load_dwordx4 v2, s[4:7], s40 offen lds
    s_add_u32 s73, s73, 128
    s_cmp_eq_u32 s73, 1280
    s_cselect_b32 s73, 0, s73
    s_bfe_u32 s41, 0x19140f0a, s70
    s_lshl_b32 s41, s41, 10
    s_add_u32 m0, s41, 0
    s_nop 0
    buffer_load_dwordx4 v240, s[8:11], s71 offen lds
    s_add_u32 m0, s41, 1024
    s_nop 0
    buffer_load_dwordx4 v241, s[8:11], s71 offen lds
    s_add_u32 m0, s41, 2048
    s_nop 0
    buffer_load_dwordx4 v242, s[8:11], s71 offen lds
    s_add_u32 m0, s41, 3072
    s_nop 0
    buffer_load_dwordx4 v243, s[8:11], s71 offen lds
    s_add_u32 m0, s41, 4096
    s_nop 0
    buffer_load_dwordx4 v244, s[8:11], s71 offen lds
    s_mul_i32 s41, s30, 160
    s_mov_b32 s3, 20480
    v_add_u32 v16, 0, v0
    v_mul_u32_u24 v17, 6554, v16
    v_lshrrev_b32 v17, 16, v17
    v_mul_u32_u24 v18, 10, v17
    v_sub_u32 v19, v16, v18
    v_bfe_u32 v18, v17, 2, 2
    v_and_b32 v16, 3, v17
    v_lshl_add_u32 v18, v18, 3, v16
    v_lshrrev_b32 v16, 4, v17
    v_lshl_add_u32 v18, v16, 2, v18
    v_lshl_add_u32 v19, v19, 4, s41
    v_lshrrev_b32 v16, 4, v18
    v_lshl_add_u32 v16, v16, 2, v18
    v_mul_u32_u24 v16, 1280, v16
    v_add_u32 v6, v16, v19
    v_lshrrev_b32 v16, 2, v18
    v_lshl_add_u32 v16, v16, 4, v18
    v_mul_u32_u24 v16, 1280, v16
    v_add3_u32 v11, v16, v19, s3
    v_add_u32 v16, 64, v0
    v_mul_u32_u24 v17, 6554, v16
    v_lshrrev_b32 v17, 16, v17
    v_mul_u32_u24 v18, 10, v17
    v_sub_u32 v19, v16, v18
    v_bfe_u32 v18, v17, 2, 2
    v_and_b32 v16, 3, v17
    v_lshl_add_u32 v18, v18, 3, v16
    v_lshrrev_b32 v16, 4, v17
    v_lshl_add_u32 v18, v16, 2, v18
    v_lshl_add_u32 v19, v19, 4, s41
    v_lshrrev_b32 v16, 4, v18
    v_lshl_add_u32 v16, v16, 2, v18
    v_mul_u32_u24 v16, 1280, v16
    v_add_u32 v7, v16, v19
    v_lshrrev_b32 v16, 2, v18
    v_lshl_add_u32 v16, v16, 4, v18
    v_mul_u32_u24 v16, 1280, v16
    v_add3_u32 v12, v16, v19, s3
    v_add_u32 v16, 128, v0
    v_mul_u32_u24 v17, 6554, v16
    v_lshrrev_b32 v17, 16, v17
    v_mul_u32_u24 v18, 10, v17
    v_sub_u32 v19, v16, v18
    v_bfe_u32 v18, v17, 2, 2
    v_and_b32 v16, 3, v17
    v_lshl_add_u32 v18, v18, 3, v16
    v_lshrrev_b32 v16, 4, v17
    v_lshl_add_u32 v18, v16, 2, v18
    v_lshl_add_u32 v19, v19, 4, s41
    v_lshrrev_b32 v16, 4, v18
    v_lshl_add_u32 v16, v16, 2, v18
    v_mul_u32_u24 v16, 1280, v16
    v_add_u32 v8, v16, v19
    v_lshrrev_b32 v16, 2, v18
    v_lshl_add_u32 v16, v16, 4, v18
    v_mul_u32_u24 v16, 1280, v16
    v_add3_u32 v13, v16, v19, s3
    v_add_u32 v16, 192, v0
    v_mul_u32_u24 v17, 6554, v16
    v_lshrrev_b32 v17, 16, v17
    v_mul_u32_u24 v18, 10, v17
    v_sub_u32 v19, v16, v18
    v_bfe_u32 v18, v17, 2, 2
    v_and_b32 v16, 3, v17
    v_lshl_add_u32 v18, v18, 3, v16
    v_lshrrev_b32 v16, 4, v17
    v_lshl_add_u32 v18, v16, 2, v18
    v_lshl_add_u32 v19, v19, 4, s41
    v_lshrrev_b32 v16, 4, v18
    v_lshl_add_u32 v16, v16, 2, v18
    v_mul_u32_u24 v16, 1280, v16
    v_add_u32 v9, v16, v19
    v_lshrrev_b32 v16, 2, v18
    v_lshl_add_u32 v16, v16, 4, v18
    v_mul_u32_u24 v16, 1280, v16
    v_add3_u32 v14, v16, v19, s3
    v_add_u32 v16, 256, v0
    v_mul_u32_u24 v17, 6554, v16
    v_lshrrev_b32 v17, 16, v17
    v_mul_u32_u24 v18, 10, v17
    v_sub_u32 v19, v16, v18
    v_bfe_u32 v18, v17, 2, 2
    v_and_b32 v16, 3, v17
    v_lshl_add_u32 v18, v18, 3, v16
    v_lshrrev_b32 v16, 4, v17
    v_lshl_add_u32 v18, v16, 2, v18
    v_lshl_add_u32 v19, v19, 4, s41
    v_lshrrev_b32 v16, 4, v18
    v_lshl_add_u32 v16, v16, 2, v18
    v_mul_u32_u24 v16, 1280, v16
    v_add_u32 v10, v16, v19
    v_lshrrev_b32 v16, 2, v18
    v_lshl_add_u32 v16, v16, 4, v18
    v_mul_u32_u24 v16, 1280, v16
    v_add3_u32 v15, v16, v19, s3
    ds_read_b32 v5, v4 offset:220
    s_waitcnt vmcnt(10)
    s_mov_b64 exec, 1
    ds_add_u32 v4, v4 offset:96
    s_mov_b64 exec, -1
    s_waitcnt lgkmcnt(1)
    v_cmp_ne_u32 vcc, 0x9e000, v5
    s_cbranch_vccnz L_cs_7
L_cb_8:
    s_add_u32 s71, s71, 245760
    s_cmp_ge_u32 s71, 2457600
    s_cselect_b32 s40, 2457600, 0
    s_sub_u32 s71, s71, s40
    s_add_u32 m0, s69, 57344
    s_add_u32 s40, s73, 0
    buffer_load_dwordx4 v1, s[4:7], s40 offen lds
    s_add_u32 m0, s69, 58368
    s_add_u32 s40, s73, 10240
    buffer_load_dwordx4 v2, s[4:7], s40 offen lds
    s_add_u32 m0, s69, 59392
    s_add_u32 s40, s73, 20480
    buffer_load_dwordx4 v1, s[4:7], s40 offen lds
    s_add_u32 m0, s69, 60416
    s_add_u32 s40, s73, 30720
    buffer_load_dwordx4 v2, s[4:7], s40 offen lds
    s_add_u32 s73, s73, 128
    s_cmp_eq_u32 s73, 1280
    s_cselect_b32 s73, 0, s73
    s_bfe_u32 s41, 0x6762231e, s70
    s_lshl_b32 s41, s41, 10
    s_add_u32 m0, s41, 0
    s_nop 0
    buffer_load_dwordx4 v240, s[8:11], s71 offen lds
    s_add_u32 m0, s41, 1024
    s_nop 0
    buffer_load_dwordx4 v241, s[8:11], s71 offen lds
    s_add_u32 m0, s41, 2048
    s_nop 0
    buffer_load_dwordx4 v242, s[8:11], s71 offen lds
    s_add_u32 m0, s41, 3072
    s_nop 0
    buffer_load_dwordx4 v243, s[8:11], s71 offen lds
    s_add_u32 m0, s41, 4096
    s_nop 0
    buffer_load_dwordx4 v244, s[8:11], s71 offen lds
    ds_read_b32 v5, v4 offset:224
    s_waitcnt vmcnt(9)
    s_mov_b64 exec, 1
    ds_add_u32 v4, v4 offset:100
    s_mov_b64 exec, -1
    s_waitcnt lgkmcnt(1)
    v_cmp_ne_u32 vcc, 0x9e000, v5
    s_cbranch_vccnz L_cs_9
L_cb_10:
    s_add_u32 s71, s71, 245760
    s_cmp_ge_u32 s71, 2457600
    s_cselect_b32 s40, 2457600, 0
    s_sub_u32 s71, s71, s40
    s_add_u32 m0, s69, 40960
    s_add_u32 s40, s73, 0
    buffer_load_dwordx4 v1, s[4:7], s40 offen lds
    s_add_u32 m0, s69, 41984
    s_add_u32 s40, s73, 10240
    buffer_load_dwordx4 v2, s[4:7], s40 offen lds
    s_add_u32 m0, s69, 43008
    s_add_u32 s40, s73, 20480
    buffer_load_dwordx4 v1, s[4:7], s40 offen lds
    s_add_u32 m0, s69, 44032
    s_add_u32 s40, s73, 30720
    buffer_load_dwordx4 v2, s[4:7], s40 offen lds
    s_add_u32 s73, s73, 128
    s_cmp_eq_u32 s73, 1280
    s_cselect_b32 s73, 0, s73
    s_bfe_u32 s41, 0x5005d58, s70
    s_lshl_b32 s41, s41, 10
    s_add_u32 m0, s41, 0
    s_nop 0
    buffer_load_dwordx4 v240, s[8:11], s71 offen lds
    s_add_u32 m0, s41, 1024
    s_nop 0
    buffer_load_dwordx4 v241, s[8:11], s71 offen lds
    s_add_u32 m0, s41, 2048
    s_nop 0
    buffer_load_dwordx4 v242, s[8:11], s71 offen lds
    s_add_u32 m0, s41, 3072
    s_nop 0
    buffer_load_dwordx4 v243, s[8:11], s71 offen lds
    s_add_u32 m0, s41, 4096
    s_nop 0
    buffer_load_dwordx4 v244, s[8:11], s71 offen lds
    v_cmp_ne_u64 vcc, 0, v[246:247]
    s_cbranch_vccz L_nc_poll
L_nc_ok:
    v_readfirstlane_b32 s32, v246
    v_readfirstlane_b32 s33, v247
    ds_write_b64 v4, v[246:247] offset:312
    ds_read_b32 v5, v4 offset:228
    s_waitcnt vmcnt(9)
    s_mov_b64 exec, 1
    ds_add_u32 v4, v4 offset:104
    s_mov_b64 exec, -1
    s_waitcnt lgkmcnt(1)
    v_cmp_ne_u32 vcc, 0x9e000, v5
    s_cbranch_vccnz L_cs_11
L_cb_12:
    s_add_u32 s71, s71, 245760
    s_cmp_ge_u32 s71, 2457600
    s_cselect_b32 s40, 2457600, 0
    s_sub_u32 s71, s71, s40
    s_add_u32 m0, s69, 73728
    s_add_u32 s40, s73, 0
    buffer_load_dwordx4 v1, s[4:7], s40 offen lds
    s_add_u32 m0, s69, 74752
    s_add_u32 s40, s73, 10240
    buffer_load_dwordx4 v2, s[4:7], s40 offen lds
    s_add_u32 m0, s69, 75776
    s_add_u32 s40, s73, 20480
    buffer_load_dwordx4 v1, s[4:7], s40 offen lds
    s_add_u32 m0, s69, 76800
    s_add_u32 s40, s73, 30720
    buffer_load_dwordx4 v2, s[4:7], s40 offen lds
    s_add_u32 s73, s73, 128
    s_cmp_eq_u32 s73, 1280
    s_cselect_b32 s73, 0, s73
    s_bfe_u32 s41, 0x19140f0a, s70
    s_lshl_b32 s41, s41, 10
    s_add_u32 m0, s41, 0
    s_nop 0
    buffer_load_dwordx4 v240, s[8:11], s71 offen lds
    s_add_u32 m0, s41, 1024
    s_nop 0
    buffer_load_dwordx4 v241, s[8:11], s71 offen lds
    s_add_u32 m0, s41, 2048
    s_nop 0
    buffer_load_dwordx4 v242, s[8:11], s71 offen lds
    s_add_u32 m0, s41, 3072
    s_nop 0
    buffer_load_dwordx4 v243, s[8:11], s71 offen lds
    s_add_u32 m0, s41, 4096
    s_nop 0
    buffer_load_dwordx4 v244, s[8:11], s71 offen lds
    ds_read_b32 v5, v4 offset:232
    s_waitcnt vmcnt(9)
    s_mov_b64 exec, 1
    ds_add_u32 v4, v4 offset:108
    s_mov_b64 exec, -1
    s_waitcnt lgkmcnt(1)
    v_cmp_ne_u32 vcc, 0x9e000, v5
    s_cbranch_vccnz L_cs_13
L_cb_14:
    s_add_u32 s71, s71, 245760
    s_cmp_ge_u32 s71, 2457600
    s_cselect_b32 s40, 2457600, 0
    s_sub_u32 s71, s71, s40
    s_add_u32 m0, s69, 57344
    s_add_u32 s40, s73, 0
    buffer_load_dwordx4 v1, s[4:7], s40 offen lds
    s_add_u32 m0, s69, 58368
    s_add_u32 s40, s73, 10240
    buffer_load_dwordx4 v2, s[4:7], s40 offen lds
    s_add_u32 m0, s69, 59392
    s_add_u32 s40, s73, 20480
    buffer_load_dwordx4 v1, s[4:7], s40 offen lds
    s_add_u32 m0, s69, 60416
    s_add_u32 s40, s73, 30720
    buffer_load_dwordx4 v2, s[4:7], s40 offen lds
    s_bfe_u32 s41, 0x6762231e, s70
    s_lshl_b32 s41, s41, 10
    s_add_u32 m0, s41, 0
    s_nop 0
    buffer_load_dwordx4 v240, s[8:11], s71 offen lds
    s_add_u32 m0, s41, 1024
    s_nop 0
    buffer_load_dwordx4 v241, s[8:11], s71 offen lds
    s_add_u32 m0, s41, 2048
    s_nop 0
    buffer_load_dwordx4 v242, s[8:11], s71 offen lds
    s_add_u32 m0, s41, 3072
    s_nop 0
    buffer_load_dwordx4 v243, s[8:11], s71 offen lds
    s_add_u32 m0, s41, 4096
    s_nop 0
    buffer_load_dwordx4 v244, s[8:11], s71 offen lds
    s_cmp_lg_u32 s28, 0
    s_cbranch_scc1 L_helperB
    s_mul_i32 s48, s37, 11584
    s_add_u32 s48, s48, 110592
    v_lshrrev_b32 v234, 2, v0
    v_mul_u32_u24 v235, 80, v234
    v_and_b32 v236, 3, v0
    v_lshl_add_u32 v235, v236, 3, v235
    v_add_u32 v213, s48, v235
    v_add_u32 v214, s74, v235
    v_add_u32 v214, 79872, v214
    ds_read_b32 v5, v4 offset:236
    s_waitcnt vmcnt(9)
    s_mov_b64 exec, 1
    ds_add_u32 v4, v4 offset:112
    s_mov_b64 exec, -1
    s_waitcnt lgkmcnt(1)
    v_cmp_ne_u32 vcc, 0x9e000, v5
    s_cbranch_vccnz L_cs_15
L_cb_16:
    s_add_u32 s71, s71, 245760
    s_cmp_ge_u32 s71, 2457600
    s_cselect_b32 s40, 2457600, 0
    s_sub_u32 s71, s71, s40
    s_cmp_lt_u32 s37, 2
    s_cselect_b32 s71, s71, s75
    s_bfe_u32 s41, 0x5005d58, s70
    s_lshl_b32 s41, s41, 10
    s_add_u32 m0, s41, 0
    s_nop 0
    buffer_load_dwordx4 v240, s[8:11], s71 offen lds
    s_add_u32 m0, s41, 1024
    s_nop 0
    buffer_load_dwordx4 v241, s[8:11], s71 offen lds
    s_add_u32 m0, s41, 2048
    s_nop 0
    buffer_load_dwordx4 v242, s[8:11], s71 offen lds
    s_add_u32 m0, s41, 3072
    s_nop 0
    buffer_load_dwordx4 v243, s[8:11], s71 offen lds
    s_add_u32 m0, s41, 4096
    s_nop 0
    buffer_load_dwordx4 v244, s[8:11], s71 offen lds
    s_cmp_ge_u32 s37, 2
    s_cbranch_scc1 L_nob_17
    s_bfe_u32 s41, 0x5002d28, s70
    s_lshl_b32 s41, s41, 10
    s_add_u32 m0, s41, 0
    s_nop 0
    buffer_load_dwordx4 v240, s[8:11], s75 offen lds
    s_add_u32 m0, s41, 1024
    s_nop 0
    buffer_load_dwordx4 v241, s[8:11], s75 offen lds
    s_add_u32 m0, s41, 2048
    s_nop 0
    buffer_load_dwordx4 v242, s[8:11], s75 offen lds
    s_add_u32 m0, s41, 3072
    s_nop 0
    buffer_load_dwordx4 v243, s[8:11], s75 offen lds
    s_add_u32 m0, s41, 4096
    s_nop 0
    buffer_load_dwordx4 v244, s[8:11], s75 offen lds
L_nob_17:
    v_lshl_add_u32 v234, v234, 4, s48
    v_and_b32 v235, 1, v0
    v_lshl_add_u32 v215, v235, 3, v234
    v_bfe_u32 v235, v0, 1, 1
    v_mul_u32_u24 v235, 2176, v235
    v_add_u32 v215, v215, v235
    v_add_u32 v234, 4424, v234
    v_cmp_eq_u32 vcc, 0, v236
    s_nop 1
    v_cndmask_b32 v216, v4, v234, vcc
    v_and_b32 v234, 15, v0
    v_lshrrev_b32 v235, 4, v0
    v_mul_u32_u24 v236, 80, v234
    v_lshl_add_u32 v217, v235, 3, v236
    v_lshlrev_b32 v231, 10, v234
    v_mov_b32 v236, 0x80000000
    v_cmp_gt_u32 vcc, 5, v234
    s_nop 1
    v_cndmask_b32 v218, v236, v217, vcc
    v_cmp_gt_u32 vcc, 2, v235
    s_nop 1
    v_cndmask_b32 v219, v236, v217, vcc
    v_cndmask_b32 v220, v236, v218, vcc
    s_mul_i32 s41, s37, 1792
    s_add_u32 s41, s41, 0x560000
    s_mul_i32 s49, s35, 7168
    s_add_u32 s49, s49, s41
    s_mul_i32 s50, s30, 7168
    s_add_u32 s50, s50, s41
    s_lshl_b32 s51, s30, 7
    s_lshl_b32 s41, s37, 3
    s_add_u32 s51, s51, s41
    s_add_u32 s51, s51, 0xb40000
    s_lshl2_add_u32 s52, s30, s37
    s_lshl_b32 s52, s52, 11
    s_add_u32 s52, s52, 0xb50000
    s_lshl_b32 s41, s29, 7
    s_add_u32 s53, s52, s41
    s_add_u32 s50, s50, s41
    s_cmp_lt_u32 s29, 13
    s_cselect_b32 s41, 8, 1
    s_cmp_lt_u32 s29, 14
    s_cselect_b32 s41, s41, 0
    v_and_b32 v221, 7, v0
    v_cmp_gt_u32 vcc, s41, v221
    v_lshlrev_b32 v221, 4, v221
    s_nop 0
    v_cndmask_b32 v221, v236, v221, vcc
    v_bfe_u32 v228, v0, 3, 1
    v_lshl_add_u32 v228, v228, 2, v235
    v_mul_u32_u24 v228, 57344, v228
    v_add_u32 v228, v228, v221
    v_lshl_add_u32 v221, v235, 3, v221
    v_and_b32 v235, 40, v0
    v_cmp_eq_u32 vcc, 0, v235
    s_nop 1
    v_cndmask_b32 v221, v236, v221, vcc
    v_lshlrev_b32 v230, 4, v0
    v_cmp_gt_u32 vcc, 41, v0
    s_nop 1
    v_cndmask_b32 v229, v236, v230, vcc
    v_lshrrev_b32 v234, 1, v234
    v_and_b32 v235, 1, v0
    v_lshlrev_b32 v235, 4, v235
    v_mov_b32 v236, 0x3f80
    v_lshlrev_b32 v235, v235, v236
    v_cmp_eq_u32 vcc, 0, v234
    s_nop 1
    v_cndmask_b32 v224, 0, v235, vcc
    v_cmp_eq_u32 vcc, 1, v234
    s_nop 1
    v_cndmask_b32 v225, 0, v235, vcc
    v_cmp_eq_u32 vcc, 2, v234
    s_nop 1
    v_cndmask_b32 v226, 0, v235, vcc
    v_cmp_eq_u32 vcc, 3, v234
    s_nop 1
    v_cndmask_b32 v227, 0, v235, vcc
    s_setprio 3
    ds_read_b32 v5, v4 offset:240
    s_cmp_lt_u32 s37, 2
    s_waitcnt vmcnt(10)
    s_cbranch_scc1 L_w01_18
    s_waitcnt vmcnt(5)
L_w01_18:
    s_mov_b64 exec, 1
    ds_add_u32 v4, v4 offset:116
    s_mov_b64 exec, -1
    s_waitcnt lgkmcnt(1)
    v_cmp_ne_u32 vcc, 0x9e000, v5
    s_cbranch_vccnz L_cs_19
L_cb_20:
    s_add_u32 s75, s75, 491520
    s_cmp_ge_u32 s75, 2457600
    s_cselect_b32 s40, 2457600, 0
    s_sub_u32 s75, s75, s40
    s_bfe_u32 s41, 0xf0a1914, s70
    s_lshl_b32 s41, s41, 10
    s_add_u32 m0, s41, 0
    s_nop 0
    buffer_load_dwordx4 v240, s[8:11], s75 offen lds
    s_add_u32 m0, s41, 1024
    s_nop 0
    buffer_load_dwordx4 v241, s[8:11], s75 offen lds
    s_add_u32 m0, s41, 2048
    s_nop 0
    buffer_load_dwordx4 v242, s[8:11], s75 offen lds
    s_add_u32 m0, s41, 3072
    s_nop 0
    buffer_load_dwordx4 v243, s[8:11], s75 offen lds
    s_add_u32 m0, s41, 4096
    s_nop 0
    buffer_load_dwordx4 v244, s[8:11], s75 offen lds
    ds_read_b32 v5, v4 offset:244
    s_cmp_lt_u32 s37, 2
    s_waitcnt vmcnt(10)
    s_cbranch_scc1 L_w01_21
    s_waitcnt vmcnt(5)
L_w01_21:
    s_mov_b64 exec, 1
    ds_add_u32 v4, v4 offset:120
    s_mov_b64 exec, -1
    s_waitcnt lgkmcnt(1)
    v_cmp_ne_u32 vcc, 0x9e000, v5
    s_cbranch_vccnz L_cs_22
L_cb_23:
    s_add_u32 s75, s75, 491520
    s_cmp_ge_u32 s75, 2457600
    s_cselect_b32 s40, 2457600, 0
    s_sub_u32 s75, s75, s40
    s_bfe_u32 s41, 0x231e3d38, s70
    s_lshl_b32 s41, s41, 10
    s_add_u32 m0, s41, 0
    s_nop 0
    buffer_load_dwordx4 v240, s[8:11], s75 offen lds
    s_add_u32 m0, s41, 1024
    s_nop 0
    buffer_load_dwordx4 v241, s[8:11], s75 offen lds
    s_add_u32 m0, s41, 2048
    s_nop 0
    buffer_load_dwordx4 v242, s[8:11], s75 offen lds
    s_add_u32 m0, s41, 3072
    s_nop 0
    buffer_load_dwordx4 v243, s[8:11], s75 offen lds
    s_add_u32 m0, s41, 4096
    s_nop 0
    buffer_load_dwordx4 v244, s[8:11], s75 offen lds
    s_add_u32 s75, s75, 491520
    s_cmp_ge_u32 s75, 2457600
    s_cselect_b32 s40, 2457600, 0
    s_sub_u32 s75, s75, s40
    s_bfe_u32 s41, 0x42326762, s70
    s_lshl_b32 s41, s41, 10
    s_add_u32 m0, s41, 0
    s_nop 0
    buffer_load_dwordx4 v240, s[8:11], s75 offen lds
    s_add_u32 m0, s41, 1024
    s_nop 0
    buffer_load_dwordx4 v241, s[8:11], s75 offen lds
    s_add_u32 m0, s41, 2048
    s_nop 0
    buffer_load_dwordx4 v242, s[8:11], s75 offen lds
    s_add_u32 m0, s41, 3072
    s_nop 0
    buffer_load_dwordx4 v243, s[8:11], s75 offen lds
    s_add_u32 m0, s41, 4096
    s_nop 0
    buffer_load_dwordx4 v244, s[8:11], s75 offen lds
    s_waitcnt vmcnt(10)
    s_mov_b64 exec, 1
    ds_add_u32 v4, v4 offset:124
    s_mov_b64 exec, -1
    s_mul_i32 s40, s39, 163840
    s_add_u32 s40, s40, 0x640000
    s_lshl_b32 s41, s30, 2
    s_add_u32 s41, s41, s37
    v_and_b32 v20, 31, v0
    v_lshrrev_b32 v21, 5, v0
    v_mul_u32_u24 v21, 20480, v21
    v_lshl_add_u32 v20, v20, 4, v21
    v_and_b32 v21, 15, v0
    v_lshrrev_b32 v16, 4, v0
    v_mul_u32_u24 v16, 20480, v16
    v_lshl_add_u32 v21, v21, 4, v16
    v_mov_b32 v16, -1
    v_mov_b32 v17, -1
    v_mov_b32 v18, -1
    v_mov_b32 v19, -1
    s_lshl_b32 s42, s41, 9
    s_add_u32 s42, s42, s40
    buffer_store_dwordx4 v[16:19], v20, s[12:15], s42 offen sc1
    s_add_u32 s42, s42, 40960
    buffer_store_dwordx4 v[16:19], v20, s[12:15], s42 offen sc1
    s_add_u32 s42, s42, 40960
    buffer_store_dwordx4 v[16:19], v20, s[12:15], s42 offen sc1
    s_add_u32 s42, s42, 40960
    buffer_store_dwordx4 v[16:19], v20, s[12:15], s42 offen sc1
    s_lshr_b32 s42, s41, 1
    s_lshl_b32 s42, s42, 8
    s_add_u32 s40, s40, s42
    s_and_b32 s42, s41, 1
    s_mul_i32 s42, s42, 81920
    s_add_u32 s40, s40, s42
    s_add_u32 s40, s40, 16384
    buffer_store_dwordx4 v[16:19], v21, s[12:15], s40 offen sc1
    v_lshlrev_b32 v22, 4, v0
    buffer_store_dwordx4 v[16:19], v22, s[12:15], s49 offen offset:0 sc1
    buffer_store_dwordx4 v[16:19], v22, s[12:15], s49 offen offset:768 sc1
    buffer_store_dwordx2 v[16:17], v221, s[12:15], s53 offen sc1
    s_waitcnt vmcnt(13)
    s_mov_b64 exec, 1
    ds_add_u32 v4, v4 offset:144
    s_mov_b64 exec, -1
    s_waitcnt vmcnt(8)
    s_mov_b64 exec, 1
    ds_add_u32 v4, v4 offset:148
    s_mov_b64 exec, -1
    s_lshl_b32 s40, s35, 7
    s_lshl_b32 s41, s37, 3
    s_add_u32 s40, s40, s41
    s_add_u32 s40, s40, 0xb40000
    v_mov_b32 v26, s32
    v_mov_b32 v27, s33
    s_waitcnt vmcnt(0)
    s_mov_b64 exec, 1
    buffer_store_dwordx2 v[26:27], off, s[12:15], s40 sc1
    s_mov_b64 exec, -1
    ds_read_b32 v5, v4 offset:176
    s_waitcnt lgkmcnt(0)
    v_cmp_ne_u32 vcc, 0x9e000, v5
    s_cbranch_vccnz L_cs_24
L_cb_25:
    ds_read_b64_tr_b16 v[188:189], v214 offset:0
    ds_read_b64_tr_b16 v[190:191], v214 offset:1280
    ds_read_b64_tr_b16 v[192:193], v214 offset:32
    ds_read_b64_tr_b16 v[194:195], v214 offset:1312
    ds_read_b64_tr_b16 v[196:197], v214 offset:64
    ds_read_b64_tr_b16 v[198:199], v214 offset:1344
    ds_read_b64_tr_b16 v[200:201], v214 offset:2560
    ds_read_b64_tr_b16 v[202:203], v214 offset:3840
    ds_read_b64_tr_b16 v[204:205], v214 offset:2592
    ds_read_b64_tr_b16 v[206:207], v214 offset:3872
    ds_read_b64_tr_b16 v[208:209], v214 offset:2624
    ds_read_b64_tr_b16 v[210:211], v214 offset:3904
    ds_read_b64_tr_b16 v[164:165], v213 offset:6464
    ds_read_b64_tr_b16 v[166:167], v213 offset:7744
    ds_read_b64_tr_b16 v[168:169], v213 offset:6496
    ds_read_b64_tr_b16 v[170:171], v213 offset:7776
    ds_read_b64_tr_b16 v[172:173], v213 offset:6528
    ds_read_b64_tr_b16 v[174:175], v213 offset:7808
    ds_read_b64_tr_b16 v[176:177], v213 offset:9024
    ds_read_b64_tr_b16 v[178:179], v213 offset:10304
    ds_read_b64_tr_b16 v[180:181], v213 offset:9056
    ds_read_b64_tr_b16 v[182:183], v213 offset:10336
    ds_read_b64_tr_b16 v[184:185], v213 offset:9088
    ds_read_b64_tr_b16 v[186:187], v213 offset:10368
    s_waitcnt lgkmcnt(12)
    s_add_u32 s75, s75, 491520
    s_cmp_ge_u32 s75, 2457600
    s_cselect_b32 s40, 2457600, 0
    s_sub_u32 s75, s75, s40
    s_bfe_u32 s41, 0x5d58534e, s70
    s_lshl_b32 s41, s41, 10
    s_add_u32 m0, s41, 0
    s_nop 0
    buffer_load_dwordx4 v240, s[8:11], s75 offen lds
    s_add_u32 m0, s41, 1024
    s_nop 0
    buffer_load_dwordx4 v241, s[8:11], s75 offen lds
    s_add_u32 m0, s41, 2048
    s_nop 0
    buffer_load_dwordx4 v242, s[8:11], s75 offen lds
    s_add_u32 m0, s41, 3072
    s_nop 0
    buffer_load_dwordx4 v243, s[8:11], s75 offen lds
    s_add_u32 m0, s41, 4096
    s_nop 0
    buffer_load_dwordx4 v244, s[8:11], s75 offen lds
    ds_read_b64_tr_b16 v[76:77], v215 offset:0
    ds_read_b64_tr_b16 v[78:79], v215 offset:256
    ds_read_b64_tr_b16 v[80:81], v216 offset:0
    ds_read_b64_tr_b16 v[82:83], v216 offset:256
    ds_read_b64_tr_b16 v[84:85], v215 offset:512
    ds_read_b64_tr_b16 v[86:87], v215 offset:768
    ds_read_b64_tr_b16 v[88:89], v216 offset:512
    ds_read_b64_tr_b16 v[90:91], v216 offset:768
    ds_read_b64_tr_b16 v[92:93], v215 offset:1024
    ds_read_b64_tr_b16 v[94:95], v215 offset:1280
    ds_read_b64_tr_b16 v[96:97], v216 offset:1024
    ds_read_b64_tr_b16 v[98:99], v216 offset:1280
    ds_read_b64_tr_b16 v[100:101], v215 offset:1536
    ds_read_b64_tr_b16 v[102:103], v215 offset:1792
    ds_read_b64_tr_b16 v[104:105], v216 offset:1536
    ds_read_b64_tr_b16 v[106:107], v216 offset:1792
    v_add_u32 v235, s48, v230
    v_mov_b32 v20, 0
    v_mov_b32 v21, 0
    v_mov_b32 v22, 0
    v_mov_b32 v23, 0
    ds_write_b128 v235, v[20:23] offset:2048
    ds_write_b128 v235, v[20:23] offset:3072
    s_waitcnt lgkmcnt(14)
    v_mfma_f32_16x16x32_bf16 v[108:111], v[164:167], v[76:79], 0
    v_mfma_f32_16x16x32_bf16 v[112:115], v[164:167], v[80:83], 0
    v_mfma_f32_16x16x32_bf16 v[116:119], v[168:171], v[76:79], 0
    v_mfma_f32_16x16x32_bf16 v[120:123], v[168:171], v[80:83], 0
    v_mfma_f32_16x16x32_bf16 v[124:127], v[172:175], v[76:79], 0
    v_mfma_f32_16x16x32_bf16 v[128:131], v[172:175], v[80:83], 0
    s_waitcnt lgkmcnt(10)
    v_mfma_f32_16x16x32_bf16 v[108:111], v[176:179], v[84:87], v[108:111]
    v_mfma_f32_16x16x32_bf16 v[112:115], v[176:179], v[88:91], v[112:115]
    v_mfma_f32_16x16x32_bf16 v[116:119], v[180:183], v[84:87], v[116:119]
    v_mfma_f32_16x16x32_bf16 v[120:123], v[180:183], v[88:91], v[120:123]
    v_mfma_f32_16x16x32_bf16 v[124:127], v[184:187], v[84:87], v[124:127]
    v_mfma_f32_16x16x32_bf16 v[128:131], v[184:187], v[88:91], v[128:131]
    s_waitcnt lgkmcnt(6)
    v_mfma_f32_16x16x32_bf16 v[108:111], v[188:191], v[92:95], v[108:111]
    v_mfma_f32_16x16x32_bf16 v[112:115], v[188:191], v[96:99], v[112:115]
    v_mfma_f32_16x16x32_bf16 v[116:119], v[192:195], v[92:95], v[116:119]
    v_mfma_f32_16x16x32_bf16 v[120:123], v[192:195], v[96:99], v[120:123]
    v_mfma_f32_16x16x32_bf16 v[124:127], v[196:199], v[92:95], v[124:127]
    v_mfma_f32_16x16x32_bf16 v[128:131], v[196:199], v[96:99], v[128:131]
    s_waitcnt lgkmcnt(2)
    v_mfma_f32_16x16x32_bf16 v[108:111], v[200:203], v[100:103], v[108:111]
    v_mfma_f32_16x16x32_bf16 v[112:115], v[200:203], v[104:107], v[112:115]
    v_mfma_f32_16x16x32_bf16 v[116:119], v[204:207], v[100:103], v[116:119]
    v_mfma_f32_16x16x32_bf16 v[120:123], v[204:207], v[104:107], v[120:123]
    v_mfma_f32_16x16x32_bf16 v[124:127], v[208:211], v[100:103], v[124:127]
    v_mfma_f32_16x16x32_bf16 v[128:131], v[208:211], v[104:107], v[128:131]
    s_nop 2
    v_cvt_pk_bf16_f32 v108, v108, v109
    v_cvt_pk_bf16_f32 v109, v110, v111
    v_min_u32 v108, 0xfffffffe, v108
    buffer_store_dwordx2 v[108:109], v217, s[12:15], s49 offen offset:0 sc1
    v_cvt_pk_bf16_f32 v112, v112, v113
    v_cvt_pk_bf16_f32 v113, v114, v115
    v_min_u32 v112, 0xfffffffe, v112
    buffer_store_dwordx2 v[112:113], v218, s[12:15], s49 offen offset:1280 sc1
    v_cvt_pk_bf16_f32 v116, v116, v117
    v_cvt_pk_bf16_f32 v117, v118, v119
    v_min_u32 v116, 0xfffffffe, v116
    buffer_store_dwordx2 v[116:117], v217, s[12:15], s49 offen offset:32 sc1
    v_cvt_pk_bf16_f32 v120, v120, v121
    v_cvt_pk_bf16_f32 v121, v122, v123
    v_min_u32 v120, 0xfffffffe, v120
    buffer_store_dwordx2 v[120:121], v218, s[12:15], s49 offen offset:1312 sc1
    v_cvt_pk_bf16_f32 v124, v124, v125
    v_cvt_pk_bf16_f32 v125, v126, v127
    v_min_u32 v124, 0xfffffffe, v124
    buffer_store_dwordx2 v[124:125], v219, s[12:15], s49 offen offset:64 sc1
    v_cvt_pk_bf16_f32 v128, v128, v129
    v_cvt_pk_bf16_f32 v129, v130, v131
    v_min_u32 v128, 0xfffffffe, v128
    buffer_store_dwordx2 v[128:129], v220, s[12:15], s49 offen offset:1344 sc1
    buffer_load_dwordx2 v[232:233], v231, s[12:15], s51 offen sc1
    s_waitcnt vmcnt(7)
    s_mov_b64 exec, 1
    ds_add_u32 v4, v4 offset:152
    s_mov_b64 exec, -1
    s_lshr_b32 s40, s2, 3
    s_lshl_b32 s40, s40, 2
    s_add_u32 s40, s40, s37
    s_mul_i32 s40, s40, 6400
    v_lshlrev_b32 v25, 7, v0
    s_mov_b32 exec_hi, 0x3ffff
    buffer_load_dword v24, v25, s[16:19], s40 offen
    s_mov_b32 exec_hi, -1
    s_waitcnt vmcnt(1)
    v_cmp_ne_u64 vcc, s[32:33], v[232:233]
    s_nop 4
    s_cbranch_vccz L_cfok
    s_mov_b32 s41, 32768
L_poll_26:
    buffer_load_dwordx2 v[232:233], v231, s[12:15], s51 offen sc1
    s_waitcnt vmcnt(0)
    v_cmp_ne_u64 vcc, s[32:33], v[232:233]
    s_nop 4
    s_cbranch_vccz L_pdone_27
    s_sub_u32 s41, s41, 1
    s_cmp_lg_u32 s41, 0
    s_cbranch_scc1 L_poll_26
L_pdone_27:
L_cfok:
    s_add_u32 s42, s50, 458752
    s_mov_b32 s77, 8192
    buffer_load_dwordx4 v[80:83], v228, s[12:15], s50 offen sc1
    buffer_load_dwordx4 v[84:87], v228, s[12:15], s42 offen sc1
    s_branch L_pa1
L_pa0:
    s_sleep 8
    buffer_load_dwordx4 v[80:83], v228, s[12:15], s50 offen sc1
    buffer_load_dwordx4 v[84:87], v228, s[12:15], s42 offen sc1
L_pa1:
    s_sub_u32 s77, s77, 1
    s_waitcnt vmcnt(0)
    s_cbranch_scc1 L_pa2
    v_max3_u32 v234, v80, v82, v84
    v_max_u32 v234, v234, v86
    v_cmp_eq_u32 vcc, -1, v234
    s_nop 4
    s_cbranch_vccnz L_pa0
L_pa2:
    v_mfma_f32_16x16x32_bf16 v[208:211], v[224:227], v[80:83], 0
    v_mfma_f32_16x16x32_bf16 v[208:211], v[224:227], v[84:87], v[208:211]
    s_nop 7
    v_add_f32_dpp v212, v208, v208 row_ror:8 row_mask:0xf bank_mask:0xf
    v_add_f32_dpp v213, v209, v209 row_ror:8 row_mask:0xf bank_mask:0xf
    v_add_f32_dpp v214, v210, v210 row_ror:8 row_mask:0xf bank_mask:0xf
    v_add_f32_dpp v215, v211, v211 row_ror:8 row_mask:0xf bank_mask:0xf
    v_cvt_pk_bf16_f32 v208, v212, v213
    v_cvt_pk_bf16_f32 v209, v214, v215
    v_min_u32 v208, 0xfffffffe, v208
    buffer_store_dwordx2 v[208:209], v221, s[12:15], s53 offen sc1
    ds_read_b32 v5, v4 offset:280
    s_waitcnt lgkmcnt(0)
    v_cmp_ne_u32 vcc, 0x9e000, v5
    s_cbranch_vccnz L_cs_28
L_cb_29:
    s_and_b32 s41, s37, 2
    s_add_u32 s41, s41, s37
    s_lshl1_add_u32 s40, s41, 0
    s_lshl_b32 s41, s30, 1
    s_add_u32 s41, s41, s40
    s_and_b32 s41, s41, 7
    s_and_b32 s42, s40, 8
    s_add_u32 s42, s42, s41
    s_mul_i32 s42, s42, 51200
    s_mul_i32 s40, s37, 10752
    s_add_u32 m0, s40, 67584
    s_nop 0
    buffer_load_dwordx4 v6, s[16:19], s42 offen lds
    s_add_u32 m0, s40, 68608
    s_nop 0
    buffer_load_dwordx4 v7, s[16:19], s42 offen lds
    s_add_u32 m0, s40, 69632
    s_nop 0
    buffer_load_dwordx4 v8, s[16:19], s42 offen lds
    s_add_u32 m0, s40, 70656
    s_nop 0
    buffer_load_dwordx4 v9, s[16:19], s42 offen lds
    s_add_u32 m0, s40, 71680
    s_nop 0
    buffer_load_dwordx4 v10, s[16:19], s42 offen lds
    s_and_b32 s41, s37, 2
    s_add_u32 s41, s41, s37
    s_lshl1_add_u32 s40, s41, 1
    s_lshl_b32 s41, s30, 1
    s_add_u32 s41, s41, s40
    s_and_b32 s41, s41, 7
    s_and_b32 s42, s40, 8
    s_add_u32 s42, s42, s41
    s_mul_i32 s42, s42, 51200
    s_mul_i32 s40, s37, 10752
    s_add_u32 m0, s40, 72704
    s_nop 0
    buffer_load_dwordx4 v6, s[16:19], s42 offen lds
    s_add_u32 m0, s40, 73728
    s_nop 0
    buffer_load_dwordx4 v7, s[16:19], s42 offen lds
    s_add_u32 m0, s40, 74752
    s_nop 0
    buffer_load_dwordx4 v8, s[16:19], s42 offen lds
    s_add_u32 m0, s40, 75776
    s_nop 0
    buffer_load_dwordx4 v9, s[16:19], s42 offen lds
    s_add_u32 m0, s40, 76800
    s_nop 0
    buffer_load_dwordx4 v10, s[16:19], s42 offen lds
    s_lshr_b32 s41, s30, 1
    s_add_u32 s41, s41, s37
    s_and_b32 s41, s41, 1
    s_and_b32 s42, s37, 2
    s_add_u32 s42, s42, s41
    s_mul_i32 s42, s42, 204800
    s_mul_i32 s40, s37, 6144
    s_add_u32 m0, s40, 43008
    s_nop 0
    buffer_load_dwordx4 v11, s[16:19], s42 offen lds
    s_add_u32 m0, s40, 44032
    s_nop 0
    buffer_load_dwordx4 v12, s[16:19], s42 offen lds
    s_add_u32 m0, s40, 45056
    s_nop 0
    buffer_load_dwordx4 v13, s[16:19], s42 offen lds
    s_add_u32 m0, s40, 46080
    s_nop 0
    buffer_load_dwordx4 v14, s[16:19], s42 offen lds
    s_add_u32 m0, s40, 47104
    s_nop 0
    buffer_load_dwordx4 v15, s[16:19], s42 offen lds
    s_mov_b32 s77, 8192
    buffer_load_dwordx4 v[80:83], v230, s[12:15], s52 offen sc1
    buffer_load_dwordx4 v[84:87], v229, s[12:15], s52 offen offset:1024 sc1
    s_branch L_pb1
L_pb0:
    s_sleep 8
    buffer_load_dwordx4 v[80:83], v230, s[12:15], s52 offen sc1
    buffer_load_dwordx4 v[84:87], v229, s[12:15], s52 offen offset:1024 sc1
L_pb1:
    s_sub_u32 s77, s77, 1
    s_waitcnt vmcnt(0)
    s_cbranch_scc1 L_pb2
    v_max3_u32 v234, v80, v82, v84
    v_max_u32 v234, v234, v86
    v_cmp_eq_u32 vcc, -1, v234
    s_nop 4
    s_cbranch_vccnz L_pb0
L_pb2:
    ds_write_b128 v235, v[80:83]
    ds_write_b128 v235, v[84:87] offset:1024
    s_mov_b64 exec, 1
    ds_add_u32 v4, v4 offset:188
    s_mov_b64 exec, -1
    s_setprio 0
    s_branch L_p3h
L_cs_1:
    s_mov_b32 s47, 1048576
L_cs_1l:
    ds_read_b32 v5, v4 offset:208
    s_waitcnt lgkmcnt(0)
    v_cmp_ne_u32 vcc, 0x9e000, v5
    s_cbranch_vccz L_cb_2
    s_sub_u32 s47, s47, 1
    s_cmp_lg_u32 s47, 0
    s_cbranch_scc1 L_cs_1l
    s_branch L_cb_2
L_cs_3:
    s_mov_b32 s47, 1048576
L_cs_3l:
    ds_read_b32 v5, v4 offset:212
    s_waitcnt lgkmcnt(0)
    v_cmp_ne_u32 vcc, 0x9e000, v5
    s_cbranch_vccz L_cb_4
    s_sub_u32 s47, s47, 1
    s_cmp_lg_u32 s47, 0
    s_cbranch_scc1 L_cs_3l
    s_branch L_cb_4
L_cs_5:
    s_mov_b32 s47, 1048576
L_cs_5l:
    ds_read_b32 v5, v4 offset:216
    s_waitcnt lgkmcnt(0)
    v_cmp_ne_u32 vcc, 0x9e000, v5
    s_cbranch_vccz L_cb_6
    s_sub_u32 s47, s47, 1
    s_cmp_lg_u32 s47, 0
    s_cbranch_scc1 L_cs_5l
    s_branch L_cb_6
L_cs_7:
    s_mov_b32 s47, 1048576
L_cs_7l:
    ds_read_b32 v5, v4 offset:220
    s_waitcnt lgkmcnt(0)
    v_cmp_ne_u32 vcc, 0x9e000, v5
    s_cbranch_vccz L_cb_8
    s_sub_u32 s47, s47, 1
    s_cmp_lg_u32 s47, 0
    s_cbranch_scc1 L_cs_7l
    s_branch L_cb_8
L_cs_9:
    s_mov_b32 s47, 1048576
L_cs_9l:
    ds_read_b32 v5, v4 offset:224
    s_waitcnt lgkmcnt(0)
    v_cmp_ne_u32 vcc, 0x9e000, v5
    s_cbranch_vccz L_cb_10
    s_sub_u32 s47, s47, 1
    s_cmp_lg_u32 s47, 0
    s_cbranch_scc1 L_cs_9l
    s_branch L_cb_10
L_cs_11:
    s_mov_b32 s47, 1048576
L_cs_11l:
    ds_read_b32 v5, v4 offset:228
    s_waitcnt lgkmcnt(0)
    v_cmp_ne_u32 vcc, 0x9e000, v5
    s_cbranch_vccz L_cb_12
    s_sub_u32 s47, s47, 1
    s_cmp_lg_u32 s47, 0
    s_cbranch_scc1 L_cs_11l
    s_branch L_cb_12
L_cs_13:
    s_mov_b32 s47, 1048576
L_cs_13l:
    ds_read_b32 v5, v4 offset:232
    s_waitcnt lgkmcnt(0)
    v_cmp_ne_u32 vcc, 0x9e000, v5
    s_cbranch_vccz L_cb_14
    s_sub_u32 s47, s47, 1
    s_cmp_lg_u32 s47, 0
    s_cbranch_scc1 L_cs_13l
    s_branch L_cb_14
L_cs_15:
    s_mov_b32 s47, 1048576
L_cs_15l:
    ds_read_b32 v5, v4 offset:236
    s_waitcnt lgkmcnt(0)
    v_cmp_ne_u32 vcc, 0x9e000, v5
    s_cbranch_vccz L_cb_16
    s_sub_u32 s47, s47, 1
    s_cmp_lg_u32 s47, 0
    s_cbranch_scc1 L_cs_15l
    s_branch L_cb_16
L_cs_19:
    s_mov_b32 s47, 1048576
L_cs_19l:
    ds_read_b32 v5, v4 offset:240
    s_waitcnt lgkmcnt(0)
    v_cmp_ne_u32 vcc, 0x9e000, v5
    s_cbranch_vccz L_cb_20
    s_sub_u32 s47, s47, 1
    s_cmp_lg_u32 s47, 0
    s_cbranch_scc1 L_cs_19l
    s_branch L_cb_20
L_cs_22:
    s_mov_b32 s47, 1048576
L_cs_22l:
    ds_read_b32 v5, v4 offset:244
    s_waitcnt lgkmcnt(0)
    v_cmp_ne_u32 vcc, 0x9e000, v5
    s_cbranch_vccz L_cb_23
    s_sub_u32 s47, s47, 1
    s_cmp_lg_u32 s47, 0
    s_cbranch_scc1 L_cs_22l
    s_branch L_cb_23
L_cs_24:
    s_mov_b32 s47, 1048576
L_cs_24l:
    ds_read_b32 v5, v4 offset:176
    s_waitcnt lgkmcnt(0)
    v_cmp_ne_u32 vcc, 0x9e000, v5
    s_cbranch_vccz L_cb_25
    s_sub_u32 s47, s47, 1
    s_cmp_lg_u32 s47, 0
    s_cbranch_scc1 L_cs_24l
    s_branch L_cb_25
L_cs_28:
    s_mov_b32 s47, 1048576
L_cs_28l:
    ds_read_b32 v5, v4 offset:280
    s_waitcnt lgkmcnt(0)
    v_cmp_ne_u32 vcc, 0x9e000, v5
    s_cbranch_vccz L_cb_29
    s_sub_u32 s47, s47, 1
    s_cmp_lg_u32 s47, 0
    s_cbranch_scc1 L_cs_28l
    s_branch L_cb_29
L_nc_poll:
    s_mov_b32 s47, 32768
L_nc_lp:
    buffer_load_dwordx2 v[246:247], off, s[24:27], 0 sc1
    s_waitcnt vmcnt(0)
    v_cmp_ne_u64 vcc, 0, v[246:247]
    s_cbranch_vccnz L_nc_ok
    s_sub_u32 s47, s47, 1
    s_cmp_lg_u32 s47, 0
    s_cbranch_scc1 L_nc_lp
    s_branch L_nc_ok
L_helperB:
    s_min_u32 s40, s29, 1
    s_min_u32 s41, s29, 2
    s_and_b32 s42, s35, 127
    s_mul_i32 s43, s37, 10752
    s_lshl_b32 s48, s40, 3
    s_sub_u32 s48, s42, s48
    s_mul_i32 s48, s48, 43008
    s_add_u32 s48, s48, s43
    s_lshl_b32 s49, s41, 3
    s_sub_u32 s49, s42, s49
    s_mul_i32 s49, s49, 43008
    s_add_u32 s49, s49, s43
    s_lshl_b32 s40, s40, 10
    s_lshl_b32 s41, s41, 10
    s_sub_u32 s40, 2048, s40
    s_sub_u32 s41, 2048, s41
    v_mov_b32 v16, s40
    v_mov_b32 v17, s41
    v_cndmask_b32 v80, v16, v17, s[80:81]
    s_lshl_b32 s50, s35, 7
    s_lshl_b32 s40, s37, 3
    s_add_u32 s50, s50, s40
    s_add_u32 s50, s50, 0xb3f820
    s_mov_b32 s51, s43
    v_lshlrev_b32 v17, 4, v0
    s_mul_i32 s63, s42, 43008
    s_add_u32 s63, s63, s43
    s_add_u32 s43, s43, 110592
    v_add_u32 v18, s43, v17
    v_lshlrev_b32 v20, 4, v0
    v_add_u32 v20, 156160, v20
    ds_write_b64 v20, v[6:7]
    ds_write_b128 v20, v[8:11] offset:1024
    ds_write_b128 v20, v[12:15] offset:2048
    ds_read_b32 v5, v4 offset:236
    s_waitcnt vmcnt(9)
    s_mov_b64 exec, 1
    ds_add_u32 v4, v4 offset:112
    s_mov_b64 exec, -1
    s_waitcnt lgkmcnt(1)
    v_cmp_ne_u32 vcc, 0x9e000, v5
    s_cbranch_vccnz L_cs_30
L_cb_31:
    s_add_u32 s71, s71, 245760
    s_cmp_ge_u32 s71, 2457600
    s_cselect_b32 s40, 2457600, 0
    s_sub_u32 s71, s71, s40
    s_cmp_lt_u32 s37, 2
    s_cselect_b32 s71, s71, s75
    s_bfe_u32 s41, 0x5005d58, s70
    s_lshl_b32 s41, s41, 10
    s_add_u32 m0, s41, 0
    s_nop 0
    buffer_load_dwordx4 v240, s[8:11], s71 offen lds
    s_add_u32 m0, s41, 1024
    s_nop 0
    buffer_load_dwordx4 v241, s[8:11], s71 offen lds
    s_add_u32 m0, s41, 2048
    s_nop 0
    buffer_load_dwordx4 v242, s[8:11], s71 offen lds
    s_add_u32 m0, s41, 3072
    s_nop 0
    buffer_load_dwordx4 v243, s[8:11], s71 offen lds
    s_add_u32 m0, s41, 4096
    s_nop 0
    buffer_load_dwordx4 v244, s[8:11], s71 offen lds
    s_cmp_ge_u32 s37, 2
    s_cbranch_scc1 L_nob_32
    s_bfe_u32 s41, 0x5002d28, s70
    s_lshl_b32 s41, s41, 10
    s_add_u32 m0, s41, 0
    s_nop 0
    buffer_load_dwordx4 v240, s[8:11], s75 offen lds
    s_add_u32 m0, s41, 1024
    s_nop 0
    buffer_load_dwordx4 v241, s[8:11], s75 offen lds
    s_add_u32 m0, s41, 2048
    s_nop 0
    buffer_load_dwordx4 v242, s[8:11], s75 offen lds
    s_add_u32 m0, s41, 3072
    s_nop 0
    buffer_load_dwordx4 v243, s[8:11], s75 offen lds
    s_add_u32 m0, s41, 4096
    s_nop 0
    buffer_load_dwordx4 v244, s[8:11], s75 offen lds
L_nob_32:
    v_and_b32 v64, 31, v0
    v_lshrrev_b32 v65, 5, v0
    v_lshlrev_b32 v69, 4, v64
    v_lshl_add_u32 v68, v65, 11, v69
    v_bfe_u32 v66, v0, 2, 2
    v_lshl_add_u32 v66, v65, 2, v66
    v_and_b32 v67, 1, v0
    v_mul_u32_u24 v67, 2176, v67
    v_bfe_u32 v70, v0, 1, 1
    v_lshl_add_u32 v67, v70, 3, v67
    v_mov_b32 v70, 4424
    s_mov_b32 s78, 0xffff0000
    s_mov_b32 s79, 0xffff0000
    v_cndmask_b32 v67, v67, v70, s[78:79]
    v_lshl_add_u32 v70, v66, 4, v67
    v_lshl_add_u32 v71, v65, 6, v4
    s_mov_b32 s78, 0xeeee0000
    s_mov_b32 s79, 0xeeee0000
    s_mul_i32 s40, s37, 6144
    s_add_u32 s40, s40, 43008
    v_add_u32 v96, s40, v69
    v_add_u32 v97, s40, v68
    s_mul_i32 s40, s37, 10752
    v_add_u32 v68, s40, v68
    v_add_u32 v69, s40, v69
    v_add_u32 v70, s40, v70
    v_add_u32 v180, 117056, v68
    v_add_u32 v66, 115008, v69
    v_mov_b32 v67, 161792
    v_cndmask_b32 v181, v66, v67, s[80:81]
    v_add_u32 v66, 110592, v70
    v_cndmask_b32 v182, v66, v71, s[78:79]
    v_sub_u32 v66, 31, v64
    v_and_b32 v67, 3, v66
    v_mul_u32_u24 v67, 576, v67
    v_lshrrev_b32 v66, 2, v66
    v_add_u32 v66, v66, v65
    v_lshl_add_u32 v66, v66, 4, v67
    v_add_u32 v189, 153600, v66
    v_add_u32 v183, 6464, v68
    v_add_u32 v66, 4416, v69
    v_mov_b32 v67, 161808
    v_cndmask_b32 v184, v66, v67, s[80:81]
    v_cndmask_b32 v185, v70, v71, s[78:79]
    v_add_u32 v186, 74048, v68
    v_add_u32 v66, 72000, v69
    v_mov_b32 v67, 161824
    v_cndmask_b32 v187, v66, v67, s[80:81]
    v_add_u32 v66, 67584, v70
    v_cndmask_b32 v188, v66, v71, s[78:79]
    v_and_b32 v66, 15, v0
    v_bfe_u32 v67, v0, 4, 1
    v_mul_u32_u24 v67, 20480, v67
    v_lshl_add_u32 v66, v66, 4, v67
    v_lshl_add_u32 v191, v65, 8, v66
    v_mov_b32 v67, 0x80000000
    v_cndmask_b32 v2, v66, v67, s[80:81]
    s_lshl_b32 s41, s37, 2
    v_add_u32 v3, s41, v4
    v_and_b32 v190, 3, v0
    v_bfe_u32 v192, v0, 2, 2
    v_lshlrev_b32 v190, 7, v190
    v_lshl_add_u32 v190, v192, 3, v190
    s_mul_i32 s54, s39, 163840
    s_add_u32 s54, s54, 0x640000
    s_lshl_b32 s41, s30, 2
    s_add_u32 s41, s41, s37
    s_lshr_b32 s42, s41, 1
    s_lshl_b32 s42, s42, 8
    s_add_u32 s55, s54, s42
    s_and_b32 s42, s41, 1
    s_lshl_b32 s42, s42, 3
    s_add_u32 s55, s55, s42
    s_add_u32 s55, s55, 16384
    s_lshl_b32 s41, s41, 9
    s_add_u32 s54, s54, s41
    s_mov_b64 s[52:53], -1
    s_lshl_b32 s56, s39, 10
    s_bfe_u32 s41, s31, 0x10001
    s_lshl_b32 s41, s41, 9
    s_add_u32 s56, s56, s41
    s_add_u32 s56, s56, 0xb40000
    s_and_b32 s41, s37, 2
    s_add_u32 s41, s41, s37
    s_lshl1_add_u32 s40, s41, 0
    s_lshl_b32 s41, s30, 1
    s_add_u32 s41, s41, s40
    s_and_b32 s41, s41, 7
    s_and_b32 s57, s40, 8
    s_add_u32 s57, s57, s41
    s_mul_i32 s57, s57, 51200
    s_add_u32 s40, s40, 1
    s_lshl_b32 s41, s30, 1
    s_add_u32 s41, s41, s40
    s_and_b32 s41, s41, 7
    s_and_b32 s58, s40, 8
    s_add_u32 s58, s58, s41
    s_mul_i32 s58, s58, 51200
    s_lshr_b32 s41, s30, 1
    s_add_u32 s41, s41, s37
    s_and_b32 s41, s41, 1
    s_and_b32 s59, s37, 2
    s_add_u32 s59, s59, s41
    s_mul_i32 s59, s59, 204800
    s_mul_i32 s60, s37, 10752
    s_add_u32 s60, s60, 110592
    s_mul_i32 s61, s37, 6144
    s_add_u32 s61, s61, 43008
    ds_read_b32 v5, v4 offset:240
    s_cmp_lt_u32 s37, 2
    s_waitcnt vmcnt(10)
    s_cbranch_scc1 L_w01_33
    s_waitcnt vmcnt(5)
L_w01_33:
    s_mov_b64 exec, 1
    ds_add_u32 v4, v4 offset:116
    s_mov_b64 exec, -1
    s_waitcnt lgkmcnt(1)
    v_cmp_ne_u32 vcc, 0x9e000, v5
    s_cbranch_vccnz L_cs_34
L_cb_35:
    s_add_u32 s75, s75, 491520
    s_cmp_ge_u32 s75, 2457600
    s_cselect_b32 s40, 2457600, 0
    s_sub_u32 s75, s75, s40
    s_bfe_u32 s41, 0xf0a1914, s70
    s_lshl_b32 s41, s41, 10
    s_add_u32 m0, s41, 0
    s_nop 0
    buffer_load_dwordx4 v240, s[8:11], s75 offen lds
    s_add_u32 m0, s41, 1024
    s_nop 0
    buffer_load_dwordx4 v241, s[8:11], s75 offen lds
    s_add_u32 m0, s41, 2048
    s_nop 0
    buffer_load_dwordx4 v242, s[8:11], s75 offen lds
    s_add_u32 m0, s41, 3072
    s_nop 0
    buffer_load_dwordx4 v243, s[8:11], s75 offen lds
    s_add_u32 m0, s41, 4096
    s_nop 0
    buffer_load_dwordx4 v244, s[8:11], s75 offen lds
    s_setprio 3
    ds_read_b32 v5, v4 offset:244
    s_cmp_lt_u32 s37, 2
    s_waitcnt vmcnt(10)
    s_cbranch_scc1 L_w01_36
    s_waitcnt vmcnt(5)
L_w01_36:
    s_mov_b64 exec, 1
    ds_add_u32 v4, v4 offset:120
    s_mov_b64 exec, -1
    s_waitcnt lgkmcnt(1)
    v_cmp_ne_u32 vcc, 0x9e000, v5
    s_cbranch_vccnz L_cs_37
L_cb_38:
    s_add_u32 s75, s75, 491520
    s_cmp_ge_u32 s75, 2457600
    s_cselect_b32 s40, 2457600, 0
    s_sub_u32 s75, s75, s40
    s_bfe_u32 s41, 0x231e3d38, s70
    s_lshl_b32 s41, s41, 10
    s_add_u32 m0, s41, 0
    s_nop 0
    buffer_load_dwordx4 v240, s[8:11], s75 offen lds
    s_add_u32 m0, s41, 1024
    s_nop 0
    buffer_load_dwordx4 v241, s[8:11], s75 offen lds
    s_add_u32 m0, s41, 2048
    s_nop 0
    buffer_load_dwordx4 v242, s[8:11], s75 offen lds
    s_add_u32 m0, s41, 3072
    s_nop 0
    buffer_load_dwordx4 v243, s[8:11], s75 offen lds
    s_add_u32 m0, s41, 4096
    s_nop 0
    buffer_load_dwordx4 v244, s[8:11], s75 offen lds
    s_add_u32 s75, s75, 491520
    s_cmp_ge_u32 s75, 2457600
    s_cselect_b32 s40, 2457600, 0
    s_sub_u32 s75, s75, s40
    s_bfe_u32 s41, 0x42326762, s70
    s_lshl_b32 s41, s41, 10
    s_add_u32 m0, s41, 0
    s_nop 0
    buffer_load_dwordx4 v240, s[8:11], s75 offen lds
    s_add_u32 m0, s41, 1024
    s_nop 0
    buffer_load_dwordx4 v241, s[8:11], s75 offen lds
    s_add_u32 m0, s41, 2048
    s_nop 0
    buffer_load_dwordx4 v242, s[8:11], s75 offen lds
    s_add_u32 m0, s41, 3072
    s_nop 0
    buffer_load_dwordx4 v243, s[8:11], s75 offen lds
    s_add_u32 m0, s41, 4096
    s_nop 0
    buffer_load_dwordx4 v244, s[8:11], s75 offen lds
    ds_read_b32 v5, v4 offset:248
    s_waitcnt vmcnt(10)
    s_mov_b64 exec, 1
    ds_add_u32 v4, v4 offset:124
    s_mov_b64 exec, -1
    s_waitcnt lgkmcnt(1)
    v_cmp_ne_u32 vcc, 0x9e000, v5
    s_cbranch_vccnz L_cs_39
L_cb_40:
    s_add_u32 s75, s75, 491520
    s_cmp_ge_u32 s75, 2457600
    s_cselect_b32 s40, 2457600, 0
    s_sub_u32 s75, s75, s40
    s_bfe_u32 s41, 0x5d58534e, s70
    s_lshl_b32 s41, s41, 10
    s_add_u32 m0, s41, 0
    s_nop 0
    buffer_load_dwordx4 v240, s[8:11], s75 offen lds
    s_add_u32 m0, s41, 1024
    s_nop 0
    buffer_load_dwordx4 v241, s[8:11], s75 offen lds
    s_add_u32 m0, s41, 2048
    s_nop 0
    buffer_load_dwordx4 v242, s[8:11], s75 offen lds
    s_add_u32 m0, s41, 3072
    s_nop 0
    buffer_load_dwordx4 v243, s[8:11], s75 offen lds
    s_add_u32 m0, s41, 4096
    s_nop 0
    buffer_load_dwordx4 v244, s[8:11], s75 offen lds
    ds_read_b32 v5, v4 offset:176
    s_waitcnt lgkmcnt(0)
    v_cmp_ne_u32 vcc, 0x9e000, v5
    s_cbranch_vccnz L_cs_41
L_cb_42:
    ds_read_b128 v[32:35], v18 offset:6464
    ds_read_b128 v[36:39], v18 offset:7488
    ds_read_b128 v[40:43], v18 offset:8512
    ds_read_b128 v[44:47], v18 offset:9536
    ds_read_b128 v[48:51], v18 offset:4416
    ds_read_b128 v[52:55], v18 offset:5440
    ds_read_b128 v[56:59], v18 offset:0
    ds_read_b128 v[60:63], v18 offset:1024
    ds_read_b128 v[64:67], v18 offset:2176
    ds_read_b128 v[68:71], v18 offset:3200
    s_waitcnt vmcnt(10)
    s_mov_b64 exec, 1
    ds_add_u32 v4, v4 offset:144
    s_mov_b64 exec, -1
    s_add_u32 s40, s63, 0x21980
    s_waitcnt lgkmcnt(9)
    buffer_store_dwordx4 v[32:35], v17, s[12:15], s40 offen offset:0 sc1
    buffer_store_dwordx4 v[36:39], v17, s[12:15], s40 offen offset:1024 sc1
    s_waitcnt vmcnt(7)
    s_mov_b64 exec, 1
    ds_add_u32 v4, v4 offset:148
    s_mov_b64 exec, -1
    s_add_u32 s40, s63, 0x22180
    s_waitcnt lgkmcnt(8)
    buffer_store_dwordx4 v[40:43], v17, s[12:15], s40 offen offset:0 sc1
    buffer_store_dwordx4 v[44:47], v17, s[12:15], s40 offen offset:1024 sc1
    s_add_u32 s40, s63, 0x21180
    s_waitcnt lgkmcnt(6)
    buffer_store_dwordx4 v[48:51], v17, s[12:15], s40 offen offset:0 sc1
    buffer_store_dwordx4 v[52:55], v17, s[12:15], s40 offen offset:1024 sc1
    s_waitcnt vmcnt(6)
    s_mov_b64 exec, 1
    ds_add_u32 v4, v4 offset:152
    s_mov_b64 exec, -1
    s_add_u32 s40, s63, 0x20000
    s_waitcnt lgkmcnt(5)
    buffer_store_dwordx4 v[56:59], v17, s[12:15], s40 offen offset:0 sc1
    buffer_store_dwordx4 v[60:63], v17, s[12:15], s40 offen offset:1024 sc1
    s_add_u32 s40, s63, 0x20880
    s_waitcnt lgkmcnt(3)
    buffer_store_dwordx4 v[64:67], v17, s[12:15], s40 offen offset:0 sc1
    buffer_store_dwordx4 v[68:71], v17, s[12:15], s40 offen offset:1024 sc1
    s_lshr_b32 s40, s2, 3
    s_lshl_b32 s40, s40, 2
    s_add_u32 s40, s40, s37
    s_mul_i32 s40, s40, 6400
    v_lshlrev_b32 v85, 7, v0
    s_mov_b32 exec_hi, 0x3ffff
    buffer_load_dword v84, v85, s[16:19], s40 offen
    s_mov_b32 exec_hi, -1
    s_lshl_b32 s63, s39, 13
    s_lshl_b32 s41, s30, 5
    s_add_u32 s63, s63, s41
    s_lshl3_add_u32 s63, s37, s63
    s_add_u32 s63, s63, 0xb80000
    s_lshl_b32 s40, s35, 7
    s_lshl_b32 s41, s37, 3
    s_add_u32 s40, s40, s41
    s_add_u32 s40, s40, 0xb40020
    v_mov_b32 v22, s32
    v_mov_b32 v23, s33
    s_waitcnt vmcnt(1)
    s_mov_b64 exec, 1
    buffer_store_dwordx2 v[22:23], off, s[12:15], s40 sc1
    s_mov_b64 exec, -1
    v_lshlrev_b32 v1, 4, v0
    s_setprio 3
    s_nop 0
    s_branch L_attH
L_cs_30:
    s_mov_b32 s47, 1048576
L_cs_30l:
    ds_read_b32 v5, v4 offset:236
    s_waitcnt lgkmcnt(0)
    v_cmp_ne_u32 vcc, 0x9e000, v5
    s_cbranch_vccz L_cb_31
    s_sub_u32 s47, s47, 1
    s_cmp_lg_u32 s47, 0
    s_cbranch_scc1 L_cs_30l
    s_branch L_cb_31
L_cs_34:
    s_mov_b32 s47, 1048576
L_cs_34l:
    ds_read_b32 v5, v4 offset:240
    s_waitcnt lgkmcnt(0)
    v_cmp_ne_u32 vcc, 0x9e000, v5
    s_cbranch_vccz L_cb_35
    s_sub_u32 s47, s47, 1
    s_cmp_lg_u32 s47, 0
    s_cbranch_scc1 L_cs_34l
    s_branch L_cb_35
L_cs_37:
    s_mov_b32 s47, 1048576
L_cs_37l:
    ds_read_b32 v5, v4 offset:244
    s_waitcnt lgkmcnt(0)
    v_cmp_ne_u32 vcc, 0x9e000, v5
    s_cbranch_vccz L_cb_38
    s_sub_u32 s47, s47, 1
    s_cmp_lg_u32 s47, 0
    s_cbranch_scc1 L_cs_37l
    s_branch L_cb_38
L_cs_39:
    s_mov_b32 s47, 1048576
L_cs_39l:
    ds_read_b32 v5, v4 offset:248
    s_waitcnt lgkmcnt(0)
    v_cmp_ne_u32 vcc, 0x9e000, v5
    s_cbranch_vccz L_cb_40
    s_sub_u32 s47, s47, 1
    s_cmp_lg_u32 s47, 0
    s_cbranch_scc1 L_cs_39l
    s_branch L_cb_40
L_cs_41:
    s_mov_b32 s47, 1048576
L_cs_41l:
    ds_read_b32 v5, v4 offset:176
    s_waitcnt lgkmcnt(0)
    v_cmp_ne_u32 vcc, 0x9e000, v5
    s_cbranch_vccz L_cb_42
    s_sub_u32 s47, s47, 1
    s_cmp_lg_u32 s47, 0
    s_cbranch_scc1 L_cs_41l
    s_branch L_cb_42
.p2align 6
L_compute:
    s_getpc_b64 s[76:77]
L_pc:
    s_sub_u32 s76, s76, L_pc-concat_heads__linear_kernel_hedgehog__sliding_block__prompt_kernel
    s_subb_u32 s77, s77, 0
    s_lshr_b32 s40, s2, 3
    s_lshl_b32 s40, s40, 2
    s_add_u32 s40, s40, s31
    s_and_b32 s40, s40, 7
    s_lshl_b32 s40, s40, 13
    v_lshl_add_u32 v20, v0, 7, s40
    v_min_u32 v20, L_end-concat_heads__linear_kernel_hedgehog__sliding_block__prompt_kernel, v20
    global_load_dword v255, v20, s[76:77]
L_nocpf:
    v_lshlrev_b32 v8, 6, v0
    s_lshl_b32 s40, s31, 4
    s_add_u32 s40, s40, 161792
    v_add_u32 v8, s40, v8
    v_mov_b32 v14, 0
    v_mov_b32 v15, 0
    s_cmp_eq_u32 s31, 0
    s_cselect_b32 s78, -1, 0x01010101
    s_cmp_eq_u32 s31, 3
    s_cselect_b32 s78, 0, s78
    s_mov_b32 s79, 0
    s_cmp_lt_u32 s29, s31
    s_cselect_b32 s41, 0x7180, 0
    v_mov_b32 v10, 0x3f803f80
    v_mov_b32 v11, s41
    v_cndmask_b32 v12, 0, v10, s[78:79]
    v_cndmask_b32 v13, 0, v11, s[78:79]
    s_mov_b32 exec_hi, 0
    ds_write_b128 v8, v[12:15]
    s_mov_b32 exec_hi, -1
    s_or_b32 s40, s2, s31
    s_cbranch_scc1 L_nononce1
    s_memrealtime s[72:73]
    s_waitcnt lgkmcnt(0)
    s_mov_b32 s24, s64
    s_mov_b32 s25, s65
    s_mov_b32 s26, 256
    s_mov_b32 s27, 0x00020000
    s_or_b32 s72, s72, 1
    v_mov_b32 v16, s72
    v_mov_b32 v17, s73
    s_mov_b64 exec, 1
    buffer_store_dwordx2 v[16:17], off, s[24:27], 0 sc1
    s_mov_b64 exec, -1
L_nononce1:
    v_lshrrev_b32 v8, 2, v0
    v_mul_u32_u24 v8, 160, v8
    v_and_b32 v9, 3, v0
    v_mad_u32_u24 v6, v9, 40, v8
    v_add_u32 v1, 45056, v6
    v_and_b32 v8, 15, v0
    v_lshrrev_b32 v9, 4, v0
    v_bfe_u32 v10, v0, 1, 3
    v_xor_b32 v10, v9, v10
    s_lshl_b32 s40, s31, 12
    s_add_u32 s40, s40, 40960
    v_lshl_add_u32 v11, v8, 7, s40
    v_lshl_add_u32 v2, v10, 4, v11
    v_xor_b32 v3, 64, v2
    v_mov_b32 v4, 161792
    s_lshl_b32 s40, s31, 9
    s_add_u32 s40, s40, 110592
    v_lshl_add_u32 v8, v8, 4, s40
    s_mov_b32 s36, 10752
    s_cmp_lg_u32 s28, 0
    s_cbranch_scc1 L_initB
    s_mov_b32 s36, 11584
    v_lshlrev_b32 v10, 4, v0
    s_lshl_b32 s40, s30, 2
    s_add_u32 s40, s40, s31
    s_mul_i32 s40, s40, 800
    s_mul_i32 s41, s31, 960
    s_add_u32 m0, s41, 156928
    v_add_u32 v11, 160768, v10
    v_mov_b32 v12, 0
    v_mov_b32 v13, 0
    s_mov_b32 exec_hi, 0x7fffff
    ds_write_b128 v11, v[12:15]
    s_waitcnt lgkmcnt(0)
    s_mov_b32 s4, s52
    s_mov_b32 s5, s53
    s_mov_b32 s6, 25600
    s_mov_b32 s7, 0x00020000
    s_mov_b32 exec_hi, 0x3ffff
    buffer_load_dwordx4 v10, s[4:7], s40 offen lds
    s_mov_b32 exec_hi, -1
    s_branch L_initJ
L_initB:
    s_mul_i32 s40, s31, 576
    s_add_u32 s40, s40, 153600
    v_lshl_add_u32 v11, v0, 3, s40
    s_sub_u32 s41, s31, 32
    v_lshl_add_u32 v12, v0, 1, s41
    v_add_u32 v13, 1, v12
    v_mov_b32 v14, 0xf149f2ca
    v_cmp_gt_u32 vcc, 64, v12
    s_nop 1
    v_cndmask_b32 v12, v14, 0, vcc
    v_cmp_gt_u32 vcc, 64, v13
    s_nop 1
    v_cndmask_b32 v13, v14, 0, vcc
    ds_write_b64 v11, v[12:13]
L_initJ:
    v_mad_u32_u24 v7, v9, s36, v8
    s_waitcnt lgkmcnt(0)
    s_barrier
    ds_read_b32 v5, v4 offset:80
    s_waitcnt lgkmcnt(0)
    v_cmp_ne_u32 vcc, 0x9e000, v5
    s_cbranch_vccnz L_cs_43
L_cb_44:
    ds_read_b128 v[96:99], v2 offset:16384
    ds_read_b128 v[100:103], v2 offset:18432
    ds_read_b64_tr_b16 v[8:9], v1 offset:55296
    ds_read_b64_tr_b16 v[10:11], v1 offset:57856
    ds_read_b64_tr_b16 v[12:13], v1 offset:55304
    ds_read_b64_tr_b16 v[14:15], v1 offset:57864
    ds_read_b64_tr_b16 v[112:113], v1 offset:55312
    ds_read_b64_tr_b16 v[114:115], v1 offset:57872
    ds_read_b64_tr_b16 v[116:117], v1 offset:55320
    ds_read_b64_tr_b16 v[118:119], v1 offset:57880
    ds_read_b64_tr_b16 v[120:121], v1 offset:55328
    s_waitcnt lgkmcnt(9)
    s_waitcnt lgkmcnt(7)
    v_mfma_f32_16x16x32_bf16 v[16:19], v[8:11], v[96:99], 0
    ds_read_b64_tr_b16 v[122:123], v1 offset:57888
    v_mfma_f32_16x16x32_bf16 v[36:39], v[8:11], v[100:103], 0
    ds_read_b128 v[104:107], v3 offset:16384
    ds_read_b128 v[108:111], v3 offset:18432
    ds_read_b64_tr_b16 v[124:125], v1 offset:60416
    s_waitcnt lgkmcnt(9)
    v_mfma_f32_16x16x32_bf16 v[20:23], v[12:15], v[96:99], 0
    ds_read_b64_tr_b16 v[126:127], v1 offset:62976
    v_mfma_f32_16x16x32_bf16 v[40:43], v[12:15], v[100:103], 0
    ds_read_b64_tr_b16 v[8:9], v1 offset:60424
    s_waitcnt lgkmcnt(9)
    v_mfma_f32_16x16x32_bf16 v[24:27], v[112:115], v[96:99], 0
    ds_read_b64_tr_b16 v[10:11], v1 offset:62984
    v_mfma_f32_16x16x32_bf16 v[44:47], v[112:115], v[100:103], 0
    ds_read_b64_tr_b16 v[12:13], v1 offset:60432
    s_waitcnt lgkmcnt(9)
    v_mfma_f32_16x16x32_bf16 v[28:31], v[116:119], v[96:99], 0
    ds_read_b64_tr_b16 v[14:15], v1 offset:62992
    v_mfma_f32_16x16x32_bf16 v[48:51], v[116:119], v[100:103], 0
    ds_read_b64_tr_b16 v[112:113], v1 offset:60440
    s_waitcnt lgkmcnt(9)
    v_mfma_f32_16x16x32_bf16 v[32:35], v[120:123], v[96:99], 0
    ds_read_b64_tr_b16 v[114:115], v1 offset:63000
    v_mfma_f32_16x16x32_bf16 v[52:55], v[120:123], v[100:103], 0
    ds_read_b64_tr_b16 v[116:117], v1 offset:60448
    s_waitcnt lgkmcnt(7)
    v_mfma_f32_16x16x32_bf16 v[56:59], v[124:127], v[96:99], 0
    ds_read_b64_tr_b16 v[118:119], v1 offset:63008
    v_mfma_f32_16x16x32_bf16 v[76:79], v[124:127], v[100:103], 0
    s_mov_b64 exec, 1
    ds_add_u32 v4, v4 offset:208
    s_mov_b64 exec, -1
    ds_read_b32 v5, v4 offset:84
    s_waitcnt lgkmcnt(0)
    v_cmp_ne_u32 vcc, 0x9e000, v5
    s_cbranch_vccnz L_cs_45
L_cb_46:
    ds_read_b64_tr_b16 v[120:121], v1 offset:45056
    v_mfma_f32_16x16x32_bf16 v[60:63], v[8:11], v[96:99], 0
    ds_read_b64_tr_b16 v[122:123], v1 offset:47616
    v_mfma_f32_16x16x32_bf16 v[80:83], v[8:11], v[100:103], 0
    ds_read_b64_tr_b16 v[124:125], v1 offset:45064
    v_mfma_f32_16x16x32_bf16 v[64:67], v[12:15], v[96:99], 0
    ds_read_b64_tr_b16 v[126:127], v1 offset:47624
    v_mfma_f32_16x16x32_bf16 v[84:87], v[12:15], v[100:103], 0
    ds_read_b64_tr_b16 v[8:9], v1 offset:45072
    v_mfma_f32_16x16x32_bf16 v[68:71], v[112:115], v[96:99], 0
    ds_read_b64_tr_b16 v[10:11], v1 offset:47632
    v_mfma_f32_16x16x32_bf16 v[88:91], v[112:115], v[100:103], 0
    ds_read_b64_tr_b16 v[12:13], v1 offset:45080
    v_mfma_f32_16x16x32_bf16 v[72:75], v[116:119], v[96:99], 0
    ds_read_b64_tr_b16 v[14:15], v1 offset:47640
    v_mfma_f32_16x16x32_bf16 v[92:95], v[116:119], v[100:103], 0
    ds_read_b64_tr_b16 v[112:113], v1 offset:45088
    s_waitcnt lgkmcnt(7)
    v_mfma_f32_16x16x32_bf16 v[16:19], v[120:123], v[104:107], v[16:19]
    ds_read_b64_tr_b16 v[114:115], v1 offset:47648
    v_mfma_f32_16x16x32_bf16 v[36:39], v[120:123], v[108:111], v[36:39]
    ds_read_b64_tr_b16 v[128:129], v1 offset:50176
    s_waitcnt lgkmcnt(7)
    v_mfma_f32_16x16x32_bf16 v[20:23], v[124:127], v[104:107], v[20:23]
    ds_read_b64_tr_b16 v[130:131], v1 offset:52736
    v_mfma_f32_16x16x32_bf16 v[40:43], v[124:127], v[108:111], v[40:43]
    ds_read_b64_tr_b16 v[120:121], v1 offset:50184
    s_waitcnt lgkmcnt(7)
    v_mfma_f32_16x16x32_bf16 v[24:27], v[8:11], v[104:107], v[24:27]
    ds_read_b64_tr_b16 v[122:123], v1 offset:52744
    v_mfma_f32_16x16x32_bf16 v[44:47], v[8:11], v[108:111], v[44:47]
    ds_read_b64_tr_b16 v[124:125], v1 offset:50192
    s_waitcnt lgkmcnt(7)
    v_mfma_f32_16x16x32_bf16 v[28:31], v[12:15], v[104:107], v[28:31]
    ds_read_b64_tr_b16 v[126:127], v1 offset:52752
    v_mfma_f32_16x16x32_bf16 v[48:51], v[12:15], v[108:111], v[48:51]
    ds_read_b64_tr_b16 v[8:9], v1 offset:50200
    s_waitcnt lgkmcnt(7)
    v_mfma_f32_16x16x32_bf16 v[32:35], v[112:115], v[104:107], v[32:35]
    ds_read_b64_tr_b16 v[10:11], v1 offset:52760
    v_mfma_f32_16x16x32_bf16 v[52:55], v[112:115], v[108:111], v[52:55]
    ds_read_b64_tr_b16 v[12:13], v1 offset:50208
    s_waitcnt lgkmcnt(7)
    v_mfma_f32_16x16x32_bf16 v[56:59], v[128:131], v[104:107], v[56:59]
    ds_read_b64_tr_b16 v[14:15], v1 offset:52768
    v_mfma_f32_16x16x32_bf16 v[76:79], v[128:131], v[108:111], v[76:79]
    ds_read_b128 v[112:115], v2 offset:0
    ds_read_b128 v[116:119], v2 offset:2048
    ds_read_b64_tr_b16 v[132:133], v6 offset:0
    s_waitcnt lgkmcnt(9)
    v_mfma_f32_16x16x32_bf16 v[60:63], v[120:123], v[104:107], v[60:63]
    ds_read_b64_tr_b16 v[134:135], v6 offset:2560
    v_mfma_f32_16x16x32_bf16 v[80:83], v[120:123], v[108:111], v[80:83]
    ds_read_b64_tr_b16 v[128:129], v6 offset:8
    s_waitcnt lgkmcnt(9)
    v_mfma_f32_16x16x32_bf16 v[64:67], v[124:127], v[104:107], v[64:67]
    ds_read_b64_tr_b16 v[130:131], v6 offset:2568
    v_mfma_f32_16x16x32_bf16 v[84:87], v[124:127], v[108:111], v[84:87]
    ds_read_b64_tr_b16 v[136:137], v6 offset:16
    s_waitcnt lgkmcnt(9)
    v_mfma_f32_16x16x32_bf16 v[68:71], v[8:11], v[104:107], v[68:71]
    ds_read_b64_tr_b16 v[138:139], v6 offset:2576
    v_mfma_f32_16x16x32_bf16 v[88:91], v[8:11], v[108:111], v[88:91]
    ds_read_b64_tr_b16 v[140:141], v6 offset:24
    s_waitcnt lgkmcnt(9)
    v_mfma_f32_16x16x32_bf16 v[72:75], v[12:15], v[104:107], v[72:75]
    ds_read_b64_tr_b16 v[142:143], v6 offset:2584
    v_mfma_f32_16x16x32_bf16 v[92:95], v[12:15], v[108:111], v[92:95]
    ds_read_b64_tr_b16 v[8:9], v6 offset:32
    s_waitcnt lgkmcnt(9)
    s_waitcnt lgkmcnt(7)
    v_mfma_f32_16x16x32_bf16 v[16:19], v[132:135], v[112:115], v[16:19]
    ds_read_b64_tr_b16 v[10:11], v6 offset:2592
    v_mfma_f32_16x16x32_bf16 v[36:39], v[132:135], v[116:119], v[36:39]
    ds_read_b128 v[120:123], v3 offset:0
    ds_read_b128 v[124:127], v3 offset:2048
    ds_read_b64_tr_b16 v[12:13], v6 offset:5120
    s_waitcnt lgkmcnt(9)
    v_mfma_f32_16x16x32_bf16 v[20:23], v[128:131], v[112:115], v[20:23]
    ds_read_b64_tr_b16 v[14:15], v6 offset:7680
    v_mfma_f32_16x16x32_bf16 v[40:43], v[128:131], v[116:119], v[40:43]
    ds_read_b64_tr_b16 v[132:133], v6 offset:5128
    s_waitcnt lgkmcnt(9)
    v_mfma_f32_16x16x32_bf16 v[24:27], v[136:139], v[112:115], v[24:27]
    ds_read_b64_tr_b16 v[134:135], v6 offset:7688
    v_mfma_f32_16x16x32_bf16 v[44:47], v[136:139], v[116:119], v[44:47]
    ds_read_b64_tr_b16 v[128:129], v6 offset:5136
    s_waitcnt lgkmcnt(9)
    v_mfma_f32_16x16x32_bf16 v[28:31], v[140:143], v[112:115], v[28:31]
    ds_read_b64_tr_b16 v[130:131], v6 offset:7696
    v_mfma_f32_16x16x32_bf16 v[48:51], v[140:143], v[116:119], v[48:51]
    ds_read_b64_tr_b16 v[136:137], v6 offset:5144
    s_waitcnt lgkmcnt(9)
    v_mfma_f32_16x16x32_bf16 v[32:35], v[8:11], v[112:115], v[32:35]
    ds_read_b64_tr_b16 v[138:139], v6 offset:7704
    v_mfma_f32_16x16x32_bf16 v[52:55], v[8:11], v[116:119], v[52:55]
    ds_read_b64_tr_b16 v[140:141], v6 offset:5152
    s_waitcnt lgkmcnt(7)
    v_mfma_f32_16x16x32_bf16 v[56:59], v[12:15], v[112:115], v[56:59]
    ds_read_b64_tr_b16 v[142:143], v6 offset:7712
    v_mfma_f32_16x16x32_bf16 v[76:79], v[12:15], v[116:119], v[76:79]
    s_mov_b64 exec, 1
    ds_add_u32 v4, v4 offset:212
    s_mov_b64 exec, -1
    ds_read_b32 v5, v4 offset:88
    s_waitcnt lgkmcnt(0)
    v_cmp_ne_u32 vcc, 0x9e000, v5
    s_cbranch_vccnz L_cs_47
L_cb_48:
    ds_read_b64_tr_b16 v[8:9], v6 offset:10240
    v_mfma_f32_16x16x32_bf16 v[60:63], v[132:135], v[112:115], v[60:63]
    ds_read_b64_tr_b16 v[10:11], v6 offset:12800
    v_mfma_f32_16x16x32_bf16 v[80:83], v[132:135], v[116:119], v[80:83]
    ds_read_b64_tr_b16 v[12:13], v6 offset:10248
    v_mfma_f32_16x16x32_bf16 v[64:67], v[128:131], v[112:115], v[64:67]
    ds_read_b64_tr_b16 v[14:15], v6 offset:12808
    v_mfma_f32_16x16x32_bf16 v[84:87], v[128:131], v[116:119], v[84:87]
    ds_read_b64_tr_b16 v[132:133], v6 offset:10256
    v_mfma_f32_16x16x32_bf16 v[68:71], v[136:139], v[112:115], v[68:71]
    ds_read_b64_tr_b16 v[134:135], v6 offset:12816
    v_mfma_f32_16x16x32_bf16 v[88:91], v[136:139], v[116:119], v[88:91]
    ds_read_b64_tr_b16 v[128:129], v6 offset:10264
    v_mfma_f32_16x16x32_bf16 v[72:75], v[140:143], v[112:115], v[72:75]
    ds_read_b64_tr_b16 v[130:131], v6 offset:12824
    v_mfma_f32_16x16x32_bf16 v[92:95], v[140:143], v[116:119], v[92:95]
    s_lshl_b32 s39, s28, 4
    s_add_u32 s39, s39, s29
    s_lshl_b32 s35, s39, 3
    s_add_u32 s35, s35, s30
    s_mov_b32 s80, 0
    s_mov_b32 s81, -1
    s_cmp_eq_u32 s28, 0
    s_cselect_b32 s38, 0x358637bd, 0
    s_mov_b32 s12, s66
    s_mov_b32 s13, s67
    s_mov_b32 s14, 0x10000000
    s_mov_b32 s15, 0x00020000
    s_cselect_b32 s16, s54, s60
    s_cselect_b32 s17, s55, s61
    s_mov_b32 s18, 819200
    s_mov_b32 s19, 0x00020000
    s_mov_b32 s20, s62
    s_mov_b32 s21, s63
    s_mov_b32 s22, 5242880
    s_mov_b32 s23, 0x00020000
    s_waitcnt vmcnt(0)
    ds_read_b64_tr_b16 v[136:137], v6 offset:10272
    s_waitcnt lgkmcnt(7)
    v_mfma_f32_16x16x32_bf16 v[16:19], v[8:11], v[120:123], v[16:19]
    ds_read_b64_tr_b16 v[138:139], v6 offset:12832
    v_mfma_f32_16x16x32_bf16 v[36:39], v[8:11], v[124:127], v[36:39]
    ds_read_b64_tr_b16 v[140:141], v6 offset:15360
    s_waitcnt lgkmcnt(7)
    v_mfma_f32_16x16x32_bf16 v[20:23], v[12:15], v[120:123], v[20:23]
    ds_read_b64_tr_b16 v[142:143], v6 offset:17920
    v_mfma_f32_16x16x32_bf16 v[40:43], v[12:15], v[124:127], v[40:43]
    ds_read_b64_tr_b16 v[8:9], v6 offset:15368
    s_waitcnt lgkmcnt(7)
    v_mfma_f32_16x16x32_bf16 v[24:27], v[132:135], v[120:123], v[24:27]
    ds_read_b64_tr_b16 v[10:11], v6 offset:17928
    v_mfma_f32_16x16x32_bf16 v[44:47], v[132:135], v[124:127], v[44:47]
    ds_read_b64_tr_b16 v[12:13], v6 offset:15376
    s_waitcnt lgkmcnt(7)
    v_mfma_f32_16x16x32_bf16 v[28:31], v[128:131], v[120:123], v[28:31]
    ds_read_b64_tr_b16 v[14:15], v6 offset:17936
    v_mfma_f32_16x16x32_bf16 v[48:51], v[128:131], v[124:127], v[48:51]
    ds_read_b64_tr_b16 v[144:145], v6 offset:15384
    s_waitcnt lgkmcnt(7)
    v_mfma_f32_16x16x32_bf16 v[32:35], v[136:139], v[120:123], v[32:35]
    ds_read_b64_tr_b16 v[146:147], v6 offset:17944
    v_mfma_f32_16x16x32_bf16 v[52:55], v[136:139], v[124:127], v[52:55]
    ds_read_b64_tr_b16 v[148:149], v6 offset:15392
    s_waitcnt lgkmcnt(7)
    v_mfma_f32_16x16x32_bf16 v[56:59], v[140:143], v[120:123], v[56:59]
    ds_read_b64_tr_b16 v[150:151], v6 offset:17952
    v_mfma_f32_16x16x32_bf16 v[76:79], v[140:143], v[124:127], v[76:79]
    ds_read_b128 v[128:131], v2 offset:32768
    ds_read_b128 v[132:135], v2 offset:34816
    ds_read_b64_tr_b16 v[152:153], v6 offset:20480
    s_waitcnt lgkmcnt(9)
    v_mfma_f32_16x16x32_bf16 v[60:63], v[8:11], v[120:123], v[60:63]
    ds_read_b64_tr_b16 v[154:155], v6 offset:23040
    v_mfma_f32_16x16x32_bf16 v[80:83], v[8:11], v[124:127], v[80:83]
    ds_read_b64_tr_b16 v[156:157], v6 offset:20488
    s_waitcnt lgkmcnt(9)
    v_mfma_f32_16x16x32_bf16 v[64:67], v[12:15], v[120:123], v[64:67]
    ds_read_b64_tr_b16 v[158:159], v6 offset:23048
    v_mfma_f32_16x16x32_bf16 v[84:87], v[12:15], v[124:127], v[84:87]
    ds_read_b64_tr_b16 v[8:9], v6 offset:20496
    s_waitcnt lgkmcnt(9)
    v_mfma_f32_16x16x32_bf16 v[68:71], v[144:147], v[120:123], v[68:71]
    ds_read_b64_tr_b16 v[10:11], v6 offset:23056
    v_mfma_f32_16x16x32_bf16 v[88:91], v[144:147], v[124:127], v[88:91]
    ds_read_b64_tr_b16 v[12:13], v6 offset:20504
    s_waitcnt lgkmcnt(9)
    v_mfma_f32_16x16x32_bf16 v[72:75], v[148:151], v[120:123], v[72:75]
    ds_read_b64_tr_b16 v[14:15], v6 offset:23064
    v_mfma_f32_16x16x32_bf16 v[92:95], v[148:151], v[124:127], v[92:95]
    ds_read_b64_tr_b16 v[144:145], v6 offset:20512
    s_waitcnt lgkmcnt(9)
    s_waitcnt lgkmcnt(7)
    v_mfma_f32_16x16x32_bf16 v[16:19], v[152:155], v[128:131], v[16:19]
    ds_read_b64_tr_b16 v[146:147], v6 offset:23072
    v_mfma_f32_16x16x32_bf16 v[36:39], v[152:155], v[132:135], v[36:39]
    ds_read_b128 v[136:139], v3 offset:32768
    ds_read_b128 v[140:143], v3 offset:34816
    ds_read_b64_tr_b16 v[148:149], v6 offset:25600
    s_waitcnt lgkmcnt(9)
    v_mfma_f32_16x16x32_bf16 v[20:23], v[156:159], v[128:131], v[20:23]
    ds_read_b64_tr_b16 v[150:151], v6 offset:28160
    v_mfma_f32_16x16x32_bf16 v[40:43], v[156:159], v[132:135], v[40:43]
    ds_read_b64_tr_b16 v[152:153], v6 offset:25608
    s_waitcnt lgkmcnt(9)
    v_mfma_f32_16x16x32_bf16 v[24:27], v[8:11], v[128:131], v[24:27]
    ds_read_b64_tr_b16 v[154:155], v6 offset:28168
    v_mfma_f32_16x16x32_bf16 v[44:47], v[8:11], v[132:135], v[44:47]
    ds_read_b64_tr_b16 v[156:157], v6 offset:25616
    s_waitcnt lgkmcnt(9)
    v_mfma_f32_16x16x32_bf16 v[28:31], v[12:15], v[128:131], v[28:31]
    ds_read_b64_tr_b16 v[158:159], v6 offset:28176
    v_mfma_f32_16x16x32_bf16 v[48:51], v[12:15], v[132:135], v[48:51]
    ds_read_b64_tr_b16 v[8:9], v6 offset:25624
    s_waitcnt lgkmcnt(9)
    v_mfma_f32_16x16x32_bf16 v[32:35], v[144:147], v[128:131], v[32:35]
    ds_read_b64_tr_b16 v[10:11], v6 offset:28184
    v_mfma_f32_16x16x32_bf16 v[52:55], v[144:147], v[132:135], v[52:55]
    ds_read_b64_tr_b16 v[12:13], v6 offset:25632
    s_waitcnt lgkmcnt(7)
    v_mfma_f32_16x16x32_bf16 v[56:59], v[148:151], v[128:131], v[56:59]
    ds_read_b64_tr_b16 v[14:15], v6 offset:28192
    v_mfma_f32_16x16x32_bf16 v[76:79], v[148:151], v[132:135], v[76:79]
    s_mov_b64 exec, 1
    ds_add_u32 v4, v4 offset:216
    s_mov_b64 exec, -1
    ds_read_b32 v5, v4 offset:92
    s_waitcnt lgkmcnt(0)
    v_cmp_ne_u32 vcc, 0x9e000, v5
    s_cbranch_vccnz L_cs_49
L_cb_50:
    ds_read_b64_tr_b16 v[144:145], v6 offset:30720
    v_mfma_f32_16x16x32_bf16 v[60:63], v[152:155], v[128:131], v[60:63]
    ds_read_b64_tr_b16 v[146:147], v6 offset:33280
    v_mfma_f32_16x16x32_bf16 v[80:83], v[152:155], v[132:135], v[80:83]
    ds_read_b64_tr_b16 v[148:149], v6 offset:30728
    v_mfma_f32_16x16x32_bf16 v[64:67], v[156:159], v[128:131], v[64:67]
    ds_read_b64_tr_b16 v[150:151], v6 offset:33288
    v_mfma_f32_16x16x32_bf16 v[84:87], v[156:159], v[132:135], v[84:87]
    ds_read_b64_tr_b16 v[152:153], v6 offset:30736
    v_mfma_f32_16x16x32_bf16 v[68:71], v[8:11], v[128:131], v[68:71]
    ds_read_b64_tr_b16 v[154:155], v6 offset:33296
    v_mfma_f32_16x16x32_bf16 v[88:91], v[8:11], v[132:135], v[88:91]
    ds_read_b64_tr_b16 v[156:157], v6 offset:30744
    v_mfma_f32_16x16x32_bf16 v[72:75], v[12:15], v[128:131], v[72:75]
    ds_read_b64_tr_b16 v[158:159], v6 offset:33304
    v_mfma_f32_16x16x32_bf16 v[92:95], v[12:15], v[132:135], v[92:95]
    ds_read_b64_tr_b16 v[8:9], v6 offset:30752
    s_waitcnt lgkmcnt(7)
    v_mfma_f32_16x16x32_bf16 v[16:19], v[144:147], v[136:139], v[16:19]
    ds_read_b64_tr_b16 v[10:11], v6 offset:33312
    v_mfma_f32_16x16x32_bf16 v[36:39], v[144:147], v[140:143], v[36:39]
    ds_read_b64_tr_b16 v[12:13], v6 offset:35840
    s_waitcnt lgkmcnt(7)
    v_mfma_f32_16x16x32_bf16 v[20:23], v[148:151], v[136:139], v[20:23]
    ds_read_b64_tr_b16 v[14:15], v6 offset:38400
    v_mfma_f32_16x16x32_bf16 v[40:43], v[148:151], v[140:143], v[40:43]
    ds_read_b64_tr_b16 v[160:161], v6 offset:35848
    s_waitcnt lgkmcnt(7)
    v_mfma_f32_16x16x32_bf16 v[24:27], v[152:155], v[136:139], v[24:27]
    ds_read_b64_tr_b16 v[162:163], v6 offset:38408
    v_mfma_f32_16x16x32_bf16 v[44:47], v[152:155], v[140:143], v[44:47]
    ds_read_b64_tr_b16 v[164:165], v6 offset:35856
    s_waitcnt lgkmcnt(7)
    v_mfma_f32_16x16x32_bf16 v[28:31], v[156:159], v[136:139], v[28:31]
    ds_read_b64_tr_b16 v[166:167], v6 offset:38416
    v_mfma_f32_16x16x32_bf16 v[48:51], v[156:159], v[140:143], v[48:51]
    ds_read_b64_tr_b16 v[152:153], v6 offset:35864
    s_waitcnt lgkmcnt(7)
    v_mfma_f32_16x16x32_bf16 v[32:35], v[8:11], v[136:139], v[32:35]
    ds_read_b64_tr_b16 v[154:155], v6 offset:38424
    v_mfma_f32_16x16x32_bf16 v[52:55], v[8:11], v[140:143], v[52:55]
    ds_read_b64_tr_b16 v[156:157], v6 offset:35872
    s_waitcnt lgkmcnt(7)
    v_mfma_f32_16x16x32_bf16 v[56:59], v[12:15], v[136:139], v[56:59]
    ds_read_b64_tr_b16 v[158:159], v6 offset:38432
    v_mfma_f32_16x16x32_bf16 v[76:79], v[12:15], v[140:143], v[76:79]
    ds_read_b128 v[144:147], v2 offset:16384
    ds_read_b128 v[148:151], v2 offset:18432
    ds_read_b64_tr_b16 v[8:9], v1 offset:55296
    s_waitcnt lgkmcnt(9)
    v_mfma_f32_16x16x32_bf16 v[60:63], v[160:163], v[136:139], v[60:63]
    ds_read_b64_tr_b16 v[10:11], v1 offset:57856
    v_mfma_f32_16x16x32_bf16 v[80:83], v[160:163], v[140:143], v[80:83]
    ds_read_b64_tr_b16 v[12:13], v1 offset:55304
    s_waitcnt lgkmcnt(9)
    v_mfma_f32_16x16x32_bf16 v[64:67], v[164:167], v[136:139], v[64:67]
    ds_read_b64_tr_b16 v[14:15], v1 offset:57864
    v_mfma_f32_16x16x32_bf16 v[84:87], v[164:167], v[140:143], v[84:87]
    ds_read_b64_tr_b16 v[160:161], v1 offset:55312
    s_waitcnt lgkmcnt(9)
    v_mfma_f32_16x16x32_bf16 v[68:71], v[152:155], v[136:139], v[68:71]
    ds_read_b64_tr_b16 v[162:163], v1 offset:57872
    v_mfma_f32_16x16x32_bf16 v[88:91], v[152:155], v[140:143], v[88:91]
    ds_read_b64_tr_b16 v[164:165], v1 offset:55320
    s_waitcnt lgkmcnt(9)
    v_mfma_f32_16x16x32_bf16 v[72:75], v[156:159], v[136:139], v[72:75]
    ds_read_b64_tr_b16 v[166:167], v1 offset:57880
    v_mfma_f32_16x16x32_bf16 v[92:95], v[156:159], v[140:143], v[92:95]
    ds_read_b64_tr_b16 v[168:169], v1 offset:55328
    s_waitcnt lgkmcnt(9)
    s_waitcnt lgkmcnt(7)
    v_mfma_f32_16x16x32_bf16 v[16:19], v[8:11], v[144:147], v[16:19]
    ds_read_b64_tr_b16 v[170:171], v1 offset:57888
    v_mfma_f32_16x16x32_bf16 v[36:39], v[8:11], v[148:151], v[36:39]
    ds_read_b128 v[152:155], v3 offset:16384
    ds_read_b128 v[156:159], v3 offset:18432
    ds_read_b64_tr_b16 v[172:173], v1 offset:60416
    s_waitcnt lgkmcnt(9)
    v_mfma_f32_16x16x32_bf16 v[20:23], v[12:15], v[144:147], v[20:23]
    ds_read_b64_tr_b16 v[174:175], v1 offset:62976
    v_mfma_f32_16x16x32_bf16 v[40:43], v[12:15], v[148:151], v[40:43]
    ds_read_b64_tr_b16 v[8:9], v1 offset:60424
    s_waitcnt lgkmcnt(9)
    v_mfma_f32_16x16x32_bf16 v[24:27], v[160:163], v[144:147], v[24:27]
    ds_read_b64_tr_b16 v[10:11], v1 offset:62984
    v_mfma_f32_16x16x32_bf16 v[44:47], v[160:163], v[148:151], v[44:47]
    ds_read_b64_tr_b16 v[12:13], v1 offset:60432
    s_waitcnt lgkmcnt(9)
    v_mfma_f32_16x16x32_bf16 v[28:31], v[164:167], v[144:147], v[28:31]
    ds_read_b64_tr_b16 v[14:15], v1 offset:62992
    v_mfma_f32_16x16x32_bf16 v[48:51], v[164:167], v[148:151], v[48:51]
    ds_read_b64_tr_b16 v[160:161], v1 offset:60440
    s_waitcnt lgkmcnt(9)
    v_mfma_f32_16x16x32_bf16 v[32:35], v[168:171], v[144:147], v[32:35]
    ds_read_b64_tr_b16 v[162:163], v1 offset:63000
    v_mfma_f32_16x16x32_bf16 v[52:55], v[168:171], v[148:151], v[52:55]
    ds_read_b64_tr_b16 v[164:165], v1 offset:60448
    s_waitcnt lgkmcnt(7)
    v_mfma_f32_16x16x32_bf16 v[56:59], v[172:175], v[144:147], v[56:59]
    ds_read_b64_tr_b16 v[166:167], v1 offset:63008
    v_mfma_f32_16x16x32_bf16 v[76:79], v[172:175], v[148:151], v[76:79]
    s_mov_b64 exec, 1
    ds_add_u32 v4, v4 offset:220
    s_mov_b64 exec, -1
    ds_read_b32 v5, v4 offset:96
    s_waitcnt lgkmcnt(0)
    v_cmp_ne_u32 vcc, 0x9e000, v5
    s_cbranch_vccnz L_cs_51
L_cb_52:
    ds_read_b64_tr_b16 v[168:169], v1 offset:45056
    v_mfma_f32_16x16x32_bf16 v[60:63], v[8:11], v[144:147], v[60:63]
    ds_read_b64_tr_b16 v[170:171], v1 offset:47616
    v_mfma_f32_16x16x32_bf16 v[80:83], v[8:11], v[148:151], v[80:83]
    ds_read_b64_tr_b16 v[172:173], v1 offset:45064
    v_mfma_f32_16x16x32_bf16 v[64:67], v[12:15], v[144:147], v[64:67]
    ds_read_b64_tr_b16 v[174:175], v1 offset:47624
    v_mfma_f32_16x16x32_bf16 v[84:87], v[12:15], v[148:151], v[84:87]
    ds_read_b64_tr_b16 v[8:9], v1 offset:45072
    v_mfma_f32_16x16x32_bf16 v[68:71], v[160:163], v[144:147], v[68:71]
    ds_read_b64_tr_b16 v[10:11], v1 offset:47632
    v_mfma_f32_16x16x32_bf16 v[88:91], v[160:163], v[148:151], v[88:91]
    ds_read_b64_tr_b16 v[12:13], v1 offset:45080
    v_mfma_f32_16x16x32_bf16 v[72:75], v[164:167], v[144:147], v[72:75]
    ds_read_b64_tr_b16 v[14:15], v1 offset:47640
    v_mfma_f32_16x16x32_bf16 v[92:95], v[164:167], v[148:151], v[92:95]
    ds_read_b64_tr_b16 v[160:161], v1 offset:45088
    s_waitcnt lgkmcnt(7)
    v_mfma_f32_16x16x32_bf16 v[16:19], v[168:171], v[152:155], v[16:19]
    ds_read_b64_tr_b16 v[162:163], v1 offset:47648
    v_mfma_f32_16x16x32_bf16 v[36:39], v[168:171], v[156:159], v[36:39]
    ds_read_b64_tr_b16 v[176:177], v1 offset:50176
    s_waitcnt lgkmcnt(7)
    v_mfma_f32_16x16x32_bf16 v[20:23], v[172:175], v[152:155], v[20:23]
    ds_read_b64_tr_b16 v[178:179], v1 offset:52736
    v_mfma_f32_16x16x32_bf16 v[40:43], v[172:175], v[156:159], v[40:43]
    ds_read_b64_tr_b16 v[168:169], v1 offset:50184
    s_waitcnt lgkmcnt(7)
    v_mfma_f32_16x16x32_bf16 v[24:27], v[8:11], v[152:155], v[24:27]
    ds_read_b64_tr_b16 v[170:171], v1 offset:52744
    v_mfma_f32_16x16x32_bf16 v[44:47], v[8:11], v[156:159], v[44:47]
    ds_read_b64_tr_b16 v[172:173], v1 offset:50192
    s_waitcnt lgkmcnt(7)
    v_mfma_f32_16x16x32_bf16 v[28:31], v[12:15], v[152:155], v[28:31]
    ds_read_b64_tr_b16 v[174:175], v1 offset:52752
    v_mfma_f32_16x16x32_bf16 v[48:51], v[12:15], v[156:159], v[48:51]
    ds_read_b64_tr_b16 v[8:9], v1 offset:50200
    s_waitcnt lgkmcnt(7)
    v_mfma_f32_16x16x32_bf16 v[32:35], v[160:163], v[152:155], v[32:35]
    ds_read_b64_tr_b16 v[10:11], v1 offset:52760
    v_mfma_f32_16x16x32_bf16 v[52:55], v[160:163], v[156:159], v[52:55]
    ds_read_b64_tr_b16 v[12:13], v1 offset:50208
    s_waitcnt lgkmcnt(7)
    v_mfma_f32_16x16x32_bf16 v[56:59], v[176:179], v[152:155], v[56:59]
    ds_read_b64_tr_b16 v[14:15], v1 offset:52768
    v_mfma_f32_16x16x32_bf16 v[76:79], v[176:179], v[156:159], v[76:79]
    ds_read_b128 v[160:163], v2 offset:0
    ds_read_b128 v[164:167], v2 offset:2048
    ds_read_b64_tr_b16 v[180:181], v6 offset:0
    s_waitcnt lgkmcnt(9)
    v_mfma_f32_16x16x32_bf16 v[60:63], v[168:171], v[152:155], v[60:63]
    ds_read_b64_tr_b16 v[182:183], v6 offset:2560
    v_mfma_f32_16x16x32_bf16 v[80:83], v[168:171], v[156:159], v[80:83]
    ds_read_b64_tr_b16 v[176:177], v6 offset:8
    s_waitcnt lgkmcnt(9)
    v_mfma_f32_16x16x32_bf16 v[64:67], v[172:175], v[152:155], v[64:67]
    ds_read_b64_tr_b16 v[178:179], v6 offset:2568
    v_mfma_f32_16x16x32_bf16 v[84:87], v[172:175], v[156:159], v[84:87]
    ds_read_b64_tr_b16 v[184:185], v6 offset:16
    s_waitcnt lgkmcnt(9)
    v_mfma_f32_16x16x32_bf16 v[68:71], v[8:11], v[152:155], v[68:71]
    ds_read_b64_tr_b16 v[186:187], v6 offset:2576
    v_mfma_f32_16x16x32_bf16 v[88:91], v[8:11], v[156:159], v[88:91]
    ds_read_b64_tr_b16 v[188:189], v6 offset:24
    s_waitcnt lgkmcnt(9)
    v_mfma_f32_16x16x32_bf16 v[72:75], v[12:15], v[152:155], v[72:75]
    ds_read_b64_tr_b16 v[190:191], v6 offset:2584
    v_mfma_f32_16x16x32_bf16 v[92:95], v[12:15], v[156:159], v[92:95]
    ds_read_b64_tr_b16 v[8:9], v6 offset:32
    s_waitcnt lgkmcnt(9)
    s_waitcnt lgkmcnt(7)
    v_mfma_f32_16x16x32_bf16 v[16:19], v[180:183], v[160:163], v[16:19]
    ds_read_b64_tr_b16 v[10:11], v6 offset:2592
    v_mfma_f32_16x16x32_bf16 v[36:39], v[180:183], v[164:167], v[36:39]
    ds_read_b128 v[168:171], v3 offset:0
    ds_read_b128 v[172:175], v3 offset:2048
    ds_read_b64_tr_b16 v[12:13], v6 offset:5120
    s_waitcnt lgkmcnt(9)
    v_mfma_f32_16x16x32_bf16 v[20:23], v[176:179], v[160:163], v[20:23]
    ds_read_b64_tr_b16 v[14:15], v6 offset:7680
    v_mfma_f32_16x16x32_bf16 v[40:43], v[176:179], v[164:167], v[40:43]
    ds_read_b64_tr_b16 v[180:181], v6 offset:5128
    s_waitcnt lgkmcnt(9)
    v_mfma_f32_16x16x32_bf16 v[24:27], v[184:187], v[160:163], v[24:27]
    ds_read_b64_tr_b16 v[182:183], v6 offset:7688
    v_mfma_f32_16x16x32_bf16 v[44:47], v[184:187], v[164:167], v[44:47]
    ds_read_b64_tr_b16 v[176:177], v6 offset:5136
    s_waitcnt lgkmcnt(9)
    v_mfma_f32_16x16x32_bf16 v[28:31], v[188:191], v[160:163], v[28:31]
    ds_read_b64_tr_b16 v[178:179], v6 offset:7696
    v_mfma_f32_16x16x32_bf16 v[48:51], v[188:191], v[164:167], v[48:51]
    ds_read_b64_tr_b16 v[184:185], v6 offset:5144
    s_waitcnt lgkmcnt(9)
    v_mfma_f32_16x16x32_bf16 v[32:35], v[8:11], v[160:163], v[32:35]
    ds_read_b64_tr_b16 v[186:187], v6 offset:7704
    v_mfma_f32_16x16x32_bf16 v[52:55], v[8:11], v[164:167], v[52:55]
    ds_read_b64_tr_b16 v[188:189], v6 offset:5152
    s_waitcnt lgkmcnt(7)
    v_mfma_f32_16x16x32_bf16 v[56:59], v[12:15], v[160:163], v[56:59]
    ds_read_b64_tr_b16 v[190:191], v6 offset:7712
    v_mfma_f32_16x16x32_bf16 v[76:79], v[12:15], v[164:167], v[76:79]
    s_mov_b64 exec, 1
    ds_add_u32 v4, v4 offset:224
    s_mov_b64 exec, -1
    ds_read_b32 v5, v4 offset:100
    s_waitcnt lgkmcnt(0)
    v_cmp_ne_u32 vcc, 0x9e000, v5
    s_cbranch_vccnz L_cs_53
L_cb_54:
    ds_read_b64_tr_b16 v[8:9], v6 offset:10240
    v_mfma_f32_16x16x32_bf16 v[60:63], v[180:183], v[160:163], v[60:63]
    ds_read_b64_tr_b16 v[10:11], v6 offset:12800
    v_mfma_f32_16x16x32_bf16 v[80:83], v[180:183], v[164:167], v[80:83]
    ds_read_b64_tr_b16 v[12:13], v6 offset:10248
    v_mfma_f32_16x16x32_bf16 v[64:67], v[176:179], v[160:163], v[64:67]
    ds_read_b64_tr_b16 v[14:15], v6 offset:12808
    v_mfma_f32_16x16x32_bf16 v[84:87], v[176:179], v[164:167], v[84:87]
    ds_read_b64_tr_b16 v[180:181], v6 offset:10256
    v_mfma_f32_16x16x32_bf16 v[68:71], v[184:187], v[160:163], v[68:71]
    ds_read_b64_tr_b16 v[182:183], v6 offset:12816
    v_mfma_f32_16x16x32_bf16 v[88:91], v[184:187], v[164:167], v[88:91]
    ds_read_b64_tr_b16 v[176:177], v6 offset:10264
    v_mfma_f32_16x16x32_bf16 v[72:75], v[188:191], v[160:163], v[72:75]
    ds_read_b64_tr_b16 v[178:179], v6 offset:12824
    v_mfma_f32_16x16x32_bf16 v[92:95], v[188:191], v[164:167], v[92:95]
    ds_read_b64_tr_b16 v[184:185], v6 offset:10272
    s_waitcnt lgkmcnt(7)
    v_mfma_f32_16x16x32_bf16 v[16:19], v[8:11], v[168:171], v[16:19]
    ds_read_b64_tr_b16 v[186:187], v6 offset:12832
    v_mfma_f32_16x16x32_bf16 v[36:39], v[8:11], v[172:175], v[36:39]
    ds_read_b64_tr_b16 v[188:189], v6 offset:15360
    s_waitcnt lgkmcnt(7)
    v_mfma_f32_16x16x32_bf16 v[20:23], v[12:15], v[168:171], v[20:23]
    ds_read_b64_tr_b16 v[190:191], v6 offset:17920
    v_mfma_f32_16x16x32_bf16 v[40:43], v[12:15], v[172:175], v[40:43]
    ds_read_b64_tr_b16 v[8:9], v6 offset:15368
    s_waitcnt lgkmcnt(7)
    v_mfma_f32_16x16x32_bf16 v[24:27], v[180:183], v[168:171], v[24:27]
    ds_read_b64_tr_b16 v[10:11], v6 offset:17928
    v_mfma_f32_16x16x32_bf16 v[44:47], v[180:183], v[172:175], v[44:47]
    ds_read_b64_tr_b16 v[12:13], v6 offset:15376
    s_waitcnt lgkmcnt(7)
    v_mfma_f32_16x16x32_bf16 v[28:31], v[176:179], v[168:171], v[28:31]
    ds_read_b64_tr_b16 v[14:15], v6 offset:17936
    v_mfma_f32_16x16x32_bf16 v[48:51], v[176:179], v[172:175], v[48:51]
    ds_read_b64_tr_b16 v[192:193], v6 offset:15384
    s_waitcnt lgkmcnt(7)
    v_mfma_f32_16x16x32_bf16 v[32:35], v[184:187], v[168:171], v[32:35]
    ds_read_b64_tr_b16 v[194:195], v6 offset:17944
    v_mfma_f32_16x16x32_bf16 v[52:55], v[184:187], v[172:175], v[52:55]
    ds_read_b64_tr_b16 v[196:197], v6 offset:15392
    s_waitcnt lgkmcnt(7)
    v_mfma_f32_16x16x32_bf16 v[56:59], v[188:191], v[168:171], v[56:59]
    ds_read_b64_tr_b16 v[198:199], v6 offset:17952
    v_mfma_f32_16x16x32_bf16 v[76:79], v[188:191], v[172:175], v[76:79]
    ds_read_b128 v[176:179], v2 offset:32768
    ds_read_b128 v[180:183], v2 offset:34816
    ds_read_b64_tr_b16 v[200:201], v6 offset:20480
    s_waitcnt lgkmcnt(9)
    v_mfma_f32_16x16x32_bf16 v[60:63], v[8:11], v[168:171], v[60:63]
    ds_read_b64_tr_b16 v[202:203], v6 offset:23040
    v_mfma_f32_16x16x32_bf16 v[80:83], v[8:11], v[172:175], v[80:83]
    ds_read_b64_tr_b16 v[204:205], v6 offset:20488
    s_waitcnt lgkmcnt(9)
    v_mfma_f32_16x16x32_bf16 v[64:67], v[12:15], v[168:171], v[64:67]
    ds_read_b64_tr_b16 v[206:207], v6 offset:23048
    v_mfma_f32_16x16x32_bf16 v[84:87], v[12:15], v[172:175], v[84:87]
    ds_read_b64_tr_b16 v[8:9], v6 offset:20496
    s_waitcnt lgkmcnt(9)
    v_mfma_f32_16x16x32_bf16 v[68:71], v[192:195], v[168:171], v[68:71]
    ds_read_b64_tr_b16 v[10:11], v6 offset:23056
    v_mfma_f32_16x16x32_bf16 v[88:91], v[192:195], v[172:175], v[88:91]
    ds_read_b64_tr_b16 v[12:13], v6 offset:20504
    s_waitcnt lgkmcnt(9)
    v_mfma_f32_16x16x32_bf16 v[72:75], v[196:199], v[168:171], v[72:75]
    ds_read_b64_tr_b16 v[14:15], v6 offset:23064
    v_mfma_f32_16x16x32_bf16 v[92:95], v[196:199], v[172:175], v[92:95]
    ds_read_b64_tr_b16 v[192:193], v6 offset:20512
    s_waitcnt lgkmcnt(9)
    s_waitcnt lgkmcnt(7)
    v_mfma_f32_16x16x32_bf16 v[16:19], v[200:203], v[176:179], v[16:19]
    ds_read_b64_tr_b16 v[194:195], v6 offset:23072
    v_mfma_f32_16x16x32_bf16 v[36:39], v[200:203], v[180:183], v[36:39]
    ds_read_b128 v[184:187], v3 offset:32768
    ds_read_b128 v[188:191], v3 offset:34816
    ds_read_b64_tr_b16 v[196:197], v6 offset:25600
    s_waitcnt lgkmcnt(9)
    v_mfma_f32_16x16x32_bf16 v[20:23], v[204:207], v[176:179], v[20:23]
    ds_read_b64_tr_b16 v[198:199], v6 offset:28160
    v_mfma_f32_16x16x32_bf16 v[40:43], v[204:207], v[180:183], v[40:43]
    ds_read_b64_tr_b16 v[200:201], v6 offset:25608
    s_waitcnt lgkmcnt(9)
    v_mfma_f32_16x16x32_bf16 v[24:27], v[8:11], v[176:179], v[24:27]
    ds_read_b64_tr_b16 v[202:203], v6 offset:28168
    v_mfma_f32_16x16x32_bf16 v[44:47], v[8:11], v[180:183], v[44:47]
    ds_read_b64_tr_b16 v[204:205], v6 offset:25616
    s_waitcnt lgkmcnt(9)
    v_mfma_f32_16x16x32_bf16 v[28:31], v[12:15], v[176:179], v[28:31]
    ds_read_b64_tr_b16 v[206:207], v6 offset:28176
    v_mfma_f32_16x16x32_bf16 v[48:51], v[12:15], v[180:183], v[48:51]
    ds_read_b64_tr_b16 v[8:9], v6 offset:25624
    s_waitcnt lgkmcnt(9)
    v_mfma_f32_16x16x32_bf16 v[32:35], v[192:195], v[176:179], v[32:35]
    ds_read_b64_tr_b16 v[10:11], v6 offset:28184
    v_mfma_f32_16x16x32_bf16 v[52:55], v[192:195], v[180:183], v[52:55]
    ds_read_b64_tr_b16 v[12:13], v6 offset:25632
    s_waitcnt lgkmcnt(7)
    v_mfma_f32_16x16x32_bf16 v[56:59], v[196:199], v[176:179], v[56:59]
    ds_read_b64_tr_b16 v[14:15], v6 offset:28192
    v_mfma_f32_16x16x32_bf16 v[76:79], v[196:199], v[180:183], v[76:79]
    s_mov_b64 exec, 1
    ds_add_u32 v4, v4 offset:228
    s_mov_b64 exec, -1
    ds_read_b32 v5, v4 offset:104
    s_waitcnt lgkmcnt(0)
    v_cmp_ne_u32 vcc, 0x9e000, v5
    s_cbranch_vccnz L_cs_55
L_cb_56:
    ds_read_b64_tr_b16 v[192:193], v6 offset:30720
    v_mfma_f32_16x16x32_bf16 v[60:63], v[200:203], v[176:179], v[60:63]
    ds_read_b64_tr_b16 v[194:195], v6 offset:33280
    v_mfma_f32_16x16x32_bf16 v[80:83], v[200:203], v[180:183], v[80:83]
    ds_read_b64_tr_b16 v[196:197], v6 offset:30728
    v_mfma_f32_16x16x32_bf16 v[64:67], v[204:207], v[176:179], v[64:67]
    ds_read_b64_tr_b16 v[198:199], v6 offset:33288
    v_mfma_f32_16x16x32_bf16 v[84:87], v[204:207], v[180:183], v[84:87]
    ds_read_b64_tr_b16 v[200:201], v6 offset:30736
    v_mfma_f32_16x16x32_bf16 v[68:71], v[8:11], v[176:179], v[68:71]
    ds_read_b64_tr_b16 v[202:203], v6 offset:33296
    v_mfma_f32_16x16x32_bf16 v[88:91], v[8:11], v[180:183], v[88:91]
    ds_read_b64_tr_b16 v[204:205], v6 offset:30744
    v_mfma_f32_16x16x32_bf16 v[72:75], v[12:15], v[176:179], v[72:75]
    ds_read_b64_tr_b16 v[206:207], v6 offset:33304
    v_mfma_f32_16x16x32_bf16 v[92:95], v[12:15], v[180:183], v[92:95]
    ds_read_b64_tr_b16 v[8:9], v6 offset:30752
    s_waitcnt lgkmcnt(7)
    v_mfma_f32_16x16x32_bf16 v[16:19], v[192:195], v[184:187], v[16:19]
    ds_read_b64_tr_b16 v[10:11], v6 offset:33312
    v_mfma_f32_16x16x32_bf16 v[36:39], v[192:195], v[188:191], v[36:39]
    ds_read_b64_tr_b16 v[12:13], v6 offset:35840
    s_waitcnt lgkmcnt(7)
    v_mfma_f32_16x16x32_bf16 v[20:23], v[196:199], v[184:187], v[20:23]
    ds_read_b64_tr_b16 v[14:15], v6 offset:38400
    v_mfma_f32_16x16x32_bf16 v[40:43], v[196:199], v[188:191], v[40:43]
    ds_read_b64_tr_b16 v[208:209], v6 offset:35848
    s_waitcnt lgkmcnt(7)
    v_mfma_f32_16x16x32_bf16 v[24:27], v[200:203], v[184:187], v[24:27]
    ds_read_b64_tr_b16 v[210:211], v6 offset:38408
    v_mfma_f32_16x16x32_bf16 v[44:47], v[200:203], v[188:191], v[44:47]
    ds_read_b64_tr_b16 v[212:213], v6 offset:35856
    s_waitcnt lgkmcnt(7)
    v_mfma_f32_16x16x32_bf16 v[28:31], v[204:207], v[184:187], v[28:31]
    ds_read_b64_tr_b16 v[214:215], v6 offset:38416
    v_mfma_f32_16x16x32_bf16 v[48:51], v[204:207], v[188:191], v[48:51]
    ds_read_b64_tr_b16 v[200:201], v6 offset:35864
    s_waitcnt lgkmcnt(7)
    v_mfma_f32_16x16x32_bf16 v[32:35], v[8:11], v[184:187], v[32:35]
    ds_read_b64_tr_b16 v[202:203], v6 offset:38424
    v_mfma_f32_16x16x32_bf16 v[52:55], v[8:11], v[188:191], v[52:55]
    ds_read_b64_tr_b16 v[204:205], v6 offset:35872
    s_waitcnt lgkmcnt(7)
    v_mfma_f32_16x16x32_bf16 v[56:59], v[12:15], v[184:187], v[56:59]
    ds_read_b64_tr_b16 v[206:207], v6 offset:38432
    v_mfma_f32_16x16x32_bf16 v[76:79], v[12:15], v[188:191], v[76:79]
    ds_read_b128 v[192:195], v2 offset:16384
    ds_read_b128 v[196:199], v2 offset:18432
    ds_read_b64_tr_b16 v[8:9], v1 offset:55296
    s_waitcnt lgkmcnt(9)
    v_mfma_f32_16x16x32_bf16 v[60:63], v[208:211], v[184:187], v[60:63]
    ds_read_b64_tr_b16 v[10:11], v1 offset:57856
    v_mfma_f32_16x16x32_bf16 v[80:83], v[208:211], v[188:191], v[80:83]
    ds_read_b64_tr_b16 v[12:13], v1 offset:55304
    s_waitcnt lgkmcnt(9)
    v_mfma_f32_16x16x32_bf16 v[64:67], v[212:215], v[184:187], v[64:67]
    ds_read_b64_tr_b16 v[14:15], v1 offset:57864
    v_mfma_f32_16x16x32_bf16 v[84:87], v[212:215], v[188:191], v[84:87]
    ds_read_b64_tr_b16 v[208:209], v1 offset:55312
    s_waitcnt lgkmcnt(9)
    v_mfma_f32_16x16x32_bf16 v[68:71], v[200:203], v[184:187], v[68:71]
    ds_read_b64_tr_b16 v[210:211], v1 offset:57872
    v_mfma_f32_16x16x32_bf16 v[88:91], v[200:203], v[188:191], v[88:91]
    ds_read_b64_tr_b16 v[212:213], v1 offset:55320
    s_waitcnt lgkmcnt(9)
    v_mfma_f32_16x16x32_bf16 v[72:75], v[204:207], v[184:187], v[72:75]
    ds_read_b64_tr_b16 v[214:215], v1 offset:57880
    v_mfma_f32_16x16x32_bf16 v[92:95], v[204:207], v[188:191], v[92:95]
    ds_read_b64_tr_b16 v[216:217], v1 offset:55328
    s_waitcnt lgkmcnt(9)
    s_waitcnt lgkmcnt(7)
    v_mfma_f32_16x16x32_bf16 v[16:19], v[8:11], v[192:195], v[16:19]
    ds_read_b64_tr_b16 v[218:219], v1 offset:57888
    v_mfma_f32_16x16x32_bf16 v[36:39], v[8:11], v[196:199], v[36:39]
    ds_read_b128 v[200:203], v3 offset:16384
    ds_read_b128 v[204:207], v3 offset:18432
    ds_read_b64_tr_b16 v[220:221], v1 offset:60416
    s_waitcnt lgkmcnt(9)
    v_mfma_f32_16x16x32_bf16 v[20:23], v[12:15], v[192:195], v[20:23]
    ds_read_b64_tr_b16 v[222:223], v1 offset:62976
    v_mfma_f32_16x16x32_bf16 v[40:43], v[12:15], v[196:199], v[40:43]
    ds_read_b64_tr_b16 v[8:9], v1 offset:60424
    s_waitcnt lgkmcnt(9)
    v_mfma_f32_16x16x32_bf16 v[24:27], v[208:211], v[192:195], v[24:27]
    ds_read_b64_tr_b16 v[10:11], v1 offset:62984
    v_mfma_f32_16x16x32_bf16 v[44:47], v[208:211], v[196:199], v[44:47]
    ds_read_b64_tr_b16 v[12:13], v1 offset:60432
    s_waitcnt lgkmcnt(9)
    v_mfma_f32_16x16x32_bf16 v[28:31], v[212:215], v[192:195], v[28:31]
    ds_read_b64_tr_b16 v[14:15], v1 offset:62992
    v_mfma_f32_16x16x32_bf16 v[48:51], v[212:215], v[196:199], v[48:51]
    ds_read_b64_tr_b16 v[208:209], v1 offset:60440
    s_waitcnt lgkmcnt(9)
    v_mfma_f32_16x16x32_bf16 v[32:35], v[216:219], v[192:195], v[32:35]
    ds_read_b64_tr_b16 v[210:211], v1 offset:63000
    v_mfma_f32_16x16x32_bf16 v[52:55], v[216:219], v[196:199], v[52:55]
    ds_read_b64_tr_b16 v[212:213], v1 offset:60448
    s_waitcnt lgkmcnt(7)
    v_mfma_f32_16x16x32_bf16 v[56:59], v[220:223], v[192:195], v[56:59]
    ds_read_b64_tr_b16 v[214:215], v1 offset:63008
    v_mfma_f32_16x16x32_bf16 v[76:79], v[220:223], v[196:199], v[76:79]
    s_mov_b64 exec, 1
    ds_add_u32 v4, v4 offset:232
    s_mov_b64 exec, -1
    ds_read_b32 v5, v4 offset:108
    s_waitcnt lgkmcnt(0)
    v_cmp_ne_u32 vcc, 0x9e000, v5
    s_cbranch_vccnz L_cs_57
L_cb_58:
    ds_read_b64_tr_b16 v[216:217], v1 offset:45056
    v_mfma_f32_16x16x32_bf16 v[60:63], v[8:11], v[192:195], v[60:63]
    ds_read_b64_tr_b16 v[218:219], v1 offset:47616
    v_mfma_f32_16x16x32_bf16 v[80:83], v[8:11], v[196:199], v[80:83]
    ds_read_b64_tr_b16 v[220:221], v1 offset:45064
    v_mfma_f32_16x16x32_bf16 v[64:67], v[12:15], v[192:195], v[64:67]
    ds_read_b64_tr_b16 v[222:223], v1 offset:47624
    v_mfma_f32_16x16x32_bf16 v[84:87], v[12:15], v[196:199], v[84:87]
    ds_read_b64_tr_b16 v[8:9], v1 offset:45072
    v_mfma_f32_16x16x32_bf16 v[68:71], v[208:211], v[192:195], v[68:71]
    ds_read_b64_tr_b16 v[10:11], v1 offset:47632
    v_mfma_f32_16x16x32_bf16 v[88:91], v[208:211], v[196:199], v[88:91]
    ds_read_b64_tr_b16 v[12:13], v1 offset:45080
    v_mfma_f32_16x16x32_bf16 v[72:75], v[212:215], v[192:195], v[72:75]
    ds_read_b64_tr_b16 v[14:15], v1 offset:47640
    v_mfma_f32_16x16x32_bf16 v[92:95], v[212:215], v[196:199], v[92:95]
    ds_read_b64_tr_b16 v[208:209], v1 offset:45088
    s_waitcnt lgkmcnt(7)
    v_mfma_f32_16x16x32_bf16 v[16:19], v[216:219], v[200:203], v[16:19]
    ds_read_b64_tr_b16 v[210:211], v1 offset:47648
    v_mfma_f32_16x16x32_bf16 v[36:39], v[216:219], v[204:207], v[36:39]
    ds_read_b64_tr_b16 v[224:225], v1 offset:50176
    s_waitcnt lgkmcnt(7)
    v_mfma_f32_16x16x32_bf16 v[20:23], v[220:223], v[200:203], v[20:23]
    ds_read_b64_tr_b16 v[226:227], v1 offset:52736
    v_mfma_f32_16x16x32_bf16 v[40:43], v[220:223], v[204:207], v[40:43]
    ds_read_b64_tr_b16 v[216:217], v1 offset:50184
    s_waitcnt lgkmcnt(7)
    v_mfma_f32_16x16x32_bf16 v[24:27], v[8:11], v[200:203], v[24:27]
    ds_read_b64_tr_b16 v[218:219], v1 offset:52744
    v_mfma_f32_16x16x32_bf16 v[44:47], v[8:11], v[204:207], v[44:47]
    ds_read_b64_tr_b16 v[220:221], v1 offset:50192
    s_waitcnt lgkmcnt(7)
    v_mfma_f32_16x16x32_bf16 v[28:31], v[12:15], v[200:203], v[28:31]
    ds_read_b64_tr_b16 v[222:223], v1 offset:52752
    v_mfma_f32_16x16x32_bf16 v[48:51], v[12:15], v[204:207], v[48:51]
    ds_read_b64_tr_b16 v[8:9], v1 offset:50200
    s_waitcnt lgkmcnt(7)
    v_mfma_f32_16x16x32_bf16 v[32:35], v[208:211], v[200:203], v[32:35]
    ds_read_b64_tr_b16 v[10:11], v1 offset:52760
    v_mfma_f32_16x16x32_bf16 v[52:55], v[208:211], v[204:207], v[52:55]
    ds_read_b64_tr_b16 v[12:13], v1 offset:50208
    s_waitcnt lgkmcnt(7)
    v_mfma_f32_16x16x32_bf16 v[56:59], v[224:227], v[200:203], v[56:59]
    ds_read_b64_tr_b16 v[14:15], v1 offset:52768
    v_mfma_f32_16x16x32_bf16 v[76:79], v[224:227], v[204:207], v[76:79]
    ds_read_b128 v[208:211], v2 offset:0
    ds_read_b128 v[212:215], v2 offset:2048
    ds_read_b64_tr_b16 v[228:229], v6 offset:0
    s_waitcnt lgkmcnt(9)
    v_mfma_f32_16x16x32_bf16 v[60:63], v[216:219], v[200:203], v[60:63]
    ds_read_b64_tr_b16 v[230:231], v6 offset:2560
    v_mfma_f32_16x16x32_bf16 v[80:83], v[216:219], v[204:207], v[80:83]
    ds_read_b64_tr_b16 v[224:225], v6 offset:8
    s_waitcnt lgkmcnt(9)
    v_mfma_f32_16x16x32_bf16 v[64:67], v[220:223], v[200:203], v[64:67]
    ds_read_b64_tr_b16 v[226:227], v6 offset:2568
    v_mfma_f32_16x16x32_bf16 v[84:87], v[220:223], v[204:207], v[84:87]
    ds_read_b64_tr_b16 v[232:233], v6 offset:16
    s_waitcnt lgkmcnt(9)
    v_mfma_f32_16x16x32_bf16 v[68:71], v[8:11], v[200:203], v[68:71]
    ds_read_b64_tr_b16 v[234:235], v6 offset:2576
    v_mfma_f32_16x16x32_bf16 v[88:91], v[8:11], v[204:207], v[88:91]
    ds_read_b64_tr_b16 v[236:237], v6 offset:24
    s_waitcnt lgkmcnt(9)
    v_mfma_f32_16x16x32_bf16 v[72:75], v[12:15], v[200:203], v[72:75]
    ds_read_b64_tr_b16 v[238:239], v6 offset:2584
    v_mfma_f32_16x16x32_bf16 v[92:95], v[12:15], v[204:207], v[92:95]
    ds_read_b64_tr_b16 v[8:9], v6 offset:32
    s_waitcnt lgkmcnt(9)
    s_waitcnt lgkmcnt(7)
    v_mfma_f32_16x16x32_bf16 v[16:19], v[228:231], v[208:211], v[16:19]
    ds_read_b64_tr_b16 v[10:11], v6 offset:2592
    v_mfma_f32_16x16x32_bf16 v[36:39], v[228:231], v[212:215], v[36:39]
    ds_read_b128 v[216:219], v3 offset:0
    ds_read_b128 v[220:223], v3 offset:2048
    ds_read_b64_tr_b16 v[12:13], v6 offset:5120
    s_waitcnt lgkmcnt(9)
    v_mfma_f32_16x16x32_bf16 v[20:23], v[224:227], v[208:211], v[20:23]
    ds_read_b64_tr_b16 v[14:15], v6 offset:7680
    v_mfma_f32_16x16x32_bf16 v[40:43], v[224:227], v[212:215], v[40:43]
    ds_read_b64_tr_b16 v[228:229], v6 offset:5128
    s_waitcnt lgkmcnt(9)
    v_mfma_f32_16x16x32_bf16 v[24:27], v[232:235], v[208:211], v[24:27]
    ds_read_b64_tr_b16 v[230:231], v6 offset:7688
    v_mfma_f32_16x16x32_bf16 v[44:47], v[232:235], v[212:215], v[44:47]
    ds_read_b64_tr_b16 v[224:225], v6 offset:5136
    s_waitcnt lgkmcnt(9)
    v_mfma_f32_16x16x32_bf16 v[28:31], v[236:239], v[208:211], v[28:31]
    ds_read_b64_tr_b16 v[226:227], v6 offset:7696
    v_mfma_f32_16x16x32_bf16 v[48:51], v[236:239], v[212:215], v[48:51]
    ds_read_b64_tr_b16 v[232:233], v6 offset:5144
    s_waitcnt lgkmcnt(9)
    v_mfma_f32_16x16x32_bf16 v[32:35], v[8:11], v[208:211], v[32:35]
    ds_read_b64_tr_b16 v[234:235], v6 offset:7704
    v_mfma_f32_16x16x32_bf16 v[52:55], v[8:11], v[212:215], v[52:55]
    ds_read_b64_tr_b16 v[236:237], v6 offset:5152
    s_waitcnt lgkmcnt(7)
    v_mfma_f32_16x16x32_bf16 v[56:59], v[12:15], v[208:211], v[56:59]
    ds_read_b64_tr_b16 v[238:239], v6 offset:7712
    v_mfma_f32_16x16x32_bf16 v[76:79], v[12:15], v[212:215], v[76:79]
    s_mov_b64 exec, 1
    ds_add_u32 v4, v4 offset:236
    s_mov_b64 exec, -1
    ds_read_b32 v5, v4 offset:112
    s_waitcnt lgkmcnt(0)
    v_cmp_ne_u32 vcc, 0x9e000, v5
    s_cbranch_vccnz L_cs_59
L_cb_60:
    ds_read_b64_tr_b16 v[8:9], v6 offset:10240
    v_mfma_f32_16x16x32_bf16 v[60:63], v[228:231], v[208:211], v[60:63]
    ds_read_b64_tr_b16 v[10:11], v6 offset:12800
    v_mfma_f32_16x16x32_bf16 v[80:83], v[228:231], v[212:215], v[80:83]
    ds_read_b64_tr_b16 v[12:13], v6 offset:10248
    v_mfma_f32_16x16x32_bf16 v[64:67], v[224:227], v[208:211], v[64:67]
    ds_read_b64_tr_b16 v[14:15], v6 offset:12808
    v_mfma_f32_16x16x32_bf16 v[84:87], v[224:227], v[212:215], v[84:87]
    ds_read_b64_tr_b16 v[228:229], v6 offset:10256
    v_mfma_f32_16x16x32_bf16 v[68:71], v[232:235], v[208:211], v[68:71]
    ds_read_b64_tr_b16 v[230:231], v6 offset:12816
    v_mfma_f32_16x16x32_bf16 v[88:91], v[232:235], v[212:215], v[88:91]
    ds_read_b64_tr_b16 v[224:225], v6 offset:10264
    v_mfma_f32_16x16x32_bf16 v[72:75], v[236:239], v[208:211], v[72:75]
    ds_read_b64_tr_b16 v[226:227], v6 offset:12824
    v_mfma_f32_16x16x32_bf16 v[92:95], v[236:239], v[212:215], v[92:95]
    ds_read_b64_tr_b16 v[232:233], v6 offset:10272
    s_waitcnt lgkmcnt(7)
    v_mfma_f32_16x16x32_bf16 v[16:19], v[8:11], v[216:219], v[16:19]
    ds_read_b64_tr_b16 v[234:235], v6 offset:12832
    v_mfma_f32_16x16x32_bf16 v[36:39], v[8:11], v[220:223], v[36:39]
    ds_read_b64_tr_b16 v[236:237], v6 offset:15360
    s_waitcnt lgkmcnt(7)
    v_mfma_f32_16x16x32_bf16 v[20:23], v[12:15], v[216:219], v[20:23]
    ds_read_b64_tr_b16 v[238:239], v6 offset:17920
    v_mfma_f32_16x16x32_bf16 v[40:43], v[12:15], v[220:223], v[40:43]
    ds_read_b64_tr_b16 v[8:9], v6 offset:15368
    s_waitcnt lgkmcnt(7)
    v_mfma_f32_16x16x32_bf16 v[24:27], v[228:231], v[216:219], v[24:27]
    ds_read_b64_tr_b16 v[10:11], v6 offset:17928
    v_mfma_f32_16x16x32_bf16 v[44:47], v[228:231], v[220:223], v[44:47]
    ds_read_b64_tr_b16 v[12:13], v6 offset:15376
    s_waitcnt lgkmcnt(7)
    v_mfma_f32_16x16x32_bf16 v[28:31], v[224:227], v[216:219], v[28:31]
    ds_read_b64_tr_b16 v[14:15], v6 offset:17936
    v_mfma_f32_16x16x32_bf16 v[48:51], v[224:227], v[220:223], v[48:51]
    ds_read_b64_tr_b16 v[240:241], v6 offset:15384
    s_waitcnt lgkmcnt(7)
    v_mfma_f32_16x16x32_bf16 v[32:35], v[232:235], v[216:219], v[32:35]
    ds_read_b64_tr_b16 v[242:243], v6 offset:17944
    v_mfma_f32_16x16x32_bf16 v[52:55], v[232:235], v[220:223], v[52:55]
    ds_read_b64_tr_b16 v[244:245], v6 offset:15392
    s_waitcnt lgkmcnt(7)
    v_mfma_f32_16x16x32_bf16 v[56:59], v[236:239], v[216:219], v[56:59]
    ds_read_b64_tr_b16 v[246:247], v6 offset:17952
    v_mfma_f32_16x16x32_bf16 v[76:79], v[236:239], v[220:223], v[76:79]
    ds_read_b128 v[224:227], v2 offset:32768
    ds_read_b128 v[228:231], v2 offset:34816
    ds_read_b64_tr_b16 v[248:249], v6 offset:20480
    s_waitcnt lgkmcnt(9)
    v_mfma_f32_16x16x32_bf16 v[60:63], v[8:11], v[216:219], v[60:63]
    ds_read_b64_tr_b16 v[250:251], v6 offset:23040
    v_mfma_f32_16x16x32_bf16 v[80:83], v[8:11], v[220:223], v[80:83]
    ds_read_b64_tr_b16 v[252:253], v6 offset:20488
    s_waitcnt lgkmcnt(9)
    v_mfma_f32_16x16x32_bf16 v[64:67], v[12:15], v[216:219], v[64:67]
    ds_read_b64_tr_b16 v[254:255], v6 offset:23048
    v_mfma_f32_16x16x32_bf16 v[84:87], v[12:15], v[220:223], v[84:87]
    ds_read_b64_tr_b16 v[8:9], v6 offset:20496
    s_waitcnt lgkmcnt(9)
    v_mfma_f32_16x16x32_bf16 v[68:71], v[240:243], v[216:219], v[68:71]
    ds_read_b64_tr_b16 v[10:11], v6 offset:23056
    v_mfma_f32_16x16x32_bf16 v[88:91], v[240:243], v[220:223], v[88:91]
    ds_read_b64_tr_b16 v[12:13], v6 offset:20504
    s_waitcnt lgkmcnt(9)
    v_mfma_f32_16x16x32_bf16 v[72:75], v[244:247], v[216:219], v[72:75]
    ds_read_b64_tr_b16 v[14:15], v6 offset:23064
    v_mfma_f32_16x16x32_bf16 v[92:95], v[244:247], v[220:223], v[92:95]
    ds_read_b64_tr_b16 v[240:241], v6 offset:20512
    s_waitcnt lgkmcnt(9)
    s_waitcnt lgkmcnt(7)
    v_mfma_f32_16x16x32_bf16 v[16:19], v[248:251], v[224:227], v[16:19]
    ds_read_b64_tr_b16 v[242:243], v6 offset:23072
    v_mfma_f32_16x16x32_bf16 v[36:39], v[248:251], v[228:231], v[36:39]
    ds_read_b128 v[232:235], v3 offset:32768
    ds_read_b128 v[236:239], v3 offset:34816
    ds_read_b64_tr_b16 v[244:245], v6 offset:25600
    s_waitcnt lgkmcnt(9)
    v_mfma_f32_16x16x32_bf16 v[20:23], v[252:255], v[224:227], v[20:23]
    ds_read_b64_tr_b16 v[246:247], v6 offset:28160
    v_mfma_f32_16x16x32_bf16 v[40:43], v[252:255], v[228:231], v[40:43]
    ds_read_b64_tr_b16 v[248:249], v6 offset:25608
    s_waitcnt lgkmcnt(9)
    v_mfma_f32_16x16x32_bf16 v[24:27], v[8:11], v[224:227], v[24:27]
    ds_read_b64_tr_b16 v[250:251], v6 offset:28168
    v_mfma_f32_16x16x32_bf16 v[44:47], v[8:11], v[228:231], v[44:47]
    ds_read_b64_tr_b16 v[252:253], v6 offset:25616
    s_waitcnt lgkmcnt(9)
    v_mfma_f32_16x16x32_bf16 v[28:31], v[12:15], v[224:227], v[28:31]
    ds_read_b64_tr_b16 v[254:255], v6 offset:28176
    v_mfma_f32_16x16x32_bf16 v[48:51], v[12:15], v[228:231], v[48:51]
    ds_read_b64_tr_b16 v[8:9], v6 offset:25624
    s_waitcnt lgkmcnt(9)
    v_mfma_f32_16x16x32_bf16 v[32:35], v[240:243], v[224:227], v[32:35]
    ds_read_b64_tr_b16 v[10:11], v6 offset:28184
    v_mfma_f32_16x16x32_bf16 v[52:55], v[240:243], v[228:231], v[52:55]
    ds_read_b64_tr_b16 v[12:13], v6 offset:25632
    s_waitcnt lgkmcnt(7)
    v_mfma_f32_16x16x32_bf16 v[56:59], v[244:247], v[224:227], v[56:59]
    ds_read_b64_tr_b16 v[14:15], v6 offset:28192
    v_mfma_f32_16x16x32_bf16 v[76:79], v[244:247], v[228:231], v[76:79]
    s_mov_b64 exec, 1
    ds_add_u32 v4, v4 offset:240
    s_mov_b64 exec, -1
    ds_read_b32 v5, v4 offset:116
    s_waitcnt lgkmcnt(0)
    v_cmp_ne_u32 vcc, 0x9e000, v5
    s_cbranch_vccnz L_cs_61
L_cb_62:
    ds_read_b64_tr_b16 v[240:241], v6 offset:30720
    v_mfma_f32_16x16x32_bf16 v[60:63], v[248:251], v[224:227], v[60:63]
    ds_read_b64_tr_b16 v[242:243], v6 offset:33280
    v_mfma_f32_16x16x32_bf16 v[80:83], v[248:251], v[228:231], v[80:83]
    ds_read_b64_tr_b16 v[244:245], v6 offset:30728
    v_mfma_f32_16x16x32_bf16 v[64:67], v[252:255], v[224:227], v[64:67]
    ds_read_b64_tr_b16 v[246:247], v6 offset:33288
    v_mfma_f32_16x16x32_bf16 v[84:87], v[252:255], v[228:231], v[84:87]
    ds_read_b64_tr_b16 v[248:249], v6 offset:30736
    v_mfma_f32_16x16x32_bf16 v[68:71], v[8:11], v[224:227], v[68:71]
    ds_read_b64_tr_b16 v[250:251], v6 offset:33296
    v_mfma_f32_16x16x32_bf16 v[88:91], v[8:11], v[228:231], v[88:91]
    ds_read_b64_tr_b16 v[252:253], v6 offset:30744
    v_mfma_f32_16x16x32_bf16 v[72:75], v[12:15], v[224:227], v[72:75]
    ds_read_b64_tr_b16 v[254:255], v6 offset:33304
    v_mfma_f32_16x16x32_bf16 v[92:95], v[12:15], v[228:231], v[92:95]
    ds_read_b64_tr_b16 v[8:9], v6 offset:30752
    s_waitcnt lgkmcnt(7)
    v_mfma_f32_16x16x32_bf16 v[16:19], v[240:243], v[232:235], v[16:19]
    ds_read_b64_tr_b16 v[10:11], v6 offset:33312
    v_mfma_f32_16x16x32_bf16 v[36:39], v[240:243], v[236:239], v[36:39]
    ds_read_b64_tr_b16 v[12:13], v6 offset:35840
    s_waitcnt lgkmcnt(7)
    v_mfma_f32_16x16x32_bf16 v[20:23], v[244:247], v[232:235], v[20:23]
    ds_read_b64_tr_b16 v[14:15], v6 offset:38400
    v_mfma_f32_16x16x32_bf16 v[40:43], v[244:247], v[236:239], v[40:43]
    ds_read_b64_tr_b16 v[224:225], v6 offset:35848
    s_waitcnt lgkmcnt(7)
    v_mfma_f32_16x16x32_bf16 v[24:27], v[248:251], v[232:235], v[24:27]
    ds_read_b64_tr_b16 v[226:227], v6 offset:38408
    v_mfma_f32_16x16x32_bf16 v[44:47], v[248:251], v[236:239], v[44:47]
    ds_read_b64_tr_b16 v[228:229], v6 offset:35856
    s_waitcnt lgkmcnt(7)
    v_mfma_f32_16x16x32_bf16 v[28:31], v[252:255], v[232:235], v[28:31]
    ds_read_b64_tr_b16 v[230:231], v6 offset:38416
    v_mfma_f32_16x16x32_bf16 v[48:51], v[252:255], v[236:239], v[48:51]
    ds_read_b64_tr_b16 v[248:249], v6 offset:35864
    s_waitcnt lgkmcnt(7)
    v_mfma_f32_16x16x32_bf16 v[32:35], v[8:11], v[232:235], v[32:35]
    ds_read_b64_tr_b16 v[250:251], v6 offset:38424
    v_mfma_f32_16x16x32_bf16 v[52:55], v[8:11], v[236:239], v[52:55]
    ds_read_b64_tr_b16 v[252:253], v6 offset:35872
    s_waitcnt lgkmcnt(7)
    v_mfma_f32_16x16x32_bf16 v[56:59], v[12:15], v[232:235], v[56:59]
    ds_read_b64_tr_b16 v[254:255], v6 offset:38432
    v_mfma_f32_16x16x32_bf16 v[76:79], v[12:15], v[236:239], v[76:79]
    ds_read_b128 v[240:243], v2 offset:16384
    ds_read_b128 v[244:247], v2 offset:18432
    ds_read_b64_tr_b16 v[8:9], v1 offset:55296
    s_waitcnt lgkmcnt(9)
    v_mfma_f32_16x16x32_bf16 v[60:63], v[224:227], v[232:235], v[60:63]
    ds_read_b64_tr_b16 v[10:11], v1 offset:57856
    v_mfma_f32_16x16x32_bf16 v[80:83], v[224:227], v[236:239], v[80:83]
    ds_read_b64_tr_b16 v[12:13], v1 offset:55304
    s_waitcnt lgkmcnt(9)
    v_mfma_f32_16x16x32_bf16 v[64:67], v[228:231], v[232:235], v[64:67]
    ds_read_b64_tr_b16 v[14:15], v1 offset:57864
    v_mfma_f32_16x16x32_bf16 v[84:87], v[228:231], v[236:239], v[84:87]
    ds_read_b64_tr_b16 v[224:225], v1 offset:55312
    s_waitcnt lgkmcnt(9)
    v_mfma_f32_16x16x32_bf16 v[68:71], v[248:251], v[232:235], v[68:71]
    ds_read_b64_tr_b16 v[226:227], v1 offset:57872
    v_mfma_f32_16x16x32_bf16 v[88:91], v[248:251], v[236:239], v[88:91]
    ds_read_b64_tr_b16 v[228:229], v1 offset:55320
    s_waitcnt lgkmcnt(9)
    v_mfma_f32_16x16x32_bf16 v[72:75], v[252:255], v[232:235], v[72:75]
    ds_read_b64_tr_b16 v[230:231], v1 offset:57880
    v_mfma_f32_16x16x32_bf16 v[92:95], v[252:255], v[236:239], v[92:95]
    ds_read_b64_tr_b16 v[232:233], v1 offset:55328
    s_waitcnt lgkmcnt(9)
    s_waitcnt lgkmcnt(7)
    v_mfma_f32_16x16x32_bf16 v[16:19], v[8:11], v[240:243], v[16:19]
    ds_read_b64_tr_b16 v[234:235], v1 offset:57888
    v_mfma_f32_16x16x32_bf16 v[36:39], v[8:11], v[244:247], v[36:39]
    ds_read_b128 v[248:251], v3 offset:16384
    ds_read_b128 v[252:255], v3 offset:18432
    ds_read_b64_tr_b16 v[236:237], v1 offset:60416
    s_waitcnt lgkmcnt(9)
    v_mfma_f32_16x16x32_bf16 v[20:23], v[12:15], v[240:243], v[20:23]
    ds_read_b64_tr_b16 v[238:239], v1 offset:62976
    v_mfma_f32_16x16x32_bf16 v[40:43], v[12:15], v[244:247], v[40:43]
    ds_read_b64_tr_b16 v[8:9], v1 offset:60424
    s_waitcnt lgkmcnt(9)
    v_mfma_f32_16x16x32_bf16 v[24:27], v[224:227], v[240:243], v[24:27]
    ds_read_b64_tr_b16 v[10:11], v1 offset:62984
    v_mfma_f32_16x16x32_bf16 v[44:47], v[224:227], v[244:247], v[44:47]
    ds_read_b64_tr_b16 v[12:13], v1 offset:60432
    s_waitcnt lgkmcnt(9)
    v_mfma_f32_16x16x32_bf16 v[28:31], v[228:231], v[240:243], v[28:31]
    ds_read_b64_tr_b16 v[14:15], v1 offset:62992
    v_mfma_f32_16x16x32_bf16 v[48:51], v[228:231], v[244:247], v[48:51]
    ds_read_b64_tr_b16 v[224:225], v1 offset:60440
    s_waitcnt lgkmcnt(9)
    v_mfma_f32_16x16x32_bf16 v[32:35], v[232:235], v[240:243], v[32:35]
    ds_read_b64_tr_b16 v[226:227], v1 offset:63000
    v_mfma_f32_16x16x32_bf16 v[52:55], v[232:235], v[244:247], v[52:55]
    ds_read_b64_tr_b16 v[228:229], v1 offset:60448
    s_waitcnt lgkmcnt(7)
    v_mfma_f32_16x16x32_bf16 v[56:59], v[236:239], v[240:243], v[56:59]
    ds_read_b64_tr_b16 v[230:231], v1 offset:63008
    v_mfma_f32_16x16x32_bf16 v[76:79], v[236:239], v[244:247], v[76:79]
    s_mov_b64 exec, 1
    ds_add_u32 v4, v4 offset:244
    s_mov_b64 exec, -1
    ds_read_b32 v5, v4 offset:120
    s_waitcnt lgkmcnt(0)
    v_cmp_ne_u32 vcc, 0x9e000, v5
    s_cbranch_vccnz L_cs_63
L_cb_64:
    ds_read_b64_tr_b16 v[232:233], v1 offset:50176
    v_mfma_f32_16x16x32_bf16 v[60:63], v[8:11], v[240:243], v[60:63]
    ds_read_b64_tr_b16 v[234:235], v1 offset:52736
    v_mfma_f32_16x16x32_bf16 v[80:83], v[8:11], v[244:247], v[80:83]
    ds_read_b64_tr_b16 v[236:237], v1 offset:50184
    v_mfma_f32_16x16x32_bf16 v[64:67], v[12:15], v[240:243], v[64:67]
    ds_read_b64_tr_b16 v[238:239], v1 offset:52744
    v_mfma_f32_16x16x32_bf16 v[84:87], v[12:15], v[244:247], v[84:87]
    ds_read_b64_tr_b16 v[8:9], v1 offset:50192
    v_mfma_f32_16x16x32_bf16 v[68:71], v[224:227], v[240:243], v[68:71]
    ds_read_b64_tr_b16 v[10:11], v1 offset:52752
    v_mfma_f32_16x16x32_bf16 v[88:91], v[224:227], v[244:247], v[88:91]
    ds_read_b64_tr_b16 v[12:13], v1 offset:50200
    v_mfma_f32_16x16x32_bf16 v[72:75], v[228:231], v[240:243], v[72:75]
    ds_read_b64_tr_b16 v[14:15], v1 offset:52760
    v_mfma_f32_16x16x32_bf16 v[92:95], v[228:231], v[244:247], v[92:95]
    ds_read_b64_tr_b16 v[224:225], v1 offset:50208
    s_waitcnt lgkmcnt(7)
    v_mfma_f32_16x16x32_bf16 v[56:59], v[232:235], v[248:251], v[56:59]
    ds_read_b64_tr_b16 v[226:227], v1 offset:52768
    v_mfma_f32_16x16x32_bf16 v[76:79], v[232:235], v[252:255], v[76:79]
    ds_read_b64_tr_b16 v[228:229], v1 offset:45056
    s_waitcnt lgkmcnt(7)
    v_mfma_f32_16x16x32_bf16 v[60:63], v[236:239], v[248:251], v[60:63]
    ds_read_b64_tr_b16 v[230:231], v1 offset:47616
    v_mfma_f32_16x16x32_bf16 v[80:83], v[236:239], v[252:255], v[80:83]
    ds_read_b64_tr_b16 v[232:233], v1 offset:45064
    s_waitcnt lgkmcnt(7)
    v_mfma_f32_16x16x32_bf16 v[64:67], v[8:11], v[248:251], v[64:67]
    ds_read_b64_tr_b16 v[234:235], v1 offset:47624
    v_mfma_f32_16x16x32_bf16 v[84:87], v[8:11], v[252:255], v[84:87]
    ds_read_b64_tr_b16 v[236:237], v1 offset:45072
    s_waitcnt lgkmcnt(7)
    v_mfma_f32_16x16x32_bf16 v[68:71], v[12:15], v[248:251], v[68:71]
    ds_read_b64_tr_b16 v[238:239], v1 offset:47632
    v_mfma_f32_16x16x32_bf16 v[88:91], v[12:15], v[252:255], v[88:91]
    ds_read_b64_tr_b16 v[8:9], v1 offset:45080
    s_waitcnt lgkmcnt(7)
    v_mfma_f32_16x16x32_bf16 v[72:75], v[224:227], v[248:251], v[72:75]
    ds_read_b64_tr_b16 v[10:11], v1 offset:47640
    v_mfma_f32_16x16x32_bf16 v[92:95], v[224:227], v[252:255], v[92:95]
    ds_read_b64_tr_b16 v[12:13], v1 offset:45088
    s_waitcnt lgkmcnt(7)
    v_mfma_f32_16x16x32_bf16 v[16:19], v[228:231], v[248:251], v[16:19]
    ds_read_b64_tr_b16 v[14:15], v1 offset:47648
    v_cvt_pk_bf16_f32 v56, v56, v57
    v_cvt_pk_bf16_f32 v57, v58, v59
    v_cvt_pk_bf16_f32 v58, v60, v61
    v_mfma_f32_16x16x32_bf16 v[36:39], v[228:231], v[252:255], v[36:39]
    v_cvt_pk_bf16_f32 v59, v62, v63
    ds_write_b128 v7, v[56:59] offset:0
    v_cvt_pk_bf16_f32 v60, v64, v65
    s_waitcnt lgkmcnt(5)
    v_mfma_f32_16x16x32_bf16 v[20:23], v[232:235], v[248:251], v[20:23]
    v_cvt_pk_bf16_f32 v61, v66, v67
    v_cvt_pk_bf16_f32 v62, v68, v69
    v_cvt_pk_bf16_f32 v63, v70, v71
    v_mfma_f32_16x16x32_bf16 v[40:43], v[232:235], v[252:255], v[40:43]
    ds_write_b128 v7, v[60:63] offset:2176
    v_cvt_pk_bf16_f32 v64, v72, v73
    v_cvt_pk_bf16_f32 v65, v74, v75
    v_mfma_f32_16x16x32_bf16 v[24:27], v[236:239], v[248:251], v[24:27]
    ds_write_b64 v7, v[64:65] offset:4424
    v_cvt_pk_bf16_f32 v76, v76, v77
    v_cvt_pk_bf16_f32 v77, v78, v79
    v_mfma_f32_16x16x32_bf16 v[44:47], v[236:239], v[252:255], v[44:47]
    v_cvt_pk_bf16_f32 v78, v80, v81
    v_cvt_pk_bf16_f32 v79, v82, v83
    ds_write_b128 v7, v[76:79] offset:256
    s_waitcnt lgkmcnt(6)
    v_mfma_f32_16x16x32_bf16 v[28:31], v[8:11], v[248:251], v[28:31]
    v_cvt_pk_bf16_f32 v80, v84, v85
    v_cvt_pk_bf16_f32 v81, v86, v87
    v_cvt_pk_bf16_f32 v82, v88, v89
    v_mfma_f32_16x16x32_bf16 v[48:51], v[8:11], v[252:255], v[48:51]
    v_cvt_pk_bf16_f32 v83, v90, v91
    ds_write_b128 v7, v[80:83] offset:2432
    v_cvt_pk_bf16_f32 v84, v92, v93
    s_waitcnt lgkmcnt(5)
    v_mfma_f32_16x16x32_bf16 v[32:35], v[12:15], v[248:251], v[32:35]
    v_cvt_pk_bf16_f32 v85, v94, v95
    ds_write_b64 v7, v[84:85] offset:4680
    v_mfma_f32_16x16x32_bf16 v[52:55], v[12:15], v[252:255], v[52:55]
    ds_read_b128 v[224:227], v2 offset:32768
    ds_read_b128 v[228:231], v2 offset:34816
    ds_read_b128 v[232:235], v3 offset:32768
    ds_read_b128 v[236:239], v3 offset:34816
    s_mov_b64 exec, 1
    ds_add_u32 v4, v4 offset:248
    s_mov_b64 exec, -1
    s_cmp_eq_u32 s28, 0
    s_cbranch_scc1 L_fmk
    v_cvt_pk_bf16_f32 v16, v16, v17
    v_cvt_pk_bf16_f32 v17, v18, v19
    v_cvt_pk_bf16_f32 v18, v20, v21
    v_cvt_pk_bf16_f32 v19, v22, v23
    ds_write_b128 v7, v[16:19] offset:6464
    v_cvt_pk_bf16_f32 v20, v24, v25
    v_cvt_pk_bf16_f32 v21, v26, v27
    v_cvt_pk_bf16_f32 v22, v28, v29
    v_cvt_pk_bf16_f32 v23, v30, v31
    ds_write_b128 v7, v[20:23] offset:8512
    v_cvt_pk_bf16_f32 v24, v32, v33
    v_cvt_pk_bf16_f32 v25, v34, v35
    ds_write_b64 v7, v[24:25] offset:4416
    v_cvt_pk_bf16_f32 v36, v36, v37
    v_cvt_pk_bf16_f32 v37, v38, v39
    v_cvt_pk_bf16_f32 v38, v40, v41
    v_cvt_pk_bf16_f32 v39, v42, v43
    ds_write_b128 v7, v[36:39] offset:6720
    v_cvt_pk_bf16_f32 v40, v44, v45
    v_cvt_pk_bf16_f32 v41, v46, v47
    v_cvt_pk_bf16_f32 v42, v48, v49
    v_cvt_pk_bf16_f32 v43, v50, v51
    ds_write_b128 v7, v[40:43] offset:8768
    v_cvt_pk_bf16_f32 v44, v52, v53
    v_cvt_pk_bf16_f32 v45, v54, v55
    ds_write_b64 v7, v[44:45] offset:4672
    s_mov_b64 exec, 1
    ds_add_u32 v4, v4 offset:176
    s_mov_b64 exec, -1
    s_branch L_fmkj
L_cs_43:
    s_mov_b32 s47, 1048576
L_cs_43l:
    ds_read_b32 v5, v4 offset:80
    s_waitcnt lgkmcnt(0)
    v_cmp_ne_u32 vcc, 0x9e000, v5
    s_cbranch_vccz L_cb_44
    s_sub_u32 s47, s47, 1
    s_cmp_lg_u32 s47, 0
    s_cbranch_scc1 L_cs_43l
    s_branch L_cb_44
L_cs_45:
    s_mov_b32 s47, 1048576
L_cs_45l:
    ds_read_b32 v5, v4 offset:84
    s_waitcnt lgkmcnt(0)
    v_cmp_ne_u32 vcc, 0x9e000, v5
    s_cbranch_vccz L_cb_46
    s_sub_u32 s47, s47, 1
    s_cmp_lg_u32 s47, 0
    s_cbranch_scc1 L_cs_45l
    s_branch L_cb_46
L_cs_47:
    s_mov_b32 s47, 1048576
L_cs_47l:
    ds_read_b32 v5, v4 offset:88
    s_waitcnt lgkmcnt(0)
    v_cmp_ne_u32 vcc, 0x9e000, v5
    s_cbranch_vccz L_cb_48
    s_sub_u32 s47, s47, 1
    s_cmp_lg_u32 s47, 0
    s_cbranch_scc1 L_cs_47l
    s_branch L_cb_48
L_cs_49:
    s_mov_b32 s47, 1048576
L_cs_49l:
    ds_read_b32 v5, v4 offset:92
    s_waitcnt lgkmcnt(0)
    v_cmp_ne_u32 vcc, 0x9e000, v5
    s_cbranch_vccz L_cb_50
    s_sub_u32 s47, s47, 1
    s_cmp_lg_u32 s47, 0
    s_cbranch_scc1 L_cs_49l
    s_branch L_cb_50
L_cs_51:
    s_mov_b32 s47, 1048576
L_cs_51l:
    ds_read_b32 v5, v4 offset:96
    s_waitcnt lgkmcnt(0)
    v_cmp_ne_u32 vcc, 0x9e000, v5
    s_cbranch_vccz L_cb_52
    s_sub_u32 s47, s47, 1
    s_cmp_lg_u32 s47, 0
    s_cbranch_scc1 L_cs_51l
    s_branch L_cb_52
L_cs_53:
    s_mov_b32 s47, 1048576
L_cs_53l:
    ds_read_b32 v5, v4 offset:100
    s_waitcnt lgkmcnt(0)
    v_cmp_ne_u32 vcc, 0x9e000, v5
    s_cbranch_vccz L_cb_54
    s_sub_u32 s47, s47, 1
    s_cmp_lg_u32 s47, 0
    s_cbranch_scc1 L_cs_53l
    s_branch L_cb_54
L_cs_55:
    s_mov_b32 s47, 1048576
L_cs_55l:
    ds_read_b32 v5, v4 offset:104
    s_waitcnt lgkmcnt(0)
    v_cmp_ne_u32 vcc, 0x9e000, v5
    s_cbranch_vccz L_cb_56
    s_sub_u32 s47, s47, 1
    s_cmp_lg_u32 s47, 0
    s_cbranch_scc1 L_cs_55l
    s_branch L_cb_56
L_cs_57:
    s_mov_b32 s47, 1048576
L_cs_57l:
    ds_read_b32 v5, v4 offset:108
    s_waitcnt lgkmcnt(0)
    v_cmp_ne_u32 vcc, 0x9e000, v5
    s_cbranch_vccz L_cb_58
    s_sub_u32 s47, s47, 1
    s_cmp_lg_u32 s47, 0
    s_cbranch_scc1 L_cs_57l
    s_branch L_cb_58
L_cs_59:
    s_mov_b32 s47, 1048576
L_cs_59l:
    ds_read_b32 v5, v4 offset:112
    s_waitcnt lgkmcnt(0)
    v_cmp_ne_u32 vcc, 0x9e000, v5
    s_cbranch_vccz L_cb_60
    s_sub_u32 s47, s47, 1
    s_cmp_lg_u32 s47, 0
    s_cbranch_scc1 L_cs_59l
    s_branch L_cb_60
L_cs_61:
    s_mov_b32 s47, 1048576
L_cs_61l:
    ds_read_b32 v5, v4 offset:116
    s_waitcnt lgkmcnt(0)
    v_cmp_ne_u32 vcc, 0x9e000, v5
    s_cbranch_vccz L_cb_62
    s_sub_u32 s47, s47, 1
    s_cmp_lg_u32 s47, 0
    s_cbranch_scc1 L_cs_61l
    s_branch L_cb_62
L_cs_63:
    s_mov_b32 s47, 1048576
L_cs_63l:
    ds_read_b32 v5, v4 offset:120
    s_waitcnt lgkmcnt(0)
    v_cmp_ne_u32 vcc, 0x9e000, v5
    s_cbranch_vccz L_cb_64
    s_sub_u32 s47, s47, 1
    s_cmp_lg_u32 s47, 0
    s_cbranch_scc1 L_cs_63l
    s_branch L_cb_64
L_fmk:
    v_and_b32 v1, 3, v0
    v_lshrrev_b32 v2, 4, v0
    v_bfe_u32 v3, v0, 2, 2
    v_mul_u32_u24 v3, 40, v3
    v_mov_b32 v8, 960
    v_mad_u32_u24 v3, v2, v8, v3
    v_add_u32 v3, 156928, v3
    v_mov_b32 v8, 160768
    v_cmp_eq_u32 vcc, v1, v2
    s_nop 1
    v_cndmask_b32 v3, v8, v3, vcc
    s_cmp_lt_u32 s31, 2
    s_mov_b32 s40, 0x12400
    s_mov_b32 s41, 5120
    s_cselect_b32 s40, 117056, s40
    s_cselect_b32 s41, 11584, s41
    s_mul_i32 s42, s31, 2560
    s_add_u32 s40, s40, s42
    ds_read_b64_tr_b16 v[8:9], v3 offset:640
    ds_read_b64_tr_b16 v[12:13], v3 offset:648
    v_mov_b32 v10, 0
    v_mov_b32 v11, 0
    v_mov_b32 v14, 0
    v_mov_b32 v15, 0
    v_and_b32 v1, 15, v0
    v_mul_u32_u24 v1, 80, v1
    v_mad_u32_u24 v1, v2, s41, v1
    v_add_u32 v1, s40, v1
    v_cvt_pk_bf16_f32 v16, v16, v17
    v_cvt_pk_bf16_f32 v17, v18, v19
    v_cvt_pk_bf16_f32 v18, v20, v21
    v_cvt_pk_bf16_f32 v19, v22, v23
    v_cvt_pk_bf16_f32 v20, v24, v25
    v_cvt_pk_bf16_f32 v21, v26, v27
    v_cvt_pk_bf16_f32 v22, v28, v29
    v_cvt_pk_bf16_f32 v23, v30, v31
    v_cvt_pk_bf16_f32 v24, v32, v33
    v_cvt_pk_bf16_f32 v25, v34, v35
    v_mov_b32 v26, 0
    v_mov_b32 v27, 0
    ds_read_b64_tr_b16 v[28:29], v3 offset:0
    ds_read_b64_tr_b16 v[30:31], v3 offset:160
    ds_read_b64_tr_b16 v[32:33], v3 offset:320
    ds_read_b64_tr_b16 v[34:35], v3 offset:480
    v_cvt_pk_bf16_f32 v36, v36, v37
    v_cvt_pk_bf16_f32 v37, v38, v39
    v_cvt_pk_bf16_f32 v38, v40, v41
    v_cvt_pk_bf16_f32 v39, v42, v43
    v_cvt_pk_bf16_f32 v40, v44, v45
    v_cvt_pk_bf16_f32 v41, v46, v47
    v_cvt_pk_bf16_f32 v42, v48, v49
    v_cvt_pk_bf16_f32 v43, v50, v51
    v_cvt_pk_bf16_f32 v44, v52, v53
    v_cvt_pk_bf16_f32 v45, v54, v55
    v_mov_b32 v46, 0
    v_mov_b32 v47, 0
    ds_read_b64_tr_b16 v[48:49], v3 offset:8
    ds_read_b64_tr_b16 v[50:51], v3 offset:168
    ds_read_b64_tr_b16 v[52:53], v3 offset:328
    ds_read_b64_tr_b16 v[54:55], v3 offset:488
    ds_read_b32 v5, v4 offset:248
    s_waitcnt lgkmcnt(7)
    v_mfma_f32_16x16x32_bf16 v[56:59], v[28:31], v[16:19], 0
    v_mfma_f32_16x16x32_bf16 v[76:79], v[28:31], v[36:39], 0
    ds_read_b64_tr_b16 v[28:29], v3 offset:16
    ds_read_b64_tr_b16 v[30:31], v3 offset:176
    s_waitcnt lgkmcnt(7)
    v_mfma_f32_16x16x32_bf16 v[56:59], v[32:35], v[20:23], v[56:59]
    v_mfma_f32_16x16x32_bf16 v[76:79], v[32:35], v[40:43], v[76:79]
    ds_read_b64_tr_b16 v[32:33], v3 offset:336
    ds_read_b64_tr_b16 v[34:35], v3 offset:496
    v_mfma_f32_16x16x32_bf16 v[56:59], v[8:11], v[24:27], v[56:59]
    v_mfma_f32_16x16x32_bf16 v[76:79], v[8:11], v[44:47], v[76:79]
    ds_read_b64_tr_b16 v[8:9], v3 offset:656
    s_waitcnt lgkmcnt(8)
    v_mfma_f32_16x16x32_bf16 v[60:63], v[48:51], v[16:19], 0
    v_mfma_f32_16x16x32_bf16 v[80:83], v[48:51], v[36:39], 0
    ds_read_b64_tr_b16 v[48:49], v3 offset:24
    ds_read_b64_tr_b16 v[50:51], v3 offset:184
    s_waitcnt lgkmcnt(8)
    v_mfma_f32_16x16x32_bf16 v[60:63], v[52:55], v[20:23], v[60:63]
    v_mfma_f32_16x16x32_bf16 v[80:83], v[52:55], v[40:43], v[80:83]
    ds_read_b64_tr_b16 v[52:53], v3 offset:344
    ds_read_b64_tr_b16 v[54:55], v3 offset:504
    v_mfma_f32_16x16x32_bf16 v[60:63], v[12:15], v[24:27], v[60:63]
    v_mfma_f32_16x16x32_bf16 v[80:83], v[12:15], v[44:47], v[80:83]
    ds_read_b64_tr_b16 v[12:13], v3 offset:664
    s_waitcnt lgkmcnt(8)
    v_mfma_f32_16x16x32_bf16 v[64:67], v[28:31], v[16:19], 0
    v_mfma_f32_16x16x32_bf16 v[84:87], v[28:31], v[36:39], 0
    ds_read_b64_tr_b16 v[28:29], v3 offset:32
    ds_read_b64_tr_b16 v[30:31], v3 offset:192
    s_waitcnt lgkmcnt(8)
    v_mfma_f32_16x16x32_bf16 v[64:67], v[32:35], v[20:23], v[64:67]
    v_mfma_f32_16x16x32_bf16 v[84:87], v[32:35], v[40:43], v[84:87]
    ds_read_b64_tr_b16 v[32:33], v3 offset:352
    ds_read_b64_tr_b16 v[34:35], v3 offset:512
    s_waitcnt lgkmcnt(9)
    v_mfma_f32_16x16x32_bf16 v[64:67], v[8:11], v[24:27], v[64:67]
    v_mfma_f32_16x16x32_bf16 v[84:87], v[8:11], v[44:47], v[84:87]
    ds_read_b64_tr_b16 v[8:9], v3 offset:672
    s_waitcnt lgkmcnt(8)
    v_mfma_f32_16x16x32_bf16 v[68:71], v[48:51], v[16:19], 0
    v_mfma_f32_16x16x32_bf16 v[88:91], v[48:51], v[36:39], 0
    s_waitcnt lgkmcnt(6)
    v_mfma_f32_16x16x32_bf16 v[68:71], v[52:55], v[20:23], v[68:71]
    v_mfma_f32_16x16x32_bf16 v[88:91], v[52:55], v[40:43], v[88:91]
    s_waitcnt lgkmcnt(5)
    v_mfma_f32_16x16x32_bf16 v[68:71], v[12:15], v[24:27], v[68:71]
    v_mfma_f32_16x16x32_bf16 v[88:91], v[12:15], v[44:47], v[88:91]
    s_waitcnt lgkmcnt(3)
    v_mfma_f32_16x16x32_bf16 v[72:75], v[28:31], v[16:19], 0
    v_mfma_f32_16x16x32_bf16 v[92:95], v[28:31], v[36:39], 0
    s_waitcnt lgkmcnt(1)
    v_mfma_f32_16x16x32_bf16 v[72:75], v[32:35], v[20:23], v[72:75]
    v_mfma_f32_16x16x32_bf16 v[92:95], v[32:35], v[40:43], v[92:95]
    s_waitcnt lgkmcnt(0)
    v_mfma_f32_16x16x32_bf16 v[72:75], v[8:11], v[24:27], v[72:75]
    v_mfma_f32_16x16x32_bf16 v[92:95], v[8:11], v[44:47], v[92:95]
    v_cmp_ne_u32 vcc, 0x9e000, v5
    s_cbranch_vccnz L_cs_65
L_cb_66:
    v_max3_f32 v8, v56, v57, v58
    v_min3_f32 v9, v56, v57, v58
    v_max3_f32 v8, v8, v59, v60
    v_min3_f32 v9, v9, v59, v60
    v_max3_f32 v8, v8, v61, v62
    v_min3_f32 v9, v9, v61, v62
    v_max3_f32 v8, v8, v63, v64
    v_min3_f32 v9, v9, v63, v64
    v_max3_f32 v8, v8, v65, v66
    v_min3_f32 v9, v9, v65, v66
    v_max3_f32 v8, v8, v67, v68
    v_min3_f32 v9, v9, v67, v68
    v_max3_f32 v8, v8, v69, v70
    v_min3_f32 v9, v9, v69, v70
    v_max3_f32 v8, v8, v71, v72
    v_min3_f32 v9, v9, v71, v72
    v_max3_f32 v8, v8, v73, v74
    v_min3_f32 v9, v9, v73, v74
    v_max_f32 v8, v8, v75
    v_min_f32 v9, v9, v75
    v_mul_f32 v8, 0xbfb8aa3b, v8
    v_mul_f32 v9, 0x3fb8aa3b, v9
    s_mov_b32 s44, 0x3fb8aa3b
    v_fma_f32 v16, v56, s44, v8
    v_fma_f32 v56, -v56, s44, v9
    v_fma_f32 v17, v57, s44, v8
    v_fma_f32 v57, -v57, s44, v9
    v_fma_f32 v18, v58, s44, v8
    v_fma_f32 v58, -v58, s44, v9
    v_fma_f32 v19, v59, s44, v8
    v_fma_f32 v59, -v59, s44, v9
    v_fma_f32 v20, v60, s44, v8
    v_fma_f32 v60, -v60, s44, v9
    v_fma_f32 v21, v61, s44, v8
    v_fma_f32 v61, -v61, s44, v9
    v_fma_f32 v22, v62, s44, v8
    v_fma_f32 v62, -v62, s44, v9
    v_fma_f32 v23, v63, s44, v8
    v_fma_f32 v63, -v63, s44, v9
    v_fma_f32 v24, v64, s44, v8
    v_fma_f32 v64, -v64, s44, v9
    v_fma_f32 v25, v65, s44, v8
    v_fma_f32 v65, -v65, s44, v9
    v_fma_f32 v26, v66, s44, v8
    v_fma_f32 v66, -v66, s44, v9
    v_fma_f32 v27, v67, s44, v8
    v_fma_f32 v67, -v67, s44, v9
    v_fma_f32 v28, v68, s44, v8
    v_fma_f32 v68, -v68, s44, v9
    v_fma_f32 v29, v69, s44, v8
    v_fma_f32 v69, -v69, s44, v9
    v_fma_f32 v30, v70, s44, v8
    v_fma_f32 v70, -v70, s44, v9
    v_fma_f32 v31, v71, s44, v8
    v_fma_f32 v71, -v71, s44, v9
    v_fma_f32 v32, v72, s44, v8
    v_fma_f32 v72, -v72, s44, v9
    v_fma_f32 v33, v73, s44, v8
    v_fma_f32 v73, -v73, s44, v9
    v_fma_f32 v34, v74, s44, v8
    v_fma_f32 v74, -v74, s44, v9
    v_fma_f32 v35, v75, s44, v8
    v_fma_f32 v75, -v75, s44, v9
    v_exp_f32 v16, v16
    v_exp_f32 v56, v56
    v_exp_f32 v17, v17
    v_exp_f32 v57, v57
    v_exp_f32 v18, v18
    v_exp_f32 v58, v58
    v_exp_f32 v19, v19
    v_exp_f32 v59, v59
    v_exp_f32 v20, v20
    v_exp_f32 v60, v60
    v_exp_f32 v21, v21
    v_exp_f32 v61, v61
    v_exp_f32 v22, v22
    v_exp_f32 v62, v62
    v_exp_f32 v23, v23
    v_exp_f32 v63, v63
    v_exp_f32 v24, v24
    v_exp_f32 v64, v64
    v_exp_f32 v25, v25
    v_exp_f32 v65, v65
    v_exp_f32 v26, v26
    v_exp_f32 v66, v66
    v_exp_f32 v27, v27
    v_exp_f32 v67, v67
    v_exp_f32 v28, v28
    v_exp_f32 v68, v68
    v_exp_f32 v29, v29
    v_exp_f32 v69, v69
    v_exp_f32 v30, v30
    v_exp_f32 v70, v70
    v_exp_f32 v31, v31
    v_exp_f32 v71, v71
    v_exp_f32 v32, v32
    v_exp_f32 v72, v72
    v_exp_f32 v33, v33
    v_exp_f32 v73, v73
    v_exp_f32 v34, v34
    v_exp_f32 v74, v74
    v_exp_f32 v35, v35
    v_exp_f32 v75, v75
    v_add_f32 v10, v16, v17
    v_add_f32 v11, v56, v57
    v_add_f32 v10, v10, v18
    v_add_f32 v11, v11, v58
    v_add_f32 v10, v10, v19
    v_add_f32 v11, v11, v59
    v_add_f32 v10, v10, v20
    v_add_f32 v11, v11, v60
    v_add_f32 v10, v10, v21
    v_add_f32 v11, v11, v61
    v_add_f32 v10, v10, v22
    v_add_f32 v11, v11, v62
    v_add_f32 v10, v10, v23
    v_add_f32 v11, v11, v63
    v_add_f32 v10, v10, v24
    v_add_f32 v11, v11, v64
    v_add_f32 v10, v10, v25
    v_add_f32 v11, v11, v65
    v_add_f32 v10, v10, v26
    v_add_f32 v11, v11, v66
    v_add_f32 v10, v10, v27
    v_add_f32 v11, v11, v67
    v_add_f32 v10, v10, v28
    v_add_f32 v11, v11, v68
    v_add_f32 v10, v10, v29
    v_add_f32 v11, v11, v69
    v_add_f32 v10, v10, v30
    v_add_f32 v11, v11, v70
    v_add_f32 v10, v10, v31
    v_add_f32 v11, v11, v71
    v_add_f32 v10, v10, v32
    v_add_f32 v11, v11, v72
    v_add_f32 v10, v10, v33
    v_add_f32 v11, v11, v73
    v_add_f32 v10, v10, v34
    v_add_f32 v11, v11, v74
    v_add_f32 v10, v10, v35
    v_add_f32 v11, v11, v75
    v_rcp_f32 v10, v10
    v_rcp_f32 v11, v11
    v_mul_f32 v16, v16, v10
    v_mul_f32 v17, v17, v10
    v_mul_f32 v18, v18, v10
    v_mul_f32 v19, v19, v10
    v_mul_f32 v20, v20, v10
    v_mul_f32 v21, v21, v10
    v_mul_f32 v22, v22, v10
    v_mul_f32 v23, v23, v10
    v_mul_f32 v24, v24, v10
    v_mul_f32 v25, v25, v10
    v_mul_f32 v26, v26, v10
    v_mul_f32 v27, v27, v10
    v_mul_f32 v28, v28, v10
    v_mul_f32 v29, v29, v10
    v_mul_f32 v30, v30, v10
    v_mul_f32 v31, v31, v10
    v_mul_f32 v32, v32, v10
    v_mul_f32 v33, v33, v10
    v_mul_f32 v34, v34, v10
    v_mul_f32 v35, v35, v10
    v_cvt_pk_bf16_f32 v16, v16, v17
    v_cvt_pk_bf16_f32 v17, v18, v19
    v_cvt_pk_bf16_f32 v18, v20, v21
    v_cvt_pk_bf16_f32 v19, v22, v23
    ds_write_b128 v1, v[16:19] offset:0
    v_cvt_pk_bf16_f32 v20, v24, v25
    v_cvt_pk_bf16_f32 v21, v26, v27
    v_cvt_pk_bf16_f32 v22, v28, v29
    v_cvt_pk_bf16_f32 v23, v30, v31
    ds_write_b128 v1, v[20:23] offset:16
    v_cvt_pk_bf16_f32 v24, v32, v33
    v_cvt_pk_bf16_f32 v25, v34, v35
    v_mul_f32 v56, v56, v11
    v_mul_f32 v57, v57, v11
    v_mul_f32 v58, v58, v11
    v_mul_f32 v59, v59, v11
    v_mul_f32 v60, v60, v11
    v_mul_f32 v61, v61, v11
    v_mul_f32 v62, v62, v11
    v_mul_f32 v63, v63, v11
    v_mul_f32 v64, v64, v11
    v_mul_f32 v65, v65, v11
    v_mul_f32 v66, v66, v11
    v_mul_f32 v67, v67, v11
    v_mul_f32 v68, v68, v11
    v_mul_f32 v69, v69, v11
    v_mul_f32 v70, v70, v11
    v_mul_f32 v71, v71, v11
    v_mul_f32 v72, v72, v11
    v_mul_f32 v73, v73, v11
    v_mul_f32 v74, v74, v11
    v_mul_f32 v75, v75, v11
    v_cvt_pk_bf16_f32 v26, v56, v57
    v_cvt_pk_bf16_f32 v27, v58, v59
    ds_write_b128 v1, v[24:27] offset:32
    v_cvt_pk_bf16_f32 v28, v60, v61
    v_cvt_pk_bf16_f32 v29, v62, v63
    v_cvt_pk_bf16_f32 v30, v64, v65
    v_cvt_pk_bf16_f32 v31, v66, v67
    ds_write_b128 v1, v[28:31] offset:48
    v_cvt_pk_bf16_f32 v32, v68, v69
    v_cvt_pk_bf16_f32 v33, v70, v71
    v_cvt_pk_bf16_f32 v34, v72, v73
    v_cvt_pk_bf16_f32 v35, v74, v75
    ds_write_b128 v1, v[32:35] offset:64
    v_max3_f32 v8, v76, v77, v78
    v_min3_f32 v9, v76, v77, v78
    v_max3_f32 v8, v8, v79, v80
    v_min3_f32 v9, v9, v79, v80
    v_max3_f32 v8, v8, v81, v82
    v_min3_f32 v9, v9, v81, v82
    v_max3_f32 v8, v8, v83, v84
    v_min3_f32 v9, v9, v83, v84
    v_max3_f32 v8, v8, v85, v86
    v_min3_f32 v9, v9, v85, v86
    v_max3_f32 v8, v8, v87, v88
    v_min3_f32 v9, v9, v87, v88
    v_max3_f32 v8, v8, v89, v90
    v_min3_f32 v9, v9, v89, v90
    v_max3_f32 v8, v8, v91, v92
    v_min3_f32 v9, v9, v91, v92
    v_max3_f32 v8, v8, v93, v94
    v_min3_f32 v9, v9, v93, v94
    v_max_f32 v8, v8, v95
    v_min_f32 v9, v9, v95
    v_mul_f32 v8, 0xbfb8aa3b, v8
    v_mul_f32 v9, 0x3fb8aa3b, v9
    s_mov_b32 s44, 0x3fb8aa3b
    v_fma_f32 v36, v76, s44, v8
    v_fma_f32 v76, -v76, s44, v9
    v_fma_f32 v37, v77, s44, v8
    v_fma_f32 v77, -v77, s44, v9
    v_fma_f32 v38, v78, s44, v8
    v_fma_f32 v78, -v78, s44, v9
    v_fma_f32 v39, v79, s44, v8
    v_fma_f32 v79, -v79, s44, v9
    v_fma_f32 v40, v80, s44, v8
    v_fma_f32 v80, -v80, s44, v9
    v_fma_f32 v41, v81, s44, v8
    v_fma_f32 v81, -v81, s44, v9
    v_fma_f32 v42, v82, s44, v8
    v_fma_f32 v82, -v82, s44, v9
    v_fma_f32 v43, v83, s44, v8
    v_fma_f32 v83, -v83, s44, v9
    v_fma_f32 v44, v84, s44, v8
    v_fma_f32 v84, -v84, s44, v9
    v_fma_f32 v45, v85, s44, v8
    v_fma_f32 v85, -v85, s44, v9
    v_fma_f32 v46, v86, s44, v8
    v_fma_f32 v86, -v86, s44, v9
    v_fma_f32 v47, v87, s44, v8
    v_fma_f32 v87, -v87, s44, v9
    v_fma_f32 v48, v88, s44, v8
    v_fma_f32 v88, -v88, s44, v9
    v_fma_f32 v49, v89, s44, v8
    v_fma_f32 v89, -v89, s44, v9
    v_fma_f32 v50, v90, s44, v8
    v_fma_f32 v90, -v90, s44, v9
    v_fma_f32 v51, v91, s44, v8
    v_fma_f32 v91, -v91, s44, v9
    v_fma_f32 v52, v92, s44, v8
    v_fma_f32 v92, -v92, s44, v9
    v_fma_f32 v53, v93, s44, v8
    v_fma_f32 v93, -v93, s44, v9
    v_fma_f32 v54, v94, s44, v8
    v_fma_f32 v94, -v94, s44, v9
    v_fma_f32 v55, v95, s44, v8
    v_fma_f32 v95, -v95, s44, v9
    v_exp_f32 v36, v36
    v_exp_f32 v76, v76
    v_exp_f32 v37, v37
    v_exp_f32 v77, v77
    v_exp_f32 v38, v38
    v_exp_f32 v78, v78
    v_exp_f32 v39, v39
    v_exp_f32 v79, v79
    v_exp_f32 v40, v40
    v_exp_f32 v80, v80
    v_exp_f32 v41, v41
    v_exp_f32 v81, v81
    v_exp_f32 v42, v42
    v_exp_f32 v82, v82
    v_exp_f32 v43, v43
    v_exp_f32 v83, v83
    v_exp_f32 v44, v44
    v_exp_f32 v84, v84
    v_exp_f32 v45, v45
    v_exp_f32 v85, v85
    v_exp_f32 v46, v46
    v_exp_f32 v86, v86
    v_exp_f32 v47, v47
    v_exp_f32 v87, v87
    v_exp_f32 v48, v48
    v_exp_f32 v88, v88
    v_exp_f32 v49, v49
    v_exp_f32 v89, v89
    v_exp_f32 v50, v50
    v_exp_f32 v90, v90
    v_exp_f32 v51, v51
    v_exp_f32 v91, v91
    v_exp_f32 v52, v52
    v_exp_f32 v92, v92
    v_exp_f32 v53, v53
    v_exp_f32 v93, v93
    v_exp_f32 v54, v54
    v_exp_f32 v94, v94
    v_exp_f32 v55, v55
    v_exp_f32 v95, v95
    v_add_f32 v10, v36, v37
    v_add_f32 v11, v76, v77
    v_add_f32 v10, v10, v38
    v_add_f32 v11, v11, v78
    v_add_f32 v10, v10, v39
    v_add_f32 v11, v11, v79
    v_add_f32 v10, v10, v40
    v_add_f32 v11, v11, v80
    v_add_f32 v10, v10, v41
    v_add_f32 v11, v11, v81
    v_add_f32 v10, v10, v42
    v_add_f32 v11, v11, v82
    v_add_f32 v10, v10, v43
    v_add_f32 v11, v11, v83
    v_add_f32 v10, v10, v44
    v_add_f32 v11, v11, v84
    v_add_f32 v10, v10, v45
    v_add_f32 v11, v11, v85
    v_add_f32 v10, v10, v46
    v_add_f32 v11, v11, v86
    v_add_f32 v10, v10, v47
    v_add_f32 v11, v11, v87
    v_add_f32 v10, v10, v48
    v_add_f32 v11, v11, v88
    v_add_f32 v10, v10, v49
    v_add_f32 v11, v11, v89
    v_add_f32 v10, v10, v50
    v_add_f32 v11, v11, v90
    v_add_f32 v10, v10, v51
    v_add_f32 v11, v11, v91
    v_add_f32 v10, v10, v52
    v_add_f32 v11, v11, v92
    v_add_f32 v10, v10, v53
    v_add_f32 v11, v11, v93
    v_add_f32 v10, v10, v54
    v_add_f32 v11, v11, v94
    v_add_f32 v10, v10, v55
    v_add_f32 v11, v11, v95
    v_rcp_f32 v10, v10
    v_rcp_f32 v11, v11
    v_mul_f32 v36, v36, v10
    v_mul_f32 v37, v37, v10
    v_mul_f32 v38, v38, v10
    v_mul_f32 v39, v39, v10
    v_mul_f32 v40, v40, v10
    v_mul_f32 v41, v41, v10
    v_mul_f32 v42, v42, v10
    v_mul_f32 v43, v43, v10
    v_mul_f32 v44, v44, v10
    v_mul_f32 v45, v45, v10
    v_mul_f32 v46, v46, v10
    v_mul_f32 v47, v47, v10
    v_mul_f32 v48, v48, v10
    v_mul_f32 v49, v49, v10
    v_mul_f32 v50, v50, v10
    v_mul_f32 v51, v51, v10
    v_mul_f32 v52, v52, v10
    v_mul_f32 v53, v53, v10
    v_mul_f32 v54, v54, v10
    v_mul_f32 v55, v55, v10
    v_cvt_pk_bf16_f32 v36, v36, v37
    v_cvt_pk_bf16_f32 v37, v38, v39
    v_cvt_pk_bf16_f32 v38, v40, v41
    v_cvt_pk_bf16_f32 v39, v42, v43
    ds_write_b128 v1, v[36:39] offset:1280
    v_cvt_pk_bf16_f32 v40, v44, v45
    v_cvt_pk_bf16_f32 v41, v46, v47
    v_cvt_pk_bf16_f32 v42, v48, v49
    v_cvt_pk_bf16_f32 v43, v50, v51
    ds_write_b128 v1, v[40:43] offset:1296
    v_cvt_pk_bf16_f32 v44, v52, v53
    v_cvt_pk_bf16_f32 v45, v54, v55
    v_mul_f32 v76, v76, v11
    v_mul_f32 v77, v77, v11
    v_mul_f32 v78, v78, v11
    v_mul_f32 v79, v79, v11
    v_mul_f32 v80, v80, v11
    v_mul_f32 v81, v81, v11
    v_mul_f32 v82, v82, v11
    v_mul_f32 v83, v83, v11
    v_mul_f32 v84, v84, v11
    v_mul_f32 v85, v85, v11
    v_mul_f32 v86, v86, v11
    v_mul_f32 v87, v87, v11
    v_mul_f32 v88, v88, v11
    v_mul_f32 v89, v89, v11
    v_mul_f32 v90, v90, v11
    v_mul_f32 v91, v91, v11
    v_mul_f32 v92, v92, v11
    v_mul_f32 v93, v93, v11
    v_mul_f32 v94, v94, v11
    v_mul_f32 v95, v95, v11
    v_cvt_pk_bf16_f32 v46, v76, v77
    v_cvt_pk_bf16_f32 v47, v78, v79
    ds_write_b128 v1, v[44:47] offset:1312
    v_cvt_pk_bf16_f32 v48, v80, v81
    v_cvt_pk_bf16_f32 v49, v82, v83
    v_cvt_pk_bf16_f32 v50, v84, v85
    v_cvt_pk_bf16_f32 v51, v86, v87
    ds_write_b128 v1, v[48:51] offset:1328
    v_cvt_pk_bf16_f32 v52, v88, v89
    v_cvt_pk_bf16_f32 v53, v90, v91
    v_cvt_pk_bf16_f32 v54, v92, v93
    v_cvt_pk_bf16_f32 v55, v94, v95
    ds_write_b128 v1, v[52:55] offset:1344
    s_mov_b64 exec, 1
    ds_add_u32 v4, v4 offset:176
    s_mov_b64 exec, -1
    v_add_u32 v1, 45056, v6
    s_nop 1
L_fmkj:
    ds_read_b64_tr_b16 v[8:9], v6 offset:0
    ds_read_b64_tr_b16 v[10:11], v6 offset:2560
    ds_read_b64_tr_b16 v[56:57], v6 offset:8
    ds_read_b64_tr_b16 v[58:59], v6 offset:2568
    ds_read_b64_tr_b16 v[60:61], v6 offset:16
    ds_read_b64_tr_b16 v[62:63], v6 offset:2576
    ds_read_b64_tr_b16 v[64:65], v6 offset:24
    ds_read_b64_tr_b16 v[66:67], v6 offset:2584
    ds_read_b64_tr_b16 v[68:69], v6 offset:32
    ds_read_b64_tr_b16 v[70:71], v6 offset:2592
    ds_read_b64_tr_b16 v[72:73], v6 offset:5120
    ds_read_b64_tr_b16 v[74:75], v6 offset:7680
    ds_read_b64_tr_b16 v[76:77], v6 offset:5128
    ds_read_b64_tr_b16 v[78:79], v6 offset:7688
    ds_read_b64_tr_b16 v[80:81], v6 offset:5136
    s_waitcnt lgkmcnt(13)
    v_mfma_f32_16x16x32_bf16 v[16:19], v[8:11], v[96:99], 0
    ds_read_b64_tr_b16 v[82:83], v6 offset:7696
    v_mfma_f32_16x16x32_bf16 v[36:39], v[8:11], v[100:103], 0
    ds_read_b64_tr_b16 v[12:13], v6 offset:5144
    ds_read_b64_tr_b16 v[14:15], v6 offset:7704
    ds_read_b32 v5, v4 offset:124
    s_waitcnt lgkmcnt(13)
    v_mfma_f32_16x16x32_bf16 v[20:23], v[56:59], v[96:99], 0
    v_mfma_f32_16x16x32_bf16 v[40:43], v[56:59], v[100:103], 0
    ds_read_b64_tr_b16 v[8:9], v6 offset:5152
    v_mfma_f32_16x16x32_bf16 v[24:27], v[60:63], v[96:99], 0
    ds_read_b64_tr_b16 v[10:11], v6 offset:7712
    v_mfma_f32_16x16x32_bf16 v[44:47], v[60:63], v[100:103], 0
    s_waitcnt lgkmcnt(2)
    v_cmp_ne_u32 vcc, 0x9e000, v5
    s_cbranch_vccnz L_cs_67
L_cb_68:
    ds_read_b64_tr_b16 v[56:57], v6 offset:40960
    v_mfma_f32_16x16x32_bf16 v[28:31], v[64:67], v[96:99], 0
    ds_read_b64_tr_b16 v[58:59], v6 offset:43520
    v_mfma_f32_16x16x32_bf16 v[48:51], v[64:67], v[100:103], 0
    ds_read_b64_tr_b16 v[60:61], v6 offset:40968
    v_mfma_f32_16x16x32_bf16 v[32:35], v[68:71], v[96:99], 0
    ds_read_b64_tr_b16 v[62:63], v6 offset:43528
    v_mfma_f32_16x16x32_bf16 v[52:55], v[68:71], v[100:103], 0
    ds_read_b64_tr_b16 v[64:65], v6 offset:40976
    v_mfma_f32_16x16x32_bf16 v[16:19], v[72:75], v[104:107], v[16:19]
    ds_read_b64_tr_b16 v[66:67], v6 offset:43536
    v_mfma_f32_16x16x32_bf16 v[36:39], v[72:75], v[108:111], v[36:39]
    ds_read_b64_tr_b16 v[68:69], v6 offset:40984
    v_mfma_f32_16x16x32_bf16 v[20:23], v[76:79], v[104:107], v[20:23]
    ds_read_b64_tr_b16 v[70:71], v6 offset:43544
    v_mfma_f32_16x16x32_bf16 v[40:43], v[76:79], v[108:111], v[40:43]
    ds_read_b64_tr_b16 v[72:73], v6 offset:40992
    v_mfma_f32_16x16x32_bf16 v[24:27], v[80:83], v[104:107], v[24:27]
    ds_read_b64_tr_b16 v[74:75], v6 offset:43552
    v_mfma_f32_16x16x32_bf16 v[44:47], v[80:83], v[108:111], v[44:47]
    ds_read_b64_tr_b16 v[76:77], v1 offset:1024
    v_mfma_f32_16x16x32_bf16 v[28:31], v[12:15], v[104:107], v[28:31]
    ds_read_b64_tr_b16 v[78:79], v1 offset:3584
    v_mfma_f32_16x16x32_bf16 v[48:51], v[12:15], v[108:111], v[48:51]
    ds_read_b64_tr_b16 v[80:81], v1 offset:1032
    s_waitcnt lgkmcnt(13)
    v_mfma_f32_16x16x32_bf16 v[32:35], v[8:11], v[104:107], v[32:35]
    ds_read_b64_tr_b16 v[82:83], v1 offset:3592
    v_mfma_f32_16x16x32_bf16 v[52:55], v[8:11], v[108:111], v[52:55]
    ds_read_b64_tr_b16 v[12:13], v1 offset:1040
    s_waitcnt lgkmcnt(13)
    v_mfma_f32_16x16x32_bf16 v[16:19], v[56:59], v[112:115], v[16:19]
    ds_read_b64_tr_b16 v[14:15], v1 offset:3600
    v_mfma_f32_16x16x32_bf16 v[36:39], v[56:59], v[116:119], v[36:39]
    ds_read_b64_tr_b16 v[8:9], v1 offset:1048
    s_waitcnt lgkmcnt(13)
    v_mfma_f32_16x16x32_bf16 v[20:23], v[60:63], v[112:115], v[20:23]
    ds_read_b64_tr_b16 v[10:11], v1 offset:3608
    v_mfma_f32_16x16x32_bf16 v[40:43], v[60:63], v[116:119], v[40:43]
    ds_read_b64_tr_b16 v[56:57], v1 offset:1056
    s_waitcnt lgkmcnt(13)
    v_mfma_f32_16x16x32_bf16 v[24:27], v[64:67], v[112:115], v[24:27]
    ds_read_b64_tr_b16 v[58:59], v1 offset:3616
    v_mfma_f32_16x16x32_bf16 v[44:47], v[64:67], v[116:119], v[44:47]
    ds_read_b64_tr_b16 v[60:61], v6 offset:10240
    s_waitcnt lgkmcnt(13)
    v_mfma_f32_16x16x32_bf16 v[28:31], v[68:71], v[112:115], v[28:31]
    ds_read_b64_tr_b16 v[62:63], v6 offset:12800
    v_mfma_f32_16x16x32_bf16 v[48:51], v[68:71], v[116:119], v[48:51]
    ds_read_b64_tr_b16 v[64:65], v6 offset:10248
    s_waitcnt lgkmcnt(13)
    v_mfma_f32_16x16x32_bf16 v[32:35], v[72:75], v[112:115], v[32:35]
    ds_read_b64_tr_b16 v[66:67], v6 offset:12808
    v_mfma_f32_16x16x32_bf16 v[52:55], v[72:75], v[116:119], v[52:55]
    ds_read_b64_tr_b16 v[68:69], v6 offset:10256
    s_waitcnt lgkmcnt(13)
    v_mfma_f32_16x16x32_bf16 v[16:19], v[76:79], v[120:123], v[16:19]
    ds_read_b64_tr_b16 v[70:71], v6 offset:12816
    v_mfma_f32_16x16x32_bf16 v[36:39], v[76:79], v[124:127], v[36:39]
    ds_read_b64_tr_b16 v[72:73], v6 offset:10264
    s_waitcnt lgkmcnt(13)
    v_mfma_f32_16x16x32_bf16 v[20:23], v[80:83], v[120:123], v[20:23]
    ds_read_b64_tr_b16 v[74:75], v6 offset:12824
    v_mfma_f32_16x16x32_bf16 v[40:43], v[80:83], v[124:127], v[40:43]
    ds_read_b64_tr_b16 v[76:77], v6 offset:10272
    s_waitcnt lgkmcnt(13)
    v_mfma_f32_16x16x32_bf16 v[24:27], v[12:15], v[120:123], v[24:27]
    ds_read_b64_tr_b16 v[78:79], v6 offset:12832
    v_mfma_f32_16x16x32_bf16 v[44:47], v[12:15], v[124:127], v[44:47]
    ds_read_b64_tr_b16 v[80:81], v6 offset:15360
    s_waitcnt lgkmcnt(13)
    v_mfma_f32_16x16x32_bf16 v[28:31], v[8:11], v[120:123], v[28:31]
    ds_read_b64_tr_b16 v[82:83], v6 offset:17920
    v_mfma_f32_16x16x32_bf16 v[48:51], v[8:11], v[124:127], v[48:51]
    ds_read_b64_tr_b16 v[12:13], v6 offset:15368
    s_waitcnt lgkmcnt(13)
    v_mfma_f32_16x16x32_bf16 v[32:35], v[56:59], v[120:123], v[32:35]
    ds_read_b64_tr_b16 v[14:15], v6 offset:17928
    v_mfma_f32_16x16x32_bf16 v[52:55], v[56:59], v[124:127], v[52:55]
    ds_read_b64_tr_b16 v[8:9], v6 offset:15376
    s_waitcnt lgkmcnt(13)
    v_mfma_f32_16x16x32_bf16 v[16:19], v[60:63], v[128:131], v[16:19]
    ds_read_b64_tr_b16 v[10:11], v6 offset:17936
    v_mfma_f32_16x16x32_bf16 v[36:39], v[60:63], v[132:135], v[36:39]
    ds_read_b64_tr_b16 v[56:57], v6 offset:15384
    s_waitcnt lgkmcnt(13)
    v_mfma_f32_16x16x32_bf16 v[20:23], v[64:67], v[128:131], v[20:23]
    ds_read_b64_tr_b16 v[58:59], v6 offset:17944
    v_mfma_f32_16x16x32_bf16 v[40:43], v[64:67], v[132:135], v[40:43]
    ds_read_b64_tr_b16 v[60:61], v6 offset:15392
    s_waitcnt lgkmcnt(13)
    v_mfma_f32_16x16x32_bf16 v[24:27], v[68:71], v[128:131], v[24:27]
    ds_read_b64_tr_b16 v[62:63], v6 offset:17952
    v_mfma_f32_16x16x32_bf16 v[44:47], v[68:71], v[132:135], v[44:47]
    ds_read_b64_tr_b16 v[64:65], v6 offset:20480
    s_waitcnt lgkmcnt(13)
    v_mfma_f32_16x16x32_bf16 v[28:31], v[72:75], v[128:131], v[28:31]
    ds_read_b64_tr_b16 v[66:67], v6 offset:23040
    v_mfma_f32_16x16x32_bf16 v[48:51], v[72:75], v[132:135], v[48:51]
    ds_read_b64_tr_b16 v[68:69], v6 offset:20488
    s_waitcnt lgkmcnt(13)
    v_mfma_f32_16x16x32_bf16 v[32:35], v[76:79], v[128:131], v[32:35]
    ds_read_b64_tr_b16 v[70:71], v6 offset:23048
    v_mfma_f32_16x16x32_bf16 v[52:55], v[76:79], v[132:135], v[52:55]
    ds_read_b64_tr_b16 v[72:73], v6 offset:20496
    s_waitcnt lgkmcnt(13)
    v_mfma_f32_16x16x32_bf16 v[16:19], v[80:83], v[136:139], v[16:19]
    ds_read_b64_tr_b16 v[74:75], v6 offset:23056
    v_mfma_f32_16x16x32_bf16 v[36:39], v[80:83], v[140:143], v[36:39]
    ds_read_b64_tr_b16 v[76:77], v6 offset:20504
    s_waitcnt lgkmcnt(13)
    v_mfma_f32_16x16x32_bf16 v[20:23], v[12:15], v[136:139], v[20:23]
    ds_read_b64_tr_b16 v[78:79], v6 offset:23064
    v_mfma_f32_16x16x32_bf16 v[40:43], v[12:15], v[140:143], v[40:43]
    ds_read_b64_tr_b16 v[80:81], v6 offset:20512
    s_waitcnt lgkmcnt(13)
    v_mfma_f32_16x16x32_bf16 v[24:27], v[8:11], v[136:139], v[24:27]
    ds_read_b64_tr_b16 v[82:83], v6 offset:23072
    v_mfma_f32_16x16x32_bf16 v[44:47], v[8:11], v[140:143], v[44:47]
    ds_read_b64_tr_b16 v[12:13], v6 offset:25600
    s_waitcnt lgkmcnt(13)
    v_mfma_f32_16x16x32_bf16 v[28:31], v[56:59], v[136:139], v[28:31]
    ds_read_b64_tr_b16 v[14:15], v6 offset:28160
    v_mfma_f32_16x16x32_bf16 v[48:51], v[56:59], v[140:143], v[48:51]
    ds_read_b64_tr_b16 v[8:9], v6 offset:25608
    s_waitcnt lgkmcnt(13)
    v_mfma_f32_16x16x32_bf16 v[32:35], v[60:63], v[136:139], v[32:35]
    ds_read_b64_tr_b16 v[10:11], v6 offset:28168
    v_mfma_f32_16x16x32_bf16 v[52:55], v[60:63], v[140:143], v[52:55]
    ds_read_b64_tr_b16 v[56:57], v6 offset:25616
    s_waitcnt lgkmcnt(13)
    v_mfma_f32_16x16x32_bf16 v[16:19], v[64:67], v[144:147], v[16:19]
    ds_read_b64_tr_b16 v[58:59], v6 offset:28176
    v_mfma_f32_16x16x32_bf16 v[36:39], v[64:67], v[148:151], v[36:39]
    ds_read_b64_tr_b16 v[60:61], v6 offset:25624
    ds_read_b64_tr_b16 v[62:63], v6 offset:28184
    ds_read_b32 v5, v4 offset:144
    s_waitcnt lgkmcnt(13)
    v_mfma_f32_16x16x32_bf16 v[20:23], v[68:71], v[144:147], v[20:23]
    v_mfma_f32_16x16x32_bf16 v[40:43], v[68:71], v[148:151], v[40:43]
    ds_read_b64_tr_b16 v[64:65], v6 offset:25632
    v_mfma_f32_16x16x32_bf16 v[24:27], v[72:75], v[144:147], v[24:27]
    ds_read_b64_tr_b16 v[66:67], v6 offset:28192
    v_mfma_f32_16x16x32_bf16 v[44:47], v[72:75], v[148:151], v[44:47]
    s_waitcnt lgkmcnt(2)
    v_cmp_ne_u32 vcc, 0x9e000, v5
    s_cbranch_vccnz L_cs_69
L_cb_70:
    ds_read_b64_tr_b16 v[68:69], v6 offset:30720
    v_mfma_f32_16x16x32_bf16 v[28:31], v[76:79], v[144:147], v[28:31]
    ds_read_b64_tr_b16 v[70:71], v6 offset:33280
    v_mfma_f32_16x16x32_bf16 v[48:51], v[76:79], v[148:151], v[48:51]
    ds_read_b64_tr_b16 v[72:73], v6 offset:30728
    v_mfma_f32_16x16x32_bf16 v[32:35], v[80:83], v[144:147], v[32:35]
    ds_read_b64_tr_b16 v[74:75], v6 offset:33288
    v_mfma_f32_16x16x32_bf16 v[52:55], v[80:83], v[148:151], v[52:55]
    ds_read_b64_tr_b16 v[76:77], v6 offset:30736
    v_mfma_f32_16x16x32_bf16 v[16:19], v[12:15], v[152:155], v[16:19]
    ds_read_b64_tr_b16 v[78:79], v6 offset:33296
    v_mfma_f32_16x16x32_bf16 v[36:39], v[12:15], v[156:159], v[36:39]
    ds_read_b64_tr_b16 v[80:81], v6 offset:30744
    v_mfma_f32_16x16x32_bf16 v[20:23], v[8:11], v[152:155], v[20:23]
    ds_read_b64_tr_b16 v[82:83], v6 offset:33304
    v_mfma_f32_16x16x32_bf16 v[40:43], v[8:11], v[156:159], v[40:43]
    ds_read_b64_tr_b16 v[12:13], v6 offset:30752
    v_mfma_f32_16x16x32_bf16 v[24:27], v[56:59], v[152:155], v[24:27]
    ds_read_b64_tr_b16 v[14:15], v6 offset:33312
    v_mfma_f32_16x16x32_bf16 v[44:47], v[56:59], v[156:159], v[44:47]
    ds_read_b64_tr_b16 v[8:9], v6 offset:35840
    v_mfma_f32_16x16x32_bf16 v[28:31], v[60:63], v[152:155], v[28:31]
    ds_read_b64_tr_b16 v[10:11], v6 offset:38400
    v_mfma_f32_16x16x32_bf16 v[48:51], v[60:63], v[156:159], v[48:51]
    ds_read_b64_tr_b16 v[56:57], v6 offset:35848
    s_waitcnt lgkmcnt(13)
    v_mfma_f32_16x16x32_bf16 v[32:35], v[64:67], v[152:155], v[32:35]
    ds_read_b64_tr_b16 v[58:59], v6 offset:38408
    v_mfma_f32_16x16x32_bf16 v[52:55], v[64:67], v[156:159], v[52:55]
    ds_read_b64_tr_b16 v[60:61], v6 offset:35856
    s_waitcnt lgkmcnt(13)
    v_mfma_f32_16x16x32_bf16 v[16:19], v[68:71], v[160:163], v[16:19]
    ds_read_b64_tr_b16 v[62:63], v6 offset:38416
    v_mfma_f32_16x16x32_bf16 v[36:39], v[68:71], v[164:167], v[36:39]
    ds_read_b64_tr_b16 v[64:65], v6 offset:35864
    s_waitcnt lgkmcnt(13)
    v_mfma_f32_16x16x32_bf16 v[20:23], v[72:75], v[160:163], v[20:23]
    ds_read_b64_tr_b16 v[66:67], v6 offset:38424
    v_mfma_f32_16x16x32_bf16 v[40:43], v[72:75], v[164:167], v[40:43]
    ds_read_b64_tr_b16 v[68:69], v6 offset:35872
    s_waitcnt lgkmcnt(13)
    v_mfma_f32_16x16x32_bf16 v[24:27], v[76:79], v[160:163], v[24:27]
    ds_read_b64_tr_b16 v[70:71], v6 offset:38432
    v_mfma_f32_16x16x32_bf16 v[44:47], v[76:79], v[164:167], v[44:47]
    ds_read_b64_tr_b16 v[72:73], v1 offset:12288
    s_waitcnt lgkmcnt(13)
    v_mfma_f32_16x16x32_bf16 v[28:31], v[80:83], v[160:163], v[28:31]
    ds_read_b64_tr_b16 v[74:75], v1 offset:14848
    v_mfma_f32_16x16x32_bf16 v[48:51], v[80:83], v[164:167], v[48:51]
    ds_read_b64_tr_b16 v[76:77], v1 offset:12296
    s_waitcnt lgkmcnt(13)
    v_mfma_f32_16x16x32_bf16 v[32:35], v[12:15], v[160:163], v[32:35]
    ds_read_b64_tr_b16 v[78:79], v1 offset:14856
    v_mfma_f32_16x16x32_bf16 v[52:55], v[12:15], v[164:167], v[52:55]
    ds_read_b64_tr_b16 v[80:81], v1 offset:12304
    s_waitcnt lgkmcnt(13)
    v_mfma_f32_16x16x32_bf16 v[16:19], v[8:11], v[168:171], v[16:19]
    ds_read_b64_tr_b16 v[82:83], v1 offset:14864
    v_mfma_f32_16x16x32_bf16 v[36:39], v[8:11], v[172:175], v[36:39]
    ds_read_b64_tr_b16 v[12:13], v1 offset:12312
    s_waitcnt lgkmcnt(13)
    v_mfma_f32_16x16x32_bf16 v[20:23], v[56:59], v[168:171], v[20:23]
    ds_read_b64_tr_b16 v[14:15], v1 offset:14872
    v_mfma_f32_16x16x32_bf16 v[40:43], v[56:59], v[172:175], v[40:43]
    ds_read_b64_tr_b16 v[8:9], v1 offset:12320
    s_waitcnt lgkmcnt(13)
    v_mfma_f32_16x16x32_bf16 v[24:27], v[60:63], v[168:171], v[24:27]
    ds_read_b64_tr_b16 v[10:11], v1 offset:14880
    v_mfma_f32_16x16x32_bf16 v[44:47], v[60:63], v[172:175], v[44:47]
    ds_read_b64_tr_b16 v[56:57], v1 offset:17408
    s_waitcnt lgkmcnt(13)
    v_mfma_f32_16x16x32_bf16 v[28:31], v[64:67], v[168:171], v[28:31]
    ds_read_b64_tr_b16 v[58:59], v1 offset:19968
    v_mfma_f32_16x16x32_bf16 v[48:51], v[64:67], v[172:175], v[48:51]
    ds_read_b64_tr_b16 v[60:61], v1 offset:17416
    s_waitcnt lgkmcnt(13)
    v_mfma_f32_16x16x32_bf16 v[32:35], v[68:71], v[168:171], v[32:35]
    ds_read_b64_tr_b16 v[62:63], v1 offset:19976
    v_mfma_f32_16x16x32_bf16 v[52:55], v[68:71], v[172:175], v[52:55]
    ds_read_b64_tr_b16 v[64:65], v1 offset:17424
    s_waitcnt lgkmcnt(13)
    v_mfma_f32_16x16x32_bf16 v[16:19], v[72:75], v[176:179], v[16:19]
    ds_read_b64_tr_b16 v[66:67], v1 offset:19984
    v_mfma_f32_16x16x32_bf16 v[36:39], v[72:75], v[180:183], v[36:39]
    ds_read_b64_tr_b16 v[68:69], v1 offset:17432
    ds_read_b64_tr_b16 v[70:71], v1 offset:19992
    ds_read_b32 v5, v4 offset:148
    s_waitcnt lgkmcnt(13)
    v_mfma_f32_16x16x32_bf16 v[20:23], v[76:79], v[176:179], v[20:23]
    v_mfma_f32_16x16x32_bf16 v[40:43], v[76:79], v[180:183], v[40:43]
    ds_read_b64_tr_b16 v[72:73], v1 offset:17440
    v_mfma_f32_16x16x32_bf16 v[24:27], v[80:83], v[176:179], v[24:27]
    ds_read_b64_tr_b16 v[74:75], v1 offset:20000
    v_mfma_f32_16x16x32_bf16 v[44:47], v[80:83], v[180:183], v[44:47]
    s_mov_b64 exec, 1
    ds_add_u32 v4, v4 offset:272
    s_mov_b64 exec, -1
    s_waitcnt lgkmcnt(3)
    v_cmp_ne_u32 vcc, 0x9e000, v5
    s_cbranch_vccnz L_cs_71
L_cb_72:
    ds_read_b64_tr_b16 v[76:77], v1 offset:6144
    v_mfma_f32_16x16x32_bf16 v[28:31], v[12:15], v[176:179], v[28:31]
    ds_read_b64_tr_b16 v[78:79], v1 offset:8704
    v_mfma_f32_16x16x32_bf16 v[48:51], v[12:15], v[180:183], v[48:51]
    ds_read_b64_tr_b16 v[80:81], v1 offset:6152
    v_mfma_f32_16x16x32_bf16 v[32:35], v[8:11], v[176:179], v[32:35]
    ds_read_b64_tr_b16 v[82:83], v1 offset:8712
    v_mfma_f32_16x16x32_bf16 v[52:55], v[8:11], v[180:183], v[52:55]
    ds_read_b64_tr_b16 v[12:13], v1 offset:6160
    v_mfma_f32_16x16x32_bf16 v[16:19], v[56:59], v[184:187], v[16:19]
    ds_read_b64_tr_b16 v[14:15], v1 offset:8720
    v_mfma_f32_16x16x32_bf16 v[36:39], v[56:59], v[188:191], v[36:39]
    ds_read_b64_tr_b16 v[8:9], v1 offset:6168
    v_mfma_f32_16x16x32_bf16 v[20:23], v[60:63], v[184:187], v[20:23]
    ds_read_b64_tr_b16 v[10:11], v1 offset:8728
    v_mfma_f32_16x16x32_bf16 v[40:43], v[60:63], v[188:191], v[40:43]
    ds_read_b64_tr_b16 v[56:57], v1 offset:6176
    v_mfma_f32_16x16x32_bf16 v[24:27], v[64:67], v[184:187], v[24:27]
    ds_read_b64_tr_b16 v[58:59], v1 offset:8736
    v_mfma_f32_16x16x32_bf16 v[44:47], v[64:67], v[188:191], v[44:47]
    ds_read_b64_tr_b16 v[60:61], v1 offset:22528
    v_mfma_f32_16x16x32_bf16 v[28:31], v[68:71], v[184:187], v[28:31]
    ds_read_b64_tr_b16 v[62:63], v1 offset:25088
    v_mfma_f32_16x16x32_bf16 v[48:51], v[68:71], v[188:191], v[48:51]
    ds_read_b64_tr_b16 v[84:85], v1 offset:22536
    s_waitcnt lgkmcnt(14)
    v_mfma_f32_16x16x32_bf16 v[32:35], v[72:75], v[184:187], v[32:35]
    ds_read_b64_tr_b16 v[86:87], v1 offset:25096
    v_mfma_f32_16x16x32_bf16 v[52:55], v[72:75], v[188:191], v[52:55]
    ds_read_b64_tr_b16 v[88:89], v1 offset:22544
    s_waitcnt lgkmcnt(13)
    v_mfma_f32_16x16x32_bf16 v[16:19], v[76:79], v[192:195], v[16:19]
    ds_read_b64_tr_b16 v[90:91], v1 offset:25104
    v_mfma_f32_16x16x32_bf16 v[36:39], v[76:79], v[196:199], v[36:39]
    ds_read_b64_tr_b16 v[72:73], v1 offset:22552
    s_waitcnt lgkmcnt(13)
    v_mfma_f32_16x16x32_bf16 v[20:23], v[80:83], v[192:195], v[20:23]
    ds_read_b64_tr_b16 v[74:75], v1 offset:25112
    v_mfma_f32_16x16x32_bf16 v[40:43], v[80:83], v[196:199], v[40:43]
    ds_read_b64_tr_b16 v[76:77], v1 offset:22560
    s_waitcnt lgkmcnt(13)
    v_mfma_f32_16x16x32_bf16 v[24:27], v[12:15], v[192:195], v[24:27]
    ds_read_b64_tr_b16 v[78:79], v1 offset:25120
    v_mfma_f32_16x16x32_bf16 v[44:47], v[12:15], v[196:199], v[44:47]
    ds_read_b64_tr_b16 v[80:81], v1 offset:55296
    s_waitcnt lgkmcnt(13)
    v_mfma_f32_16x16x32_bf16 v[28:31], v[8:11], v[192:195], v[28:31]
    ds_read_b64_tr_b16 v[82:83], v1 offset:57856
    v_mfma_f32_16x16x32_bf16 v[48:51], v[8:11], v[196:199], v[48:51]
    ds_read_b64_tr_b16 v[12:13], v1 offset:55304
    s_waitcnt lgkmcnt(13)
    v_mfma_f32_16x16x32_bf16 v[32:35], v[56:59], v[192:195], v[32:35]
    ds_read_b64_tr_b16 v[14:15], v1 offset:57864
    v_mfma_f32_16x16x32_bf16 v[52:55], v[56:59], v[196:199], v[52:55]
    ds_read_b64_tr_b16 v[8:9], v1 offset:55312
    s_waitcnt lgkmcnt(13)
    v_mfma_f32_16x16x32_bf16 v[16:19], v[60:63], v[200:203], v[16:19]
    ds_read_b64_tr_b16 v[10:11], v1 offset:57872
    v_and_b32 v64, 31, v0
    v_mfma_f32_16x16x32_bf16 v[36:39], v[60:63], v[204:207], v[36:39]
    v_lshrrev_b32 v65, 5, v0
    v_lshlrev_b32 v69, 4, v64
    ds_read_b64_tr_b16 v[56:57], v1 offset:55320
    s_waitcnt lgkmcnt(13)
    v_mfma_f32_16x16x32_bf16 v[20:23], v[84:87], v[200:203], v[20:23]
    ds_read_b64_tr_b16 v[58:59], v1 offset:57880
    v_lshl_add_u32 v68, v65, 11, v69
    v_mfma_f32_16x16x32_bf16 v[40:43], v[84:87], v[204:207], v[40:43]
    v_bfe_u32 v66, v0, 2, 2
    v_lshl_add_u32 v66, v65, 2, v66
    ds_read_b64_tr_b16 v[60:61], v1 offset:55328
    s_waitcnt lgkmcnt(13)
    v_mfma_f32_16x16x32_bf16 v[24:27], v[88:91], v[200:203], v[24:27]
    ds_read_b64_tr_b16 v[62:63], v1 offset:57888
    v_and_b32 v67, 1, v0
    v_mfma_f32_16x16x32_bf16 v[44:47], v[88:91], v[204:207], v[44:47]
    v_mul_u32_u24 v67, 2176, v67
    v_bfe_u32 v70, v0, 1, 1
    ds_read_b64_tr_b16 v[84:85], v1 offset:60416
    s_waitcnt lgkmcnt(13)
    v_mfma_f32_16x16x32_bf16 v[28:31], v[72:75], v[200:203], v[28:31]
    ds_read_b64_tr_b16 v[86:87], v1 offset:62976
    v_lshl_add_u32 v67, v70, 3, v67
    v_mfma_f32_16x16x32_bf16 v[48:51], v[72:75], v[204:207], v[48:51]
    v_mov_b32 v70, 4424
    s_mov_b32 s78, 0xffff0000
    ds_read_b64_tr_b16 v[88:89], v1 offset:60424
    s_waitcnt lgkmcnt(13)
    v_mfma_f32_16x16x32_bf16 v[32:35], v[76:79], v[200:203], v[32:35]
    ds_read_b64_tr_b16 v[90:91], v1 offset:62984
    s_mov_b32 s79, 0xffff0000
    v_mfma_f32_16x16x32_bf16 v[52:55], v[76:79], v[204:207], v[52:55]
    v_cndmask_b32 v67, v67, v70, s[78:79]
    v_lshl_add_u32 v70, v66, 4, v67
    ds_read_b64_tr_b16 v[72:73], v1 offset:60432
    s_waitcnt lgkmcnt(13)
    v_mfma_f32_16x16x32_bf16 v[16:19], v[80:83], v[208:211], v[16:19]
    ds_read_b64_tr_b16 v[74:75], v1 offset:62992
    v_lshl_add_u32 v71, v65, 6, v4
    v_mfma_f32_16x16x32_bf16 v[36:39], v[80:83], v[212:215], v[36:39]
    s_mov_b32 s78, 0xeeee0000
    s_mov_b32 s79, 0xeeee0000
    ds_read_b64_tr_b16 v[76:77], v1 offset:60440
    ds_read_b64_tr_b16 v[78:79], v1 offset:63000
    ds_read_b32 v5, v4 offset:152
    s_waitcnt lgkmcnt(13)
    v_mfma_f32_16x16x32_bf16 v[20:23], v[12:15], v[208:211], v[20:23]
    s_mul_i32 s40, s37, 6144
    v_mfma_f32_16x16x32_bf16 v[40:43], v[12:15], v[212:215], v[40:43]
    s_add_u32 s40, s40, 43008
    v_add_u32 v96, s40, v69
    ds_read_b64_tr_b16 v[80:81], v1 offset:60448
    v_mfma_f32_16x16x32_bf16 v[24:27], v[8:11], v[208:211], v[24:27]
    ds_read_b64_tr_b16 v[82:83], v1 offset:63008
    v_add_u32 v97, s40, v68
    v_mfma_f32_16x16x32_bf16 v[44:47], v[8:11], v[212:215], v[44:47]
    s_mul_i32 s40, s37, 10752
    v_add_u32 v68, s40, v68
    s_mov_b64 exec, 1
    ds_add_u32 v4, v4 offset:276
    s_mov_b64 exec, -1
    s_waitcnt lgkmcnt(3)
    v_cmp_ne_u32 vcc, 0x9e000, v5
    s_cbranch_vccnz L_cs_73
L_cb_74:
    ds_read_b64_tr_b16 v[12:13], v1 offset:45056
    v_mfma_f32_16x16x32_bf16 v[28:31], v[56:59], v[208:211], v[28:31]
    ds_read_b64_tr_b16 v[14:15], v1 offset:47616
    v_add_u32 v69, s40, v69
    v_mfma_f32_16x16x32_bf16 v[48:51], v[56:59], v[212:215], v[48:51]
    v_add_u32 v70, s40, v70
    v_add_u32 v180, 117056, v68
    ds_read_b64_tr_b16 v[8:9], v1 offset:45064
    v_mfma_f32_16x16x32_bf16 v[32:35], v[60:63], v[208:211], v[32:35]
    ds_read_b64_tr_b16 v[10:11], v1 offset:47624
    v_add_u32 v66, 115008, v69
    v_mfma_f32_16x16x32_bf16 v[52:55], v[60:63], v[212:215], v[52:55]
    v_mov_b32 v67, 161792
    v_cndmask_b32 v181, v66, v67, s[80:81]
    ds_read_b64_tr_b16 v[56:57], v1 offset:45072
    v_mfma_f32_16x16x32_bf16 v[16:19], v[84:87], v[216:219], v[16:19]
    ds_read_b64_tr_b16 v[58:59], v1 offset:47632
    v_add_u32 v66, 110592, v70
    v_mfma_f32_16x16x32_bf16 v[36:39], v[84:87], v[220:223], v[36:39]
    v_cndmask_b32 v182, v66, v71, s[78:79]
    v_sub_u32 v66, 31, v64
    ds_read_b64_tr_b16 v[60:61], v1 offset:45080
    v_mfma_f32_16x16x32_bf16 v[20:23], v[88:91], v[216:219], v[20:23]
    ds_read_b64_tr_b16 v[62:63], v1 offset:47640
    v_and_b32 v67, 3, v66
    v_mfma_f32_16x16x32_bf16 v[40:43], v[88:91], v[220:223], v[40:43]
    v_mul_u32_u24 v67, 576, v67
    v_lshrrev_b32 v66, 2, v66
    ds_read_b64_tr_b16 v[84:85], v1 offset:45088
    v_mfma_f32_16x16x32_bf16 v[24:27], v[72:75], v[216:219], v[24:27]
    ds_read_b64_tr_b16 v[86:87], v1 offset:47648
    v_add_u32 v66, v66, v65
    v_mfma_f32_16x16x32_bf16 v[44:47], v[72:75], v[220:223], v[44:47]
    v_lshl_add_u32 v66, v66, 4, v67
    v_add_u32 v189, 153600, v66
    ds_read_b64_tr_b16 v[88:89], v1 offset:50176
    v_mfma_f32_16x16x32_bf16 v[28:31], v[76:79], v[216:219], v[28:31]
    ds_read_b64_tr_b16 v[90:91], v1 offset:52736
    v_add_u32 v183, 6464, v68
    v_mfma_f32_16x16x32_bf16 v[48:51], v[76:79], v[220:223], v[48:51]
    v_add_u32 v66, 4416, v69
    v_mov_b32 v67, 161808
    ds_read_b64_tr_b16 v[72:73], v1 offset:50184
    s_waitcnt lgkmcnt(14)
    v_mfma_f32_16x16x32_bf16 v[32:35], v[80:83], v[216:219], v[32:35]
    ds_read_b64_tr_b16 v[74:75], v1 offset:52744
    v_cndmask_b32 v184, v66, v67, s[80:81]
    v_mfma_f32_16x16x32_bf16 v[52:55], v[80:83], v[220:223], v[52:55]
    v_cndmask_b32 v185, v70, v71, s[78:79]
    v_add_u32 v186, 74048, v68
    ds_read_b64_tr_b16 v[76:77], v1 offset:50192
    s_waitcnt lgkmcnt(13)
    v_mfma_f32_16x16x32_bf16 v[16:19], v[12:15], v[224:227], v[16:19]
    ds_read_b64_tr_b16 v[78:79], v1 offset:52752
    v_add_u32 v66, 72000, v69
    v_mfma_f32_16x16x32_bf16 v[36:39], v[12:15], v[228:231], v[36:39]
    v_mov_b32 v67, 161824
    v_cndmask_b32 v187, v66, v67, s[80:81]
    ds_read_b64_tr_b16 v[80:81], v1 offset:50200
    s_waitcnt lgkmcnt(13)
    v_mfma_f32_16x16x32_bf16 v[20:23], v[8:11], v[224:227], v[20:23]
    ds_read_b64_tr_b16 v[82:83], v1 offset:52760
    v_add_u32 v66, 67584, v70
    v_mfma_f32_16x16x32_bf16 v[40:43], v[8:11], v[228:231], v[40:43]
    v_cndmask_b32 v188, v66, v71, s[78:79]
    v_and_b32 v66, 15, v0
    ds_read_b64_tr_b16 v[12:13], v1 offset:50208
    s_waitcnt lgkmcnt(13)
    v_mfma_f32_16x16x32_bf16 v[24:27], v[56:59], v[224:227], v[24:27]
    ds_read_b64_tr_b16 v[14:15], v1 offset:52768
    v_bfe_u32 v67, v0, 4, 1
    v_mfma_f32_16x16x32_bf16 v[44:47], v[56:59], v[228:231], v[44:47]
    v_mul_u32_u24 v67, 20480, v67
    v_lshl_add_u32 v66, v66, 4, v67
    ds_read_b64_tr_b16 v[8:9], v1 offset:34816
    s_waitcnt lgkmcnt(13)
    v_mfma_f32_16x16x32_bf16 v[28:31], v[60:63], v[224:227], v[28:31]
    ds_read_b64_tr_b16 v[10:11], v1 offset:37376
    v_lshl_add_u32 v191, v65, 8, v66
    v_mfma_f32_16x16x32_bf16 v[48:51], v[60:63], v[228:231], v[48:51]
    v_mov_b32 v67, 0x80000000
    v_cndmask_b32 v2, v66, v67, s[80:81]
    ds_read_b64_tr_b16 v[56:57], v1 offset:34824
    s_waitcnt lgkmcnt(13)
    v_mfma_f32_16x16x32_bf16 v[32:35], v[84:87], v[224:227], v[32:35]
    ds_read_b64_tr_b16 v[58:59], v1 offset:37384
    s_lshl_b32 s41, s37, 2
    v_mfma_f32_16x16x32_bf16 v[52:55], v[84:87], v[228:231], v[52:55]
    v_add_u32 v3, s41, v4
    v_and_b32 v190, 3, v0
    ds_read_b64_tr_b16 v[60:61], v1 offset:34832
    s_waitcnt lgkmcnt(13)
    v_mfma_f32_16x16x32_bf16 v[16:19], v[88:91], v[232:235], v[16:19]
    ds_read_b64_tr_b16 v[62:63], v1 offset:37392
    v_bfe_u32 v192, v0, 2, 2
    v_mfma_f32_16x16x32_bf16 v[36:39], v[88:91], v[236:239], v[36:39]
    v_lshlrev_b32 v190, 7, v190
    v_lshl_add_u32 v190, v192, 3, v190
    ds_read_b64_tr_b16 v[84:85], v1 offset:34840
    s_waitcnt lgkmcnt(13)
    v_mfma_f32_16x16x32_bf16 v[20:23], v[72:75], v[232:235], v[20:23]
    ds_read_b64_tr_b16 v[86:87], v1 offset:37400
    s_mul_i32 s54, s39, 163840
    v_mfma_f32_16x16x32_bf16 v[40:43], v[72:75], v[236:239], v[40:43]
    s_add_u32 s54, s54, 0x640000
    s_lshl_b32 s41, s30, 2
    ds_read_b64_tr_b16 v[88:89], v1 offset:34848
    s_waitcnt lgkmcnt(13)
    v_mfma_f32_16x16x32_bf16 v[24:27], v[76:79], v[232:235], v[24:27]
    ds_read_b64_tr_b16 v[90:91], v1 offset:37408
    s_add_u32 s41, s41, s37
    v_mfma_f32_16x16x32_bf16 v[44:47], v[76:79], v[236:239], v[44:47]
    s_lshr_b32 s42, s41, 1
    s_lshl_b32 s42, s42, 8
    ds_read_b64_tr_b16 v[92:93], v1 offset:39936
    s_waitcnt lgkmcnt(13)
    v_mfma_f32_16x16x32_bf16 v[28:31], v[80:83], v[232:235], v[28:31]
    ds_read_b64_tr_b16 v[94:95], v1 offset:42496
    s_add_u32 s55, s54, s42
    v_mfma_f32_16x16x32_bf16 v[48:51], v[80:83], v[236:239], v[48:51]
    s_and_b32 s42, s41, 1
    s_lshl_b32 s42, s42, 3
    ds_read_b64_tr_b16 v[76:77], v1 offset:39944
    s_waitcnt lgkmcnt(13)
    v_mfma_f32_16x16x32_bf16 v[32:35], v[12:15], v[232:235], v[32:35]
    ds_read_b64_tr_b16 v[78:79], v1 offset:42504
    s_add_u32 s55, s55, s42
    v_mfma_f32_16x16x32_bf16 v[52:55], v[12:15], v[236:239], v[52:55]
    s_add_u32 s55, s55, 16384
    s_lshl_b32 s41, s41, 9
    ds_read_b64_tr_b16 v[80:81], v1 offset:39952
    s_waitcnt lgkmcnt(13)
    v_mfma_f32_16x16x32_bf16 v[16:19], v[8:11], v[240:243], v[16:19]
    ds_read_b64_tr_b16 v[82:83], v1 offset:42512
    s_add_u32 s54, s54, s41
    s_mov_b64 s[52:53], -1
    v_mfma_f32_16x16x32_bf16 v[36:39], v[8:11], v[244:247], v[36:39]
    s_lshl_b32 s56, s39, 10
    s_bfe_u32 s41, s31, 0x10001
    ds_read_b64_tr_b16 v[12:13], v1 offset:39960
    s_waitcnt lgkmcnt(13)
    v_mfma_f32_16x16x32_bf16 v[20:23], v[56:59], v[240:243], v[20:23]
    ds_read_b64_tr_b16 v[14:15], v1 offset:42520
    s_lshl_b32 s41, s41, 9
    s_add_u32 s56, s56, s41
    v_mfma_f32_16x16x32_bf16 v[40:43], v[56:59], v[244:247], v[40:43]
    s_add_u32 s56, s56, 0xb40000
    s_and_b32 s41, s37, 2
    ds_read_b64_tr_b16 v[8:9], v1 offset:39968
    ds_read_b64_tr_b16 v[10:11], v1 offset:42528
    s_mov_b64 exec, 1
    ds_add_u32 v4, v4 offset:280
    s_mov_b64 exec, -1
    s_waitcnt lgkmcnt(13)
    v_mfma_f32_16x16x32_bf16 v[24:27], v[60:63], v[240:243], v[24:27]
    s_add_u32 s41, s41, s37
    s_lshl1_add_u32 s40, s41, 4
    v_mfma_f32_16x16x32_bf16 v[44:47], v[60:63], v[244:247], v[44:47]
    s_lshl_b32 s41, s30, 1
    s_add_u32 s41, s41, s40
    v_mfma_f32_16x16x32_bf16 v[28:31], v[84:87], v[240:243], v[28:31]
    s_and_b32 s41, s41, 7
    s_and_b32 s57, s40, 8
    v_mfma_f32_16x16x32_bf16 v[48:51], v[84:87], v[244:247], v[48:51]
    s_add_u32 s57, s57, s41
    s_mul_i32 s57, s57, 51200
    s_waitcnt lgkmcnt(9)
    v_mfma_f32_16x16x32_bf16 v[32:35], v[88:91], v[240:243], v[32:35]
    s_add_u32 s40, s40, 1
    s_lshl_b32 s41, s30, 1
    v_mfma_f32_16x16x32_bf16 v[52:55], v[88:91], v[244:247], v[52:55]
    s_add_u32 s41, s41, s40
    s_and_b32 s41, s41, 7
    v_mfma_f32_16x16x32_bf16 v[16:19], v[92:95], v[248:251], v[16:19]
    s_and_b32 s58, s40, 8
    s_add_u32 s58, s58, s41
    v_mfma_f32_16x16x32_bf16 v[36:39], v[92:95], v[252:255], v[36:39]
    s_mul_i32 s58, s58, 51200
    ds_read_b64 v[72:73], v4 offset:312
    s_waitcnt lgkmcnt(6)
    v_mfma_f32_16x16x32_bf16 v[20:23], v[76:79], v[248:251], v[20:23]
    v_mfma_f32_16x16x32_bf16 v[40:43], v[76:79], v[252:255], v[40:43]
    ds_read_b32 v5, v4 offset:276
    v_mfma_f32_16x16x32_bf16 v[24:27], v[80:83], v[248:251], v[24:27]
    v_mfma_f32_16x16x32_bf16 v[44:47], v[80:83], v[252:255], v[44:47]
    s_waitcnt lgkmcnt(5)
    v_mfma_f32_16x16x32_bf16 v[28:31], v[12:15], v[248:251], v[28:31]
    v_mfma_f32_16x16x32_bf16 v[48:51], v[12:15], v[252:255], v[48:51]
    s_waitcnt lgkmcnt(3)
    v_mfma_f32_16x16x32_bf16 v[32:35], v[8:11], v[248:251], v[32:35]
    v_mfma_f32_16x16x32_bf16 v[52:55], v[8:11], v[252:255], v[52:55]
    s_waitcnt lgkmcnt(1)
    v_readfirstlane_b32 s32, v72
    v_readfirstlane_b32 s33, v73
    s_cmp_eq_u32 s28, 0
    s_nop 3
    s_cbranch_scc1 L_A_c
    v_and_b32 v8, 15, v0
    v_lshrrev_b32 v9, 4, v0
    s_lshl_b32 s40, s31, 9
    s_add_u32 s40, s40, 43008
    v_lshl_add_u32 v8, v8, 4, s40
    v_mul_u32_u24 v9, 6144, v9
    v_add_u32 v8, v8, v9
    s_mov_b32 s40, 0x3ea52b5c
    s_waitcnt lgkmcnt(0)
    v_cmp_ne_u32 vcc, 0x9e000, v5
    s_cbranch_vccnz L_cs_75
L_cb_76:
    v_mul_f32 v16, s40, v16
    v_mul_f32 v17, s40, v17
    v_mul_f32 v18, s40, v18
    v_mul_f32 v19, s40, v19
    v_mul_f32 v20, s40, v20
    v_mul_f32 v21, s40, v21
    v_mul_f32 v22, s40, v22
    v_mul_f32 v23, s40, v23
    v_cvt_pk_bf16_f32 v16, v16, v17
    v_cvt_pk_bf16_f32 v17, v18, v19
    v_cvt_pk_bf16_f32 v18, v20, v21
    v_cvt_pk_bf16_f32 v19, v22, v23
    ds_write_b128 v8, v[16:19] offset:0
    v_mul_f32 v24, s40, v24
    v_mul_f32 v25, s40, v25
    v_mul_f32 v26, s40, v26
    v_mul_f32 v27, s40, v27
    v_mul_f32 v28, s40, v28
    v_mul_f32 v29, s40, v29
    v_mul_f32 v30, s40, v30
    v_mul_f32 v31, s40, v31
    v_cvt_pk_bf16_f32 v20, v24, v25
    v_cvt_pk_bf16_f32 v21, v26, v27
    v_cvt_pk_bf16_f32 v22, v28, v29
    v_cvt_pk_bf16_f32 v23, v30, v31
    ds_write_b128 v8, v[20:23] offset:2048
    v_mul_f32 v32, s40, v32
    v_mul_f32 v33, s40, v33
    v_mul_f32 v34, s40, v34
    v_mul_f32 v35, s40, v35
    v_cvt_pk_bf16_f32 v24, v32, v33
    v_cvt_pk_bf16_f32 v25, v34, v35
    ds_write_b64 v8, v[24:25] offset:4096
    v_mul_f32 v36, s40, v36
    v_mul_f32 v37, s40, v37
    v_mul_f32 v38, s40, v38
    v_mul_f32 v39, s40, v39
    v_mul_f32 v40, s40, v40
    v_mul_f32 v41, s40, v41
    v_mul_f32 v42, s40, v42
    v_mul_f32 v43, s40, v43
    v_cvt_pk_bf16_f32 v36, v36, v37
    v_cvt_pk_bf16_f32 v37, v38, v39
    v_cvt_pk_bf16_f32 v38, v40, v41
    v_cvt_pk_bf16_f32 v39, v42, v43
    ds_write_b128 v8, v[36:39] offset:256
    v_mul_f32 v44, s40, v44
    v_mul_f32 v45, s40, v45
    v_mul_f32 v46, s40, v46
    v_mul_f32 v47, s40, v47
    v_mul_f32 v48, s40, v48
    v_mul_f32 v49, s40, v49
    v_mul_f32 v50, s40, v50
    v_mul_f32 v51, s40, v51
    v_cvt_pk_bf16_f32 v40, v44, v45
    v_cvt_pk_bf16_f32 v41, v46, v47
    v_cvt_pk_bf16_f32 v42, v48, v49
    v_cvt_pk_bf16_f32 v43, v50, v51
    ds_write_b128 v8, v[40:43] offset:2304
    v_mul_f32 v52, s40, v52
    v_mul_f32 v53, s40, v53
    v_mul_f32 v54, s40, v54
    v_mul_f32 v55, s40, v55
    v_cvt_pk_bf16_f32 v44, v52, v53
    v_cvt_pk_bf16_f32 v45, v54, v55
    ds_write_b64 v8, v[44:45] offset:4352
    s_mov_b64 exec, 1
    ds_add_u32 v4, v4 offset:184
    s_mov_b64 exec, -1
    v_lshlrev_b32 v80, 4, v0
    v_add_u32 v80, 156160, v80
    ds_read_b128 v[8:11], v80 offset:1024
    ds_read_b128 v[12:15], v80 offset:2048
    ds_read_b64 v[6:7], v80
    ds_read_b128 v[104:107], v181 offset:0
    ds_read_b128 v[108:111], v180 offset:0
    ds_read_b128 v[112:115], v181 offset:512
    ds_read_b128 v[116:119], v180 offset:512
    ds_read_b128 v[120:123], v181 offset:1024
    ds_read_b128 v[124:127], v180 offset:1024
    ds_read_b128 v[128:131], v181 offset:1536
    ds_read_b128 v[132:135], v180 offset:1536
    ds_read_b128 v[160:163], v189 offset:256
    ds_read_b128 v[164:167], v189 offset:288
    ds_read_b128 v[168:171], v189 offset:320
    ds_read_b128 v[172:175], v189 offset:352
    ds_read_b32 v5, v4 offset:184
    s_waitcnt lgkmcnt(0)
    v_cmp_ne_u32 vcc, 0x9e000, v5
    s_cbranch_vccnz L_cs_77
L_cb_78:
    ds_read_b64 v[20:21], v96 offset:5632
    ds_read_b128 v[16:19], v97 offset:1536
    ds_read_b64 v[28:29], v96 offset:4608
    ds_read_b128 v[24:27], v97 offset:512
    ds_read_b64_tr_b16 v[136:137], v182 offset:0
    ds_read_b64_tr_b16 v[138:139], v182 offset:128
    ds_read_b64_tr_b16 v[140:141], v182 offset:256
    ds_read_b64_tr_b16 v[142:143], v182 offset:384
    v_mov_b32 v176, 0xbf80
    v_mov_b32 v22, 0
    v_mov_b32 v23, 0
    v_mov_b32 v30, 0
    v_mov_b32 v31, 0
    s_waitcnt lgkmcnt(6)
    v_cndmask_b32 v20, v20, 0, s[80:81]
    v_cndmask_b32 v21, v21, v176, s[80:81]
    s_waitcnt lgkmcnt(4)
    v_cndmask_b32 v28, v28, 0, s[80:81]
    v_cndmask_b32 v29, v29, v176, s[80:81]
    v_mfma_f32_32x32x16_bf16 v[32:47], v[128:131], v[20:23], v[160:175]
    v_mfma_f32_32x32x16_bf16 v[32:47], v[132:135], v[16:19], v[32:47]
    v_mfma_f32_32x32x16_bf16 v[48:63], v[112:115], v[28:31], v[160:175]
    v_mfma_f32_32x32x16_bf16 v[48:63], v[116:119], v[24:27], v[48:63]
    s_nop 9
    v_max3_f32 v176, v32, v33, v34
    v_max_f32 v176, v176, v35
    v_max3_f32 v176, v176, v36, v37
    v_max3_f32 v176, v176, v38, v39
    v_max3_f32 v176, v176, v40, v41
    v_max3_f32 v176, v176, v42, v43
    v_max3_f32 v176, v176, v44, v45
    v_max3_f32 v176, v176, v46, v47
    v_mov_b32 v177, v176
    s_nop 1
    v_permlane32_swap_b32 v177, v176
    v_max_f32 v176, v176, v177
    v_sub_f32 v176, 0xc1a00000, v176
    v_and_b32 v177, 0xffff0000, v176
    v_sub_f32 v176, v176, v177
    v_and_b32 v176, 0xffff0000, v176
    v_lshrrev_b32 v177, 16, v177
    v_or_b32 v177, v177, v176
    v_cndmask_b32 v20, v20, v177, s[80:81]
    v_max3_f32 v178, v48, v49, v50
    v_max_f32 v178, v178, v51
    v_max3_f32 v178, v178, v52, v53
    v_max3_f32 v178, v178, v54, v55
    v_max3_f32 v178, v178, v56, v57
    v_max3_f32 v178, v178, v58, v59
    v_max3_f32 v178, v178, v60, v61
    v_max3_f32 v178, v178, v62, v63
    v_mov_b32 v179, v178
    s_nop 1
    v_permlane32_swap_b32 v179, v178
    v_max_f32 v178, v178, v179
    v_sub_f32 v178, 0xc1a00000, v178
    v_and_b32 v179, 0xffff0000, v178
    v_sub_f32 v178, v178, v179
    v_and_b32 v178, 0xffff0000, v178
    v_lshrrev_b32 v179, 16, v179
    v_or_b32 v179, v179, v178
    v_cndmask_b32 v28, v28, v179, s[80:81]
    s_nop 1
    s_branch L_main_hotC
L_mainC:
    ds_read_b128 v[104:107], v181 offset:0
    ds_read_b128 v[108:111], v180 offset:0
    ds_read_b128 v[112:115], v181 offset:512
    ds_read_b128 v[116:119], v180 offset:512
    ds_read_b128 v[120:123], v181 offset:1024
    ds_read_b128 v[124:127], v180 offset:1024
    ds_read_b128 v[128:131], v181 offset:1536
    ds_read_b128 v[132:135], v180 offset:1536
    ds_read_b128 v[160:163], v189 offset:256
    ds_read_b128 v[164:167], v189 offset:288
    ds_read_b128 v[168:171], v189 offset:320
    ds_read_b128 v[172:175], v189 offset:352
    ds_read_b64_tr_b16 v[136:137], v182 offset:0
    ds_read_b64_tr_b16 v[138:139], v182 offset:128
    ds_read_b64_tr_b16 v[140:141], v182 offset:256
    ds_read_b64_tr_b16 v[142:143], v182 offset:384
    s_waitcnt lgkmcnt(0)
L_main_hotC:
    v_mfma_f32_32x32x16_bf16 v[64:79], v[104:107], v[20:23], 0
    v_mfma_f32_32x32x16_bf16 v[64:79], v[108:111], v[16:19], v[64:79]
    s_nop 11
    v_exp_f32 v64, v64
    v_exp_f32 v65, v65
    v_exp_f32 v66, v66
    v_exp_f32 v67, v67
    v_exp_f32 v68, v68
    v_exp_f32 v69, v69
    v_cvt_pk_bf16_f32 v96, v64, v65
    v_mfma_f32_32x32x16_bf16 v[80:95], v[104:107], v[28:31], 0
    v_exp_f32 v70, v70
    v_exp_f32 v71, v71
    v_cvt_pk_bf16_f32 v97, v66, v67
    v_cvt_pk_bf16_f32 v98, v68, v69
    v_exp_f32 v72, v72
    v_exp_f32 v73, v73
    v_mfma_f32_32x32x16_bf16 v[80:95], v[108:111], v[24:27], v[80:95]
    s_waitcnt lgkmcnt(0)
    v_cvt_pk_bf16_f32 v99, v70, v71
    v_exp_f32 v74, v74
    v_exp_f32 v75, v75
    v_exp_f32 v76, v76
    v_exp_f32 v77, v77
    v_mfma_f32_32x32x16_bf16 v[32:47], v[136:139], v[96:99], 0
    v_exp_f32 v78, v78
    v_exp_f32 v79, v79
    v_cvt_pk_bf16_f32 v100, v72, v73
    v_cvt_pk_bf16_f32 v101, v74, v75
    v_cvt_pk_bf16_f32 v102, v76, v77
    v_cvt_pk_bf16_f32 v103, v78, v79
    v_exp_f32 v80, v80
    v_exp_f32 v81, v81
    v_mfma_f32_32x32x16_bf16 v[32:47], v[140:143], v[100:103], v[32:47]
    v_exp_f32 v82, v82
    v_exp_f32 v83, v83
    v_exp_f32 v84, v84
    v_exp_f32 v85, v85
    v_cvt_pk_bf16_f32 v96, v80, v81
    v_mfma_f32_32x32x16_bf16 v[64:79], v[112:115], v[20:23], 0
    ds_read_b64_tr_b16 v[144:145], v182 offset:512
    ds_read_b64_tr_b16 v[146:147], v182 offset:640
    v_exp_f32 v86, v86
    v_exp_f32 v87, v87
    v_cvt_pk_bf16_f32 v97, v82, v83
    v_cvt_pk_bf16_f32 v98, v84, v85
    v_exp_f32 v88, v88
    v_exp_f32 v89, v89
    v_mfma_f32_32x32x16_bf16 v[64:79], v[116:119], v[16:19], v[64:79]
    ds_read_b64_tr_b16 v[148:149], v182 offset:768
    ds_read_b64_tr_b16 v[150:151], v182 offset:896
    v_cvt_pk_bf16_f32 v99, v86, v87
    v_exp_f32 v90, v90
    v_exp_f32 v91, v91
    v_exp_f32 v92, v92
    v_exp_f32 v93, v93
    v_mfma_f32_32x32x16_bf16 v[48:63], v[136:139], v[96:99], 0
    v_exp_f32 v94, v94
    v_exp_f32 v95, v95
    v_cvt_pk_bf16_f32 v100, v88, v89
    v_cvt_pk_bf16_f32 v101, v90, v91
    v_cvt_pk_bf16_f32 v102, v92, v93
    v_cvt_pk_bf16_f32 v103, v94, v95
    v_exp_f32 v64, v64
    v_exp_f32 v65, v65
    v_mfma_f32_32x32x16_bf16 v[48:63], v[140:143], v[100:103], v[48:63]
    v_exp_f32 v66, v66
    v_exp_f32 v67, v67
    v_exp_f32 v68, v68
    v_exp_f32 v69, v69
    v_cvt_pk_bf16_f32 v96, v64, v65
    v_mfma_f32_32x32x16_bf16 v[80:95], v[112:115], v[28:31], v[160:175]
    v_exp_f32 v70, v70
    v_exp_f32 v71, v71
    v_cvt_pk_bf16_f32 v97, v66, v67
    v_cvt_pk_bf16_f32 v98, v68, v69
    v_exp_f32 v72, v72
    v_exp_f32 v73, v73
    v_mfma_f32_32x32x16_bf16 v[80:95], v[116:119], v[24:27], v[80:95]
    s_waitcnt lgkmcnt(0)
    v_cvt_pk_bf16_f32 v99, v70, v71
    v_exp_f32 v74, v74
    v_exp_f32 v75, v75
    v_exp_f32 v76, v76
    v_exp_f32 v77, v77
    v_mfma_f32_32x32x16_bf16 v[32:47], v[144:147], v[96:99], v[32:47]
    v_exp_f32 v78, v78
    v_exp_f32 v79, v79
    v_cvt_pk_bf16_f32 v100, v72, v73
    v_cvt_pk_bf16_f32 v101, v74, v75
    v_cvt_pk_bf16_f32 v102, v76, v77
    v_cvt_pk_bf16_f32 v103, v78, v79
    v_exp_f32 v80, v80
    v_exp_f32 v81, v81
    v_mfma_f32_32x32x16_bf16 v[32:47], v[148:151], v[100:103], v[32:47]
    v_exp_f32 v82, v82
    v_exp_f32 v83, v83
    v_exp_f32 v84, v84
    v_exp_f32 v85, v85
    v_cvt_pk_bf16_f32 v96, v80, v81
    v_mfma_f32_32x32x16_bf16 v[64:79], v[120:123], v[20:23], 0
    ds_read_b64_tr_b16 v[152:153], v182 offset:1024
    ds_read_b64_tr_b16 v[154:155], v182 offset:1152
    v_exp_f32 v86, v86
    v_exp_f32 v87, v87
    v_cvt_pk_bf16_f32 v97, v82, v83
    v_cvt_pk_bf16_f32 v98, v84, v85
    v_exp_f32 v88, v88
    v_exp_f32 v89, v89
    v_mfma_f32_32x32x16_bf16 v[64:79], v[124:127], v[16:19], v[64:79]
    ds_read_b64_tr_b16 v[156:157], v182 offset:1280
    ds_read_b64_tr_b16 v[158:159], v182 offset:1408
    v_cvt_pk_bf16_f32 v99, v86, v87
    v_exp_f32 v90, v90
    v_exp_f32 v91, v91
    v_exp_f32 v92, v92
    v_exp_f32 v93, v93
    v_mfma_f32_32x32x16_bf16 v[48:63], v[144:147], v[96:99], v[48:63]
    v_exp_f32 v94, v94
    v_exp_f32 v95, v95
    v_cvt_pk_bf16_f32 v100, v88, v89
    v_cvt_pk_bf16_f32 v101, v90, v91
    v_cvt_pk_bf16_f32 v102, v92, v93
    v_cvt_pk_bf16_f32 v103, v94, v95
    v_exp_f32 v64, v64
    v_exp_f32 v65, v65
    v_mfma_f32_32x32x16_bf16 v[48:63], v[148:151], v[100:103], v[48:63]
    v_exp_f32 v66, v66
    v_exp_f32 v67, v67
    v_exp_f32 v68, v68
    v_exp_f32 v69, v69
    v_cvt_pk_bf16_f32 v96, v64, v65
    v_mfma_f32_32x32x16_bf16 v[80:95], v[128:131], v[20:23], v[160:175]
    ds_read_b64_tr_b16 v[136:137], v182 offset:1536
    ds_read_b64_tr_b16 v[138:139], v182 offset:1664
    v_exp_f32 v70, v70
    v_exp_f32 v71, v71
    v_cvt_pk_bf16_f32 v97, v66, v67
    v_cvt_pk_bf16_f32 v98, v68, v69
    v_exp_f32 v72, v72
    v_exp_f32 v73, v73
    v_mfma_f32_32x32x16_bf16 v[80:95], v[132:135], v[16:19], v[80:95]
    s_waitcnt lgkmcnt(2)
    ds_read_b64_tr_b16 v[140:141], v182 offset:1792
    ds_read_b64_tr_b16 v[142:143], v182 offset:1920
    v_cvt_pk_bf16_f32 v99, v70, v71
    v_exp_f32 v74, v74
    v_exp_f32 v75, v75
    v_exp_f32 v76, v76
    v_exp_f32 v77, v77
    v_mfma_f32_32x32x16_bf16 v[32:47], v[152:155], v[96:99], v[32:47]
    v_exp_f32 v78, v78
    v_exp_f32 v79, v79
    v_cvt_pk_bf16_f32 v100, v72, v73
    v_cvt_pk_bf16_f32 v101, v74, v75
    v_cvt_pk_bf16_f32 v102, v76, v77
    v_cvt_pk_bf16_f32 v103, v78, v79
    v_exp_f32 v80, v80
    v_exp_f32 v81, v81
    v_mfma_f32_32x32x16_bf16 v[32:47], v[156:159], v[100:103], v[32:47]
    v_exp_f32 v82, v82
    v_exp_f32 v83, v83
    v_exp_f32 v84, v84
    v_exp_f32 v85, v85
    v_cvt_pk_bf16_f32 v96, v80, v81
    v_exp_f32 v86, v86
    v_exp_f32 v87, v87
    v_cvt_pk_bf16_f32 v97, v82, v83
    v_cvt_pk_bf16_f32 v98, v84, v85
    v_exp_f32 v88, v88
    v_exp_f32 v89, v89
    s_waitcnt lgkmcnt(0)
    v_cvt_pk_bf16_f32 v99, v86, v87
    v_exp_f32 v90, v90
    v_exp_f32 v91, v91
    v_exp_f32 v92, v92
    v_exp_f32 v93, v93
    v_mfma_f32_32x32x16_bf16 v[32:47], v[136:139], v[96:99], v[32:47]
    v_exp_f32 v94, v94
    v_exp_f32 v95, v95
    v_cvt_pk_bf16_f32 v100, v88, v89
    v_cvt_pk_bf16_f32 v101, v90, v91
    v_cvt_pk_bf16_f32 v102, v92, v93
    v_cvt_pk_bf16_f32 v103, v94, v95
    s_nop 1
    v_mfma_f32_32x32x16_bf16 v[32:47], v[140:143], v[100:103], v[32:47]
    s_nop 11
    v_max_f32 v176, v44, v60
    v_cmp_u_f32 s[64:65], v44, v60
    v_cmp_ngt_f32 vcc, 0x4e800000, v176
    s_mov_b32 s62, 0x71800000
    s_or_b64 vcc, vcc, s[64:65]
    s_and_b64 vcc, vcc, s[52:53]
    s_cbranch_scc1 L_slowC
    ds_write_b32 v3, v4 offset:416
    s_mul_i32 s40, s39, 163840
    s_add_u32 s40, s40, 0x640000
    s_lshl_b32 s41, s30, 2
    s_add_u32 s41, s41, s37
    v_and_b32 v240, 31, v0
    v_lshrrev_b32 v241, 5, v0
    v_mul_u32_u24 v241, 20480, v241
    v_lshl_add_u32 v240, v240, 4, v241
    v_and_b32 v241, 15, v0
    v_lshrrev_b32 v236, 4, v0
    v_mul_u32_u24 v236, 20480, v236
    v_lshl_add_u32 v241, v241, 4, v236
    v_mov_b32 v236, -1
    v_mov_b32 v237, -1
    v_mov_b32 v238, -1
    v_mov_b32 v239, -1
    s_lshl_b32 s42, s41, 9
    s_add_u32 s42, s42, s40
    buffer_store_dwordx4 v[236:239], v240, s[12:15], s42 offen sc1
    s_add_u32 s42, s42, 40960
    buffer_store_dwordx4 v[236:239], v240, s[12:15], s42 offen sc1
    s_add_u32 s42, s42, 40960
    buffer_store_dwordx4 v[236:239], v240, s[12:15], s42 offen sc1
    s_add_u32 s42, s42, 40960
    buffer_store_dwordx4 v[236:239], v240, s[12:15], s42 offen sc1
    s_lshr_b32 s42, s41, 1
    s_lshl_b32 s42, s42, 8
    s_add_u32 s40, s40, s42
    s_and_b32 s42, s41, 1
    s_mul_i32 s42, s42, 81920
    s_add_u32 s40, s40, s42
    s_add_u32 s40, s40, 16384
    buffer_store_dwordx4 v[236:239], v241, s[12:15], s40 offen sc1
    ds_read_b32 v5, v3 offset:336
    s_waitcnt lgkmcnt(0)
    v_cmp_ne_u32 vcc, 0x27800, v5
    s_cbranch_vccnz L_cs_79
L_cb_80:
    ds_read_b128 v[104:107], v184 offset:0
    ds_read_b128 v[108:111], v183 offset:0
    ds_read_b64_tr_b16 v[144:145], v185 offset:0
    ds_read_b64_tr_b16 v[146:147], v185 offset:128
    ds_read_b64_tr_b16 v[148:149], v185 offset:256
    ds_read_b64_tr_b16 v[150:151], v185 offset:384
    s_waitcnt lgkmcnt(4)
    v_mfma_f32_32x32x16_bf16 v[64:79], v[104:107], v[20:23], 0
    v_mfma_f32_32x32x16_bf16 v[64:79], v[108:111], v[16:19], v[64:79]
    ds_read_b128 v[112:115], v184 offset:512
    ds_read_b128 v[116:119], v183 offset:512
    ds_read_b128 v[160:163], v189 offset:0
    ds_read_b128 v[164:167], v189 offset:32
    ds_read_b128 v[168:171], v189 offset:64
    ds_read_b128 v[172:175], v189 offset:96
    s_nop 5
    v_exp_f32 v64, v64
    v_exp_f32 v65, v65
    v_exp_f32 v66, v66
    v_exp_f32 v67, v67
    v_exp_f32 v68, v68
    v_exp_f32 v69, v69
    v_cvt_pk_bf16_f32 v96, v64, v65
    v_mfma_f32_32x32x16_bf16 v[80:95], v[104:107], v[28:31], 0
    v_exp_f32 v70, v70
    v_exp_f32 v71, v71
    v_cvt_pk_bf16_f32 v97, v66, v67
    v_cvt_pk_bf16_f32 v98, v68, v69
    v_exp_f32 v72, v72
    v_exp_f32 v73, v73
    v_mfma_f32_32x32x16_bf16 v[80:95], v[108:111], v[24:27], v[80:95]
    s_waitcnt lgkmcnt(6)
    v_cvt_pk_bf16_f32 v99, v70, v71
    v_exp_f32 v74, v74
    v_exp_f32 v75, v75
    v_exp_f32 v76, v76
    v_exp_f32 v77, v77
    v_mfma_f32_32x32x16_bf16 v[32:47], v[144:147], v[96:99], v[32:47]
    buffer_load_dwordx4 v[196:199], v6, s[16:19], s57 offen
    v_exp_f32 v78, v78
    v_exp_f32 v79, v79
    v_cvt_pk_bf16_f32 v100, v72, v73
    v_cvt_pk_bf16_f32 v101, v74, v75
    v_cvt_pk_bf16_f32 v102, v76, v77
    v_cvt_pk_bf16_f32 v103, v78, v79
    v_exp_f32 v80, v80
    v_exp_f32 v81, v81
    v_mfma_f32_32x32x16_bf16 v[32:47], v[148:151], v[100:103], v[32:47]
    s_waitcnt lgkmcnt(4)
    v_exp_f32 v82, v82
    v_exp_f32 v83, v83
    v_exp_f32 v84, v84
    v_exp_f32 v85, v85
    v_cvt_pk_bf16_f32 v96, v80, v81
    v_mfma_f32_32x32x16_bf16 v[64:79], v[112:115], v[20:23], 0
    ds_read_b64_tr_b16 v[152:153], v185 offset:512
    ds_read_b64_tr_b16 v[154:155], v185 offset:640
    v_exp_f32 v86, v86
    v_exp_f32 v87, v87
    v_cvt_pk_bf16_f32 v97, v82, v83
    v_cvt_pk_bf16_f32 v98, v84, v85
    v_exp_f32 v88, v88
    v_exp_f32 v89, v89
    v_mfma_f32_32x32x16_bf16 v[64:79], v[116:119], v[16:19], v[64:79]
    ds_read_b64_tr_b16 v[156:157], v185 offset:768
    ds_read_b64_tr_b16 v[158:159], v185 offset:896
    v_cvt_pk_bf16_f32 v99, v86, v87
    v_exp_f32 v90, v90
    v_exp_f32 v91, v91
    v_exp_f32 v92, v92
    v_exp_f32 v93, v93
    v_mfma_f32_32x32x16_bf16 v[48:63], v[144:147], v[96:99], v[48:63]
    buffer_load_dwordx4 v[200:203], v7, s[16:19], s57 offen
    v_exp_f32 v94, v94
    v_exp_f32 v95, v95
    v_cvt_pk_bf16_f32 v100, v88, v89
    v_cvt_pk_bf16_f32 v101, v90, v91
    v_cvt_pk_bf16_f32 v102, v92, v93
    v_cvt_pk_bf16_f32 v103, v94, v95
    v_exp_f32 v64, v64
    v_exp_f32 v65, v65
    v_mfma_f32_32x32x16_bf16 v[48:63], v[148:151], v[100:103], v[48:63]
    ds_read_b128 v[120:123], v184 offset:1024
    ds_read_b128 v[124:127], v183 offset:1024
    v_exp_f32 v66, v66
    v_exp_f32 v67, v67
    v_exp_f32 v68, v68
    v_exp_f32 v69, v69
    v_cvt_pk_bf16_f32 v96, v64, v65
    v_mfma_f32_32x32x16_bf16 v[80:95], v[112:115], v[28:31], 0
    v_exp_f32 v70, v70
    v_exp_f32 v71, v71
    v_cvt_pk_bf16_f32 v97, v66, v67
    v_cvt_pk_bf16_f32 v98, v68, v69
    v_exp_f32 v72, v72
    v_exp_f32 v73, v73
    v_mfma_f32_32x32x16_bf16 v[80:95], v[116:119], v[24:27], v[80:95]
    s_waitcnt lgkmcnt(2)
    v_cvt_pk_bf16_f32 v99, v70, v71
    v_exp_f32 v74, v74
    v_exp_f32 v75, v75
    v_exp_f32 v76, v76
    v_exp_f32 v77, v77
    v_mfma_f32_32x32x16_bf16 v[32:47], v[152:155], v[96:99], v[32:47]
    buffer_load_dwordx4 v[204:207], v8, s[16:19], s57 offen
    v_exp_f32 v78, v78
    v_exp_f32 v79, v79
    v_cvt_pk_bf16_f32 v100, v72, v73
    v_cvt_pk_bf16_f32 v101, v74, v75
    v_cvt_pk_bf16_f32 v102, v76, v77
    v_cvt_pk_bf16_f32 v103, v78, v79
    v_exp_f32 v80, v80
    v_exp_f32 v81, v81
    v_mfma_f32_32x32x16_bf16 v[32:47], v[156:159], v[100:103], v[32:47]
    s_waitcnt lgkmcnt(0)
    s_lshl_b32 s40, s35, 7
    s_lshl_b32 s41, s37, 3
    s_add_u32 s40, s40, s41
    s_add_u32 s40, s40, 0xb40000
    v_mov_b32 v178, s32
    v_mov_b32 v179, s33
    s_waitcnt vmcnt(3)
    s_mov_b64 exec, 1
    buffer_store_dwordx2 v[178:179], off, s[12:15], s40 sc1
    ds_add_u32 v4, v4 offset:400
    s_mov_b64 exec, -1
    v_exp_f32 v82, v82
    v_exp_f32 v83, v83
    v_exp_f32 v84, v84
    v_exp_f32 v85, v85
    v_cvt_pk_bf16_f32 v96, v80, v81
    v_mfma_f32_32x32x16_bf16 v[64:79], v[120:123], v[20:23], 0
    ds_read_b64_tr_b16 v[136:137], v185 offset:1024
    ds_read_b64_tr_b16 v[138:139], v185 offset:1152
    v_exp_f32 v86, v86
    v_exp_f32 v87, v87
    v_cvt_pk_bf16_f32 v97, v82, v83
    v_cvt_pk_bf16_f32 v98, v84, v85
    v_exp_f32 v88, v88
    v_exp_f32 v89, v89
    v_mfma_f32_32x32x16_bf16 v[64:79], v[124:127], v[16:19], v[64:79]
    ds_read_b64_tr_b16 v[140:141], v185 offset:1280
    ds_read_b64_tr_b16 v[142:143], v185 offset:1408
    v_cvt_pk_bf16_f32 v99, v86, v87
    v_exp_f32 v90, v90
    v_exp_f32 v91, v91
    v_exp_f32 v92, v92
    v_exp_f32 v93, v93
    v_mfma_f32_32x32x16_bf16 v[48:63], v[152:155], v[96:99], v[48:63]
    buffer_load_dwordx4 v[208:211], v9, s[16:19], s57 offen
    v_exp_f32 v94, v94
    v_exp_f32 v95, v95
    v_cvt_pk_bf16_f32 v100, v88, v89
    v_cvt_pk_bf16_f32 v101, v90, v91
    v_cvt_pk_bf16_f32 v102, v92, v93
    v_cvt_pk_bf16_f32 v103, v94, v95
    v_exp_f32 v64, v64
    v_exp_f32 v65, v65
    v_mfma_f32_32x32x16_bf16 v[48:63], v[156:159], v[100:103], v[48:63]
    ds_read_b128 v[128:131], v184 offset:1536
    ds_read_b128 v[132:135], v183 offset:1536
    v_exp_f32 v66, v66
    v_exp_f32 v67, v67
    v_exp_f32 v68, v68
    v_exp_f32 v69, v69
    v_cvt_pk_bf16_f32 v96, v64, v65
    v_mfma_f32_32x32x16_bf16 v[80:95], v[120:123], v[28:31], 0
    v_exp_f32 v70, v70
    v_exp_f32 v71, v71
    v_cvt_pk_bf16_f32 v97, v66, v67
    v_cvt_pk_bf16_f32 v98, v68, v69
    v_exp_f32 v72, v72
    v_exp_f32 v73, v73
    v_mfma_f32_32x32x16_bf16 v[80:95], v[124:127], v[24:27], v[80:95]
    s_waitcnt lgkmcnt(2)
    v_cvt_pk_bf16_f32 v99, v70, v71
    v_exp_f32 v74, v74
    v_exp_f32 v75, v75
    v_exp_f32 v76, v76
    v_exp_f32 v77, v77
    v_mfma_f32_32x32x16_bf16 v[32:47], v[136:139], v[96:99], v[32:47]
    buffer_load_dwordx4 v[212:215], v10, s[16:19], s57 offen
    v_exp_f32 v78, v78
    v_exp_f32 v79, v79
    v_cvt_pk_bf16_f32 v100, v72, v73
    v_cvt_pk_bf16_f32 v101, v74, v75
    v_cvt_pk_bf16_f32 v102, v76, v77
    v_cvt_pk_bf16_f32 v103, v78, v79
    v_exp_f32 v80, v80
    v_exp_f32 v81, v81
    v_mfma_f32_32x32x16_bf16 v[32:47], v[140:143], v[100:103], v[32:47]
    s_waitcnt lgkmcnt(0)
    ds_read_b32 v5, v3 offset:352
    v_exp_f32 v82, v82
    v_exp_f32 v83, v83
    v_exp_f32 v84, v84
    v_exp_f32 v85, v85
    v_cvt_pk_bf16_f32 v96, v80, v81
    v_mfma_f32_32x32x16_bf16 v[64:79], v[128:131], v[20:23], 0
    ds_read_b64_tr_b16 v[144:145], v185 offset:1536
    ds_read_b64_tr_b16 v[146:147], v185 offset:1664
    v_exp_f32 v86, v86
    v_exp_f32 v87, v87
    v_cvt_pk_bf16_f32 v97, v82, v83
    v_cvt_pk_bf16_f32 v98, v84, v85
    v_exp_f32 v88, v88
    v_exp_f32 v89, v89
    v_mfma_f32_32x32x16_bf16 v[64:79], v[132:135], v[16:19], v[64:79]
    ds_read_b64_tr_b16 v[148:149], v185 offset:1792
    ds_read_b64_tr_b16 v[150:151], v185 offset:1920
    v_cvt_pk_bf16_f32 v99, v86, v87
    v_exp_f32 v90, v90
    v_exp_f32 v91, v91
    v_exp_f32 v92, v92
    v_exp_f32 v93, v93
    v_mfma_f32_32x32x16_bf16 v[48:63], v[136:139], v[96:99], v[48:63]
    buffer_load_dwordx4 v[216:219], v6, s[16:19], s58 offen
    v_exp_f32 v94, v94
    v_exp_f32 v95, v95
    v_cvt_pk_bf16_f32 v100, v88, v89
    v_cvt_pk_bf16_f32 v101, v90, v91
    v_cvt_pk_bf16_f32 v102, v92, v93
    v_cvt_pk_bf16_f32 v103, v94, v95
    v_exp_f32 v64, v64
    v_exp_f32 v65, v65
    v_mfma_f32_32x32x16_bf16 v[48:63], v[140:143], v[100:103], v[48:63]
    s_waitcnt lgkmcnt(4)
    v_cmp_ne_u32 vcc, 0x27800, v5
    s_cbranch_vccnz L_cs_81
L_cb_82:
    ds_read_b128 v[104:107], v187 offset:1536
    ds_read_b128 v[108:111], v186 offset:1536
    v_exp_f32 v66, v66
    v_exp_f32 v67, v67
    v_exp_f32 v68, v68
    v_exp_f32 v69, v69
    v_cvt_pk_bf16_f32 v96, v64, v65
    v_mfma_f32_32x32x16_bf16 v[80:95], v[128:131], v[28:31], 0
    v_exp_f32 v70, v70
    v_exp_f32 v71, v71
    v_cvt_pk_bf16_f32 v97, v66, v67
    v_cvt_pk_bf16_f32 v98, v68, v69
    v_exp_f32 v72, v72
    v_exp_f32 v73, v73
    v_mfma_f32_32x32x16_bf16 v[80:95], v[132:135], v[24:27], v[80:95]
    s_waitcnt lgkmcnt(2)
    v_cvt_pk_bf16_f32 v99, v70, v71
    v_exp_f32 v74, v74
    v_exp_f32 v75, v75
    v_exp_f32 v76, v76
    v_exp_f32 v77, v77
    v_mfma_f32_32x32x16_bf16 v[32:47], v[144:147], v[96:99], v[32:47]
    buffer_load_dwordx4 v[220:223], v7, s[16:19], s58 offen
    v_exp_f32 v78, v78
    v_exp_f32 v79, v79
    v_cvt_pk_bf16_f32 v100, v72, v73
    v_cvt_pk_bf16_f32 v101, v74, v75
    v_cvt_pk_bf16_f32 v102, v76, v77
    v_cvt_pk_bf16_f32 v103, v78, v79
    v_exp_f32 v80, v80
    v_exp_f32 v81, v81
    v_mfma_f32_32x32x16_bf16 v[32:47], v[148:151], v[100:103], v[32:47]
    s_waitcnt lgkmcnt(0)
    v_exp_f32 v82, v82
    v_exp_f32 v83, v83
    v_exp_f32 v84, v84
    v_exp_f32 v85, v85
    v_cvt_pk_bf16_f32 v96, v80, v81
    v_mfma_f32_32x32x16_bf16 v[64:79], v[104:107], v[20:23], v[160:175]
    ds_read_b64_tr_b16 v[152:153], v188 offset:1536
    ds_read_b64_tr_b16 v[154:155], v188 offset:1664
    v_exp_f32 v86, v86
    v_exp_f32 v87, v87
    v_cvt_pk_bf16_f32 v97, v82, v83
    v_cvt_pk_bf16_f32 v98, v84, v85
    v_exp_f32 v88, v88
    v_exp_f32 v89, v89
    v_mfma_f32_32x32x16_bf16 v[64:79], v[108:111], v[16:19], v[64:79]
    ds_read_b64_tr_b16 v[156:157], v188 offset:1792
    ds_read_b64_tr_b16 v[158:159], v188 offset:1920
    v_cvt_pk_bf16_f32 v99, v86, v87
    v_exp_f32 v90, v90
    v_exp_f32 v91, v91
    v_exp_f32 v92, v92
    v_exp_f32 v93, v93
    v_mfma_f32_32x32x16_bf16 v[48:63], v[144:147], v[96:99], v[48:63]
    buffer_load_dwordx4 v[224:227], v8, s[16:19], s58 offen
    v_exp_f32 v94, v94
    v_exp_f32 v95, v95
    v_cvt_pk_bf16_f32 v100, v88, v89
    v_cvt_pk_bf16_f32 v101, v90, v91
    v_cvt_pk_bf16_f32 v102, v92, v93
    v_cvt_pk_bf16_f32 v103, v94, v95
    v_exp_f32 v64, v64
    v_exp_f32 v65, v65
    v_mfma_f32_32x32x16_bf16 v[48:63], v[148:151], v[100:103], v[48:63]
    ds_read_b128 v[112:115], v187 offset:1024
    ds_read_b128 v[116:119], v186 offset:1024
    buffer_load_dwordx2 v[192:193], v190, s[12:15], s56 offen sc1
    ds_read_b32 v5, v4 offset:400
    v_exp_f32 v66, v66
    v_exp_f32 v67, v67
    v_exp_f32 v68, v68
    v_exp_f32 v69, v69
    v_cvt_pk_bf16_f32 v96, v64, v65
    v_mfma_f32_32x32x16_bf16 v[80:95], v[104:107], v[28:31], 0
    v_exp_f32 v70, v70
    v_exp_f32 v71, v71
    v_cvt_pk_bf16_f32 v97, v66, v67
    v_cvt_pk_bf16_f32 v98, v68, v69
    v_exp_f32 v72, v72
    v_exp_f32 v73, v73
    v_mfma_f32_32x32x16_bf16 v[80:95], v[108:111], v[24:27], v[80:95]
    s_waitcnt lgkmcnt(3)
    v_cvt_pk_bf16_f32 v99, v70, v71
    v_exp_f32 v74, v74
    v_exp_f32 v75, v75
    v_exp_f32 v76, v76
    v_exp_f32 v77, v77
    v_mfma_f32_32x32x16_bf16 v[32:47], v[152:155], v[96:99], v[32:47]
    buffer_load_dwordx4 v[228:231], v9, s[16:19], s58 offen
    v_exp_f32 v78, v78
    v_exp_f32 v79, v79
    v_cvt_pk_bf16_f32 v100, v72, v73
    v_cvt_pk_bf16_f32 v101, v74, v75
    v_cvt_pk_bf16_f32 v102, v76, v77
    v_cvt_pk_bf16_f32 v103, v78, v79
    v_exp_f32 v80, v80
    v_exp_f32 v81, v81
    v_mfma_f32_32x32x16_bf16 v[32:47], v[156:159], v[100:103], v[32:47]
    s_waitcnt lgkmcnt(1)
    ds_read_b128 v[120:123], v187 offset:512
    ds_read_b128 v[124:127], v186 offset:512
    v_exp_f32 v82, v82
    v_exp_f32 v83, v83
    v_exp_f32 v84, v84
    v_exp_f32 v85, v85
    v_cvt_pk_bf16_f32 v96, v80, v81
    v_mfma_f32_32x32x16_bf16 v[64:79], v[112:115], v[28:31], 0
    ds_read_b64_tr_b16 v[136:137], v188 offset:1024
    ds_read_b64_tr_b16 v[138:139], v188 offset:1152
    v_exp_f32 v86, v86
    v_exp_f32 v87, v87
    v_cvt_pk_bf16_f32 v97, v82, v83
    v_cvt_pk_bf16_f32 v98, v84, v85
    v_exp_f32 v88, v88
    v_exp_f32 v89, v89
    v_mfma_f32_32x32x16_bf16 v[64:79], v[116:119], v[24:27], v[64:79]
    ds_read_b64_tr_b16 v[140:141], v188 offset:1280
    ds_read_b64_tr_b16 v[142:143], v188 offset:1408
    v_cvt_pk_bf16_f32 v99, v86, v87
    v_exp_f32 v90, v90
    v_exp_f32 v91, v91
    v_exp_f32 v92, v92
    v_exp_f32 v93, v93
    s_waitcnt lgkmcnt(6)
    v_cmp_ne_u32 vcc, 0x9e000, v5
    s_cbranch_vccnz L_cs_83
L_cb_84:
    v_cmp_ngt_f32 s[64:65], s62, v44
    s_cmp_lg_u64 s[64:65], 0
    s_cbranch_scc1 L_skC0
    v_rcp_f32 v177, v44
    s_add_u32 s40, s54, 122880
    s_add_u32 s41, s55, 122880
    v_mul_f32 v32, v32, v177
    v_mul_f32 v33, v33, v177
    v_mul_f32 v34, v34, v177
    v_mul_f32 v35, v35, v177
    v_mul_f32 v36, v36, v177
    v_mul_f32 v37, v37, v177
    v_mul_f32 v38, v38, v177
    v_mul_f32 v39, v39, v177
    v_mul_f32 v40, v40, v177
    v_mul_f32 v41, v41, v177
    v_mul_f32 v42, v42, v177
    v_mul_f32 v43, v43, v177
    v_cvt_pk_bf16_f32 v32, v32, v33
    v_cvt_pk_bf16_f32 v33, v34, v35
    v_cvt_pk_bf16_f32 v34, v36, v37
    v_cvt_pk_bf16_f32 v35, v38, v39
    v_cvt_pk_bf16_f32 v36, v40, v41
    v_cvt_pk_bf16_f32 v37, v42, v43
    v_min_u32 v32, 0xfffffffe, v32
    v_min_u32 v36, 0xfffffffe, v36
    buffer_store_dwordx4 v[32:35], v191, s[12:15], s40 offen sc1
    buffer_store_dwordx2 v[36:37], v2, s[12:15], s41 offen sc1
L_skipC0:
    v_mfma_f32_32x32x16_bf16 v[48:63], v[152:155], v[96:99], v[48:63]
    buffer_load_dwordx4 v[232:235], v10, s[16:19], s58 offen
    v_exp_f32 v94, v94
    v_exp_f32 v95, v95
    v_cvt_pk_bf16_f32 v100, v88, v89
    v_cvt_pk_bf16_f32 v101, v90, v91
    v_cvt_pk_bf16_f32 v102, v92, v93
    v_cvt_pk_bf16_f32 v103, v94, v95
    v_exp_f32 v64, v64
    v_exp_f32 v65, v65
    v_mfma_f32_32x32x16_bf16 v[48:63], v[156:159], v[100:103], v[48:63]
    s_waitcnt lgkmcnt(4)
    v_exp_f32 v66, v66
    v_exp_f32 v67, v67
    v_exp_f32 v68, v68
    v_exp_f32 v69, v69
    v_cvt_pk_bf16_f32 v96, v64, v65
    v_mfma_f32_32x32x16_bf16 v[80:95], v[120:123], v[28:31], v[160:175]
    ds_read_b64_tr_b16 v[144:145], v188 offset:512
    ds_read_b64_tr_b16 v[146:147], v188 offset:640
    v_exp_f32 v70, v70
    v_exp_f32 v71, v71
    v_cvt_pk_bf16_f32 v97, v66, v67
    v_cvt_pk_bf16_f32 v98, v68, v69
    v_exp_f32 v72, v72
    v_exp_f32 v73, v73
    v_mfma_f32_32x32x16_bf16 v[80:95], v[124:127], v[24:27], v[80:95]
    s_waitcnt lgkmcnt(2)
    ds_read_b64_tr_b16 v[148:149], v188 offset:768
    ds_read_b64_tr_b16 v[150:151], v188 offset:896
    v_cvt_pk_bf16_f32 v99, v70, v71
    v_exp_f32 v74, v74
    v_exp_f32 v75, v75
    v_exp_f32 v76, v76
    v_exp_f32 v77, v77
    v_mfma_f32_32x32x16_bf16 v[48:63], v[136:139], v[96:99], v[48:63]
    v_exp_f32 v78, v78
    v_exp_f32 v79, v79
    v_cvt_pk_bf16_f32 v100, v72, v73
    v_cvt_pk_bf16_f32 v101, v74, v75
    v_cvt_pk_bf16_f32 v102, v76, v77
    v_cvt_pk_bf16_f32 v103, v78, v79
    v_exp_f32 v80, v80
    v_exp_f32 v81, v81
    v_mfma_f32_32x32x16_bf16 v[48:63], v[140:143], v[100:103], v[48:63]
    v_exp_f32 v82, v82
    v_exp_f32 v83, v83
    v_exp_f32 v84, v84
    v_exp_f32 v85, v85
    v_cvt_pk_bf16_f32 v96, v80, v81
    v_exp_f32 v86, v86
    v_exp_f32 v87, v87
    v_cvt_pk_bf16_f32 v97, v82, v83
    v_cvt_pk_bf16_f32 v98, v84, v85
    v_exp_f32 v88, v88
    v_exp_f32 v89, v89
    s_waitcnt lgkmcnt(0)
    v_cvt_pk_bf16_f32 v99, v86, v87
    v_exp_f32 v90, v90
    v_exp_f32 v91, v91
    v_exp_f32 v92, v92
    v_exp_f32 v93, v93
    v_mfma_f32_32x32x16_bf16 v[48:63], v[144:147], v[96:99], v[48:63]
    v_exp_f32 v94, v94
    v_exp_f32 v95, v95
    v_cvt_pk_bf16_f32 v100, v88, v89
    v_cvt_pk_bf16_f32 v101, v90, v91
    v_cvt_pk_bf16_f32 v102, v92, v93
    v_cvt_pk_bf16_f32 v103, v94, v95
    s_nop 1
    v_mfma_f32_32x32x16_bf16 v[48:63], v[148:151], v[100:103], v[48:63]
    s_nop 11
    v_cmp_ngt_f32 s[66:67], s62, v60
    s_cmp_lg_u64 s[66:67], 0
    s_cbranch_scc1 L_skC1
    v_rcp_f32 v177, v60
    s_add_u32 s40, s54, 40960
    s_add_u32 s41, s55, 40960
    v_mul_f32 v48, v48, v177
    v_mul_f32 v49, v49, v177
    v_mul_f32 v50, v50, v177
    v_mul_f32 v51, v51, v177
    v_mul_f32 v52, v52, v177
    v_mul_f32 v53, v53, v177
    v_mul_f32 v54, v54, v177
    v_mul_f32 v55, v55, v177
    v_mul_f32 v56, v56, v177
    v_mul_f32 v57, v57, v177
    v_mul_f32 v58, v58, v177
    v_mul_f32 v59, v59, v177
    v_cvt_pk_bf16_f32 v48, v48, v49
    v_cvt_pk_bf16_f32 v49, v50, v51
    v_cvt_pk_bf16_f32 v50, v52, v53
    v_cvt_pk_bf16_f32 v51, v54, v55
    v_cvt_pk_bf16_f32 v52, v56, v57
    v_cvt_pk_bf16_f32 v53, v58, v59
    v_min_u32 v48, 0xfffffffe, v48
    v_min_u32 v52, 0xfffffffe, v52
    buffer_store_dwordx4 v[48:51], v191, s[12:15], s40 offen sc1
    buffer_store_dwordx2 v[52:53], v2, s[12:15], s41 offen sc1
L_skipC1:
    s_or_b64 vcc, s[64:65], s[66:67]
    s_cbranch_scc1 L_fixC
L_fixdC:
    s_mov_b64 exec, 1
    ds_add_u32 v4, v4 offset:308
    s_mov_b64 exec, -1
    s_mov_b64 exec, 1
    ds_add_u32 v4, v4 offset:408
    s_mov_b64 exec, -1
    s_mul_i32 s40, s37, 10752
    v_lshl_add_u32 v1, v0, 4, s40
    s_mov_b32 s62, 1
    s_bfe_u32 s42, s31, 0x10001
    s_and_b32 s44, s31, 1
    s_bfe_u32 s40, s31, 0x10002
    s_xor_b32 s40, s40, 1
    s_lshl1_add_u32 s44, s44, s40
    s_mul_i32 s40, s42, 20480
    s_sub_u32 s41, 20480, s40
    v_lshl_add_u32 v6, v0, 4, s40
    v_lshl_add_u32 v7, v0, 4, s41
    s_mul_i32 s40, s39, 163840
    s_add_u32 s40, s40, 0x640000
    s_mul_i32 s41, s44, 40960
    s_add_u32 s40, s40, s41
    s_lshl_b32 s41, s42, 13
    s_add_u32 s43, s40, s41
    s_add_u32 s41, s30, 0
    s_and_b32 s41, s41, 3
    s_lshl_b32 s41, s41, 11
    s_add_u32 s48, s43, s41
    s_add_u32 s41, s30, 1
    s_and_b32 s41, s41, 3
    s_lshl_b32 s41, s41, 11
    s_add_u32 s49, s43, s41
    s_add_u32 s41, s30, 2
    s_and_b32 s41, s41, 3
    s_lshl_b32 s41, s41, 11
    s_add_u32 s50, s43, s41
    s_add_u32 s41, s30, 3
    s_and_b32 s41, s41, 3
    s_lshl_b32 s41, s41, 11
    s_add_u32 s51, s43, s41
    s_lshl_b32 s41, s42, 11
    s_add_u32 s43, s40, s41
    s_add_u32 s43, s43, 16384
    s_bfe_u32 s41, s30, 0x10001
    s_lshl_b32 s41, s41, 10
    s_add_u32 s52, s43, s41
    s_xor_b32 s41, s41, 1024
    s_add_u32 s53, s43, s41
    v_lshrrev_b32 v16, 2, v0
    v_mul_u32_u24 v16, 160, v16
    v_and_b32 v17, 3, v0
    v_mul_u32_u24 v17, 40, v17
    s_mul_i32 s40, s42, 21504
    v_add3_u32 v15, v16, v17, s40
    s_mul_i32 s40, s42, 12288
    s_add_u32 s40, s40, 43008
    v_add3_u32 v14, v16, v17, s40
    s_mul_i32 s41, s28, 43008
    s_add_u32 s40, s41, 67584
    v_add_u32 v8, s40, v15
    s_sub_u32 s41, 110592, s41
    s_mul_i32 s40, s31, 5120
    s_add_u32 s40, s40, s41
    v_lshl_add_u32 v9, v0, 4, s40
    s_xor_b32 s40, s31, 2
    s_mul_i32 s40, s40, 5120
    s_add_u32 s40, s40, s41
    v_lshl_add_u32 v10, v0, 4, s40
    v_and_b32 v16, 15, v0
    v_lshrrev_b32 v17, 4, v0
    v_mul_u32_u24 v16, 2560, v16
    v_mad_u32_u24 v11, v17, 40, v16
    s_lshl_b32 s40, s29, 3
    s_lshl_b32 s41, s44, 1
    s_add_u32 s40, s40, s41
    s_add_u32 s40, s40, s42
    s_mul_i32 s57, s40, 40960
    s_mul_i32 s41, s28, 1280
    s_add_u32 s57, s57, s41
    s_mul_i32 s41, s30, 160
    s_add_u32 s57, s57, s41
    s_lshl_b32 s41, s44, 2
    v_add_u32 v12, s41, v4
    s_lshl2_add_u32 s3, s35, s44
    s_lshl1_add_u32 s3, s3, s42
    s_lshl_b32 s3, s3, 7
    s_add_u32 s3, s3, 0xb80000
    s_waitcnt vmcnt(6)
    v_cmp_ne_u64 vcc, s[32:33], v[192:193]
    s_cbranch_vccz L_cf_85
    s_mov_b32 s41, 32768
L_poll_86:
    buffer_load_dwordx2 v[192:193], v190, s[12:15], s56 offen sc1
    s_waitcnt vmcnt(0)
    v_cmp_ne_u64 vcc, s[32:33], v[192:193]
    s_nop 4
    s_cbranch_vccz L_pdone_87
    s_sub_u32 s41, s41, 1
    s_cmp_lg_u32 s41, 0
    s_cbranch_scc1 L_poll_86
L_pdone_87:
L_cf_85:
    s_waitcnt vmcnt(2)
    ds_read_b32 v5, v4 offset:308
    s_waitcnt lgkmcnt(0)
    v_cmp_ne_u32 vcc, 0x13c000, v5
    s_cbranch_vccnz L_cs_88
L_cb_89:
    s_nop 3
    s_branch L_p3w
L_cs_65:
    s_mov_b32 s47, 1048576
L_cs_65l:
    ds_read_b32 v5, v4 offset:248
    s_waitcnt lgkmcnt(0)
    v_cmp_ne_u32 vcc, 0x9e000, v5
    s_cbranch_vccz L_cb_66
    s_sub_u32 s47, s47, 1
    s_cmp_lg_u32 s47, 0
    s_cbranch_scc1 L_cs_65l
    s_branch L_cb_66
L_cs_67:
    s_mov_b32 s47, 1048576
L_cs_67l:
    ds_read_b32 v5, v4 offset:124
    s_waitcnt lgkmcnt(0)
    v_cmp_ne_u32 vcc, 0x9e000, v5
    s_cbranch_vccz L_cb_68
    s_sub_u32 s47, s47, 1
    s_cmp_lg_u32 s47, 0
    s_cbranch_scc1 L_cs_67l
    s_branch L_cb_68
L_cs_69:
    s_mov_b32 s47, 1048576
L_cs_69l:
    ds_read_b32 v5, v4 offset:144
    s_waitcnt lgkmcnt(0)
    v_cmp_ne_u32 vcc, 0x9e000, v5
    s_cbranch_vccz L_cb_70
    s_sub_u32 s47, s47, 1
    s_cmp_lg_u32 s47, 0
    s_cbranch_scc1 L_cs_69l
    s_branch L_cb_70
L_cs_71:
    s_mov_b32 s47, 1048576
L_cs_71l:
    ds_read_b32 v5, v4 offset:148
    s_waitcnt lgkmcnt(0)
    v_cmp_ne_u32 vcc, 0x9e000, v5
    s_cbranch_vccz L_cb_72
    s_sub_u32 s47, s47, 1
    s_cmp_lg_u32 s47, 0
    s_cbranch_scc1 L_cs_71l
    s_branch L_cb_72
L_cs_73:
    s_mov_b32 s47, 1048576
L_cs_73l:
    ds_read_b32 v5, v4 offset:152
    s_waitcnt lgkmcnt(0)
    v_cmp_ne_u32 vcc, 0x9e000, v5
    s_cbranch_vccz L_cb_74
    s_sub_u32 s47, s47, 1
    s_cmp_lg_u32 s47, 0
    s_cbranch_scc1 L_cs_73l
    s_branch L_cb_74
L_cs_75:
    s_mov_b32 s47, 1048576
L_cs_75l:
    ds_read_b32 v5, v4 offset:276
    s_waitcnt lgkmcnt(0)
    v_cmp_ne_u32 vcc, 0x9e000, v5
    s_cbranch_vccz L_cb_76
    s_sub_u32 s47, s47, 1
    s_cmp_lg_u32 s47, 0
    s_cbranch_scc1 L_cs_75l
    s_branch L_cb_76
L_cs_77:
    s_mov_b32 s47, 1048576
L_cs_77l:
    ds_read_b32 v5, v4 offset:184
    s_waitcnt lgkmcnt(0)
    v_cmp_ne_u32 vcc, 0x9e000, v5
    s_cbranch_vccz L_cb_78
    s_sub_u32 s47, s47, 1
    s_cmp_lg_u32 s47, 0
    s_cbranch_scc1 L_cs_77l
    s_branch L_cb_78
L_cs_79:
    s_mov_b32 s47, 1048576
L_cs_79l:
    ds_read_b32 v5, v3 offset:336
    s_waitcnt lgkmcnt(0)
    v_cmp_ne_u32 vcc, 0x27800, v5
    s_cbranch_vccz L_cb_80
    s_sub_u32 s47, s47, 1
    s_cmp_lg_u32 s47, 0
    s_cbranch_scc1 L_cs_79l
    s_branch L_cb_80
L_cs_81:
    s_mov_b32 s47, 1048576
L_cs_81l:
    ds_read_b32 v5, v3 offset:352
    s_waitcnt lgkmcnt(0)
    v_cmp_ne_u32 vcc, 0x27800, v5
    s_cbranch_vccz L_cb_82
    s_sub_u32 s47, s47, 1
    s_cmp_lg_u32 s47, 0
    s_cbranch_scc1 L_cs_81l
    s_branch L_cb_82
L_cs_83:
    s_mov_b32 s47, 1048576
L_cs_83l:
    ds_read_b32 v5, v4 offset:400
    s_waitcnt lgkmcnt(0)
    v_cmp_ne_u32 vcc, 0x9e000, v5
    s_cbranch_vccz L_cb_84
    s_sub_u32 s47, s47, 1
    s_cmp_lg_u32 s47, 0
    s_cbranch_scc1 L_cs_83l
    s_branch L_cb_84
L_cs_88:
    s_mov_b32 s47, 1048576
L_cs_88l:
    ds_read_b32 v5, v4 offset:308
    s_waitcnt lgkmcnt(0)
    v_cmp_ne_u32 vcc, 0x13c000, v5
    s_cbranch_vccz L_cb_89
    s_sub_u32 s47, s47, 1
    s_cmp_lg_u32 s47, 0
    s_cbranch_scc1 L_cs_88l
    s_branch L_cb_89
L_attH:
    ds_read_b128 v[104:107], v181 offset:0
    ds_read_b128 v[108:111], v180 offset:0
    ds_read_b128 v[112:115], v181 offset:512
    ds_read_b128 v[116:119], v180 offset:512
    ds_read_b128 v[120:123], v181 offset:1024
    ds_read_b128 v[124:127], v180 offset:1024
    ds_read_b128 v[160:163], v189 offset:256
    ds_read_b128 v[164:167], v189 offset:288
    ds_read_b128 v[168:171], v189 offset:320
    ds_read_b128 v[172:175], v189 offset:352
    ds_read_b32 v5, v4 offset:184
    s_waitcnt lgkmcnt(0)
    v_cmp_ne_u32 vcc, 0x9e000, v5
    s_cbranch_vccnz L_cs_90
L_cb_91:
    buffer_load_dwordx2 v[82:83], v80, s[12:15], s50 offen sc1
    ds_read_b64 v[20:21], v96 offset:5120
    ds_read_b128 v[16:19], v97 offset:1024
    ds_read_b64 v[28:29], v96 offset:4096
    ds_read_b128 v[24:27], v97 offset:0
    ds_read_b64_tr_b16 v[136:137], v182 offset:0
    ds_read_b64_tr_b16 v[138:139], v182 offset:128
    ds_read_b64_tr_b16 v[140:141], v182 offset:256
    ds_read_b64_tr_b16 v[142:143], v182 offset:384
    v_mov_b32 v176, 0xbf80
    v_mov_b32 v22, 0
    v_mov_b32 v23, 0
    v_mov_b32 v30, 0
    v_mov_b32 v31, 0
    s_waitcnt lgkmcnt(6)
    v_cndmask_b32 v20, v20, 0, s[80:81]
    v_cndmask_b32 v21, v21, v176, s[80:81]
    s_waitcnt lgkmcnt(4)
    v_cndmask_b32 v28, v28, 0, s[80:81]
    v_cndmask_b32 v29, v29, v176, s[80:81]
    v_mfma_f32_32x32x16_bf16 v[32:47], v[120:123], v[20:23], v[160:175]
    v_mfma_f32_32x32x16_bf16 v[32:47], v[124:127], v[16:19], v[32:47]
    v_mfma_f32_32x32x16_bf16 v[48:63], v[104:107], v[28:31], v[160:175]
    v_mfma_f32_32x32x16_bf16 v[48:63], v[108:111], v[24:27], v[48:63]
    s_nop 9
    v_max3_f32 v176, v32, v33, v34
    v_max_f32 v176, v176, v35
    v_max3_f32 v176, v176, v36, v37
    v_max3_f32 v176, v176, v38, v39
    v_max3_f32 v176, v176, v40, v41
    v_max3_f32 v176, v176, v42, v43
    v_max3_f32 v176, v176, v44, v45
    v_max3_f32 v176, v176, v46, v47
    v_mov_b32 v177, v176
    s_nop 1
    v_permlane32_swap_b32 v177, v176
    v_max_f32 v176, v176, v177
    v_sub_f32 v176, 0xc1a00000, v176
    v_and_b32 v177, 0xffff0000, v176
    v_sub_f32 v176, v176, v177
    v_and_b32 v176, 0xffff0000, v176
    v_lshrrev_b32 v177, 16, v177
    v_or_b32 v177, v177, v176
    v_cndmask_b32 v20, v20, v177, s[80:81]
    v_max3_f32 v178, v48, v49, v50
    v_max_f32 v178, v178, v51
    v_max3_f32 v178, v178, v52, v53
    v_max3_f32 v178, v178, v54, v55
    v_max3_f32 v178, v178, v56, v57
    v_max3_f32 v178, v178, v58, v59
    v_max3_f32 v178, v178, v60, v61
    v_max3_f32 v178, v178, v62, v63
    v_mov_b32 v179, v178
    s_nop 1
    v_permlane32_swap_b32 v179, v178
    v_max_f32 v178, v178, v179
    v_sub_f32 v178, 0xc1a00000, v178
    v_and_b32 v179, 0xffff0000, v178
    v_sub_f32 v178, v178, v179
    v_and_b32 v178, 0xffff0000, v178
    v_lshrrev_b32 v179, 16, v179
    v_or_b32 v179, v179, v178
    v_cndmask_b32 v28, v28, v179, s[80:81]
    s_waitcnt vmcnt(0)
    v_cmp_ne_u64 vcc, s[32:33], v[82:83]
    s_cbranch_vccz L_nfok
    s_mov_b32 s41, 32768
L_poll_92:
    buffer_load_dwordx2 v[82:83], v80, s[12:15], s50 offen sc1
    s_waitcnt vmcnt(0)
    v_cmp_ne_u64 vcc, s[32:33], v[82:83]
    s_nop 4
    s_cbranch_vccz L_pdone_93
    s_sub_u32 s41, s41, 1
    s_cmp_lg_u32 s41, 0
    s_cbranch_scc1 L_poll_92
L_pdone_93:
L_nfok:
    s_add_u32 m0, s51, 6464
    s_add_u32 s40, s48, 0x21980
    buffer_load_dwordx4 v1, s[12:15], s40 offen offset:0 sc1 lds
    buffer_load_dwordx4 v1, s[12:15], s40 offen offset:1024 sc1 lds
    s_add_u32 m0, s51, 8512
    s_add_u32 s40, s48, 0x22180
    buffer_load_dwordx4 v1, s[12:15], s40 offen offset:0 sc1 lds
    buffer_load_dwordx4 v1, s[12:15], s40 offen offset:1024 sc1 lds
    s_add_u32 m0, s51, 4416
    s_add_u32 s40, s48, 0x21180
    buffer_load_dwordx4 v1, s[12:15], s40 offen offset:0 sc1 lds
    buffer_load_dwordx4 v1, s[12:15], s40 offen offset:1024 sc1 lds
    s_add_u32 m0, s51, 0
    s_add_u32 s40, s48, 0x20000
    buffer_load_dwordx4 v1, s[12:15], s40 offen offset:0 sc1 lds
    buffer_load_dwordx4 v1, s[12:15], s40 offen offset:1024 sc1 lds
    s_add_u32 m0, s51, 2176
    s_add_u32 s40, s48, 0x20880
    buffer_load_dwordx4 v1, s[12:15], s40 offen offset:0 sc1 lds
    buffer_load_dwordx4 v1, s[12:15], s40 offen offset:1024 sc1 lds
    s_branch L_main_hotH
L_mainH:
    ds_read_b128 v[104:107], v181 offset:0
    ds_read_b128 v[108:111], v180 offset:0
    ds_read_b128 v[112:115], v181 offset:512
    ds_read_b128 v[116:119], v180 offset:512
    ds_read_b128 v[120:123], v181 offset:1024
    ds_read_b128 v[124:127], v180 offset:1024
    ds_read_b128 v[160:163], v189 offset:256
    ds_read_b128 v[164:167], v189 offset:288
    ds_read_b128 v[168:171], v189 offset:320
    ds_read_b128 v[172:175], v189 offset:352
    ds_read_b64_tr_b16 v[136:137], v182 offset:0
    ds_read_b64_tr_b16 v[138:139], v182 offset:128
    ds_read_b64_tr_b16 v[140:141], v182 offset:256
    ds_read_b64_tr_b16 v[142:143], v182 offset:384
    s_waitcnt lgkmcnt(0)
L_main_hotH:
    v_mfma_f32_32x32x16_bf16 v[64:79], v[104:107], v[20:23], 0
    v_mfma_f32_32x32x16_bf16 v[64:79], v[108:111], v[16:19], v[64:79]
    s_nop 11
    v_exp_f32 v64, v64
    v_exp_f32 v65, v65
    v_exp_f32 v66, v66
    v_exp_f32 v67, v67
    v_exp_f32 v68, v68
    v_exp_f32 v69, v69
    v_cvt_pk_bf16_f32 v96, v64, v65
    v_mfma_f32_32x32x16_bf16 v[80:95], v[104:107], v[28:31], v[160:175]
    v_exp_f32 v70, v70
    v_exp_f32 v71, v71
    v_cvt_pk_bf16_f32 v97, v66, v67
    v_cvt_pk_bf16_f32 v98, v68, v69
    v_exp_f32 v72, v72
    v_exp_f32 v73, v73
    v_mfma_f32_32x32x16_bf16 v[80:95], v[108:111], v[24:27], v[80:95]
    s_waitcnt lgkmcnt(0)
    v_cvt_pk_bf16_f32 v99, v70, v71
    v_exp_f32 v74, v74
    v_exp_f32 v75, v75
    v_exp_f32 v76, v76
    v_exp_f32 v77, v77
    v_mfma_f32_32x32x16_bf16 v[32:47], v[136:139], v[96:99], 0
    v_exp_f32 v78, v78
    v_exp_f32 v79, v79
    v_cvt_pk_bf16_f32 v100, v72, v73
    v_cvt_pk_bf16_f32 v101, v74, v75
    v_cvt_pk_bf16_f32 v102, v76, v77
    v_cvt_pk_bf16_f32 v103, v78, v79
    v_exp_f32 v80, v80
    v_exp_f32 v81, v81
    v_mfma_f32_32x32x16_bf16 v[32:47], v[140:143], v[100:103], v[32:47]
    v_exp_f32 v82, v82
    v_exp_f32 v83, v83
    v_exp_f32 v84, v84
    v_exp_f32 v85, v85
    v_cvt_pk_bf16_f32 v96, v80, v81
    v_mfma_f32_32x32x16_bf16 v[64:79], v[112:115], v[20:23], 0
    ds_read_b64_tr_b16 v[144:145], v182 offset:512
    ds_read_b64_tr_b16 v[146:147], v182 offset:640
    v_exp_f32 v86, v86
    v_exp_f32 v87, v87
    v_cvt_pk_bf16_f32 v97, v82, v83
    v_cvt_pk_bf16_f32 v98, v84, v85
    v_exp_f32 v88, v88
    v_exp_f32 v89, v89
    v_mfma_f32_32x32x16_bf16 v[64:79], v[116:119], v[16:19], v[64:79]
    ds_read_b64_tr_b16 v[148:149], v182 offset:768
    ds_read_b64_tr_b16 v[150:151], v182 offset:896
    v_cvt_pk_bf16_f32 v99, v86, v87
    v_exp_f32 v90, v90
    v_exp_f32 v91, v91
    v_exp_f32 v92, v92
    v_exp_f32 v93, v93
    v_mfma_f32_32x32x16_bf16 v[48:63], v[136:139], v[96:99], 0
    v_exp_f32 v94, v94
    v_exp_f32 v95, v95
    v_cvt_pk_bf16_f32 v100, v88, v89
    v_cvt_pk_bf16_f32 v101, v90, v91
    v_cvt_pk_bf16_f32 v102, v92, v93
    v_cvt_pk_bf16_f32 v103, v94, v95
    v_exp_f32 v64, v64
    v_exp_f32 v65, v65
    v_mfma_f32_32x32x16_bf16 v[48:63], v[140:143], v[100:103], v[48:63]
    s_add_u32 m0, s51, 74048
    s_add_u32 s40, s49, 0x21980
    buffer_load_dwordx4 v1, s[12:15], s40 offen offset:0 sc1 lds
    buffer_load_dwordx4 v1, s[12:15], s40 offen offset:1024 sc1 lds
    v_exp_f32 v66, v66
    v_exp_f32 v67, v67
    v_exp_f32 v68, v68
    v_exp_f32 v69, v69
    v_cvt_pk_bf16_f32 v96, v64, v65
    v_mfma_f32_32x32x16_bf16 v[80:95], v[120:123], v[20:23], v[160:175]
    ds_read_b64_tr_b16 v[152:153], v182 offset:1024
    ds_read_b64_tr_b16 v[154:155], v182 offset:1152
    v_exp_f32 v70, v70
    v_exp_f32 v71, v71
    v_cvt_pk_bf16_f32 v97, v66, v67
    v_cvt_pk_bf16_f32 v98, v68, v69
    v_exp_f32 v72, v72
    v_exp_f32 v73, v73
    v_mfma_f32_32x32x16_bf16 v[80:95], v[124:127], v[16:19], v[80:95]
    s_waitcnt lgkmcnt(2)
    ds_read_b64_tr_b16 v[156:157], v182 offset:1280
    ds_read_b64_tr_b16 v[158:159], v182 offset:1408
    v_cvt_pk_bf16_f32 v99, v70, v71
    v_exp_f32 v74, v74
    v_exp_f32 v75, v75
    v_exp_f32 v76, v76
    v_exp_f32 v77, v77
    v_mfma_f32_32x32x16_bf16 v[32:47], v[144:147], v[96:99], v[32:47]
    s_add_u32 m0, s51, 76096
    s_add_u32 s40, s49, 0x22180
    buffer_load_dwordx4 v1, s[12:15], s40 offen offset:0 sc1 lds
    buffer_load_dwordx4 v1, s[12:15], s40 offen offset:1024 sc1 lds
    v_exp_f32 v78, v78
    v_exp_f32 v79, v79
    v_cvt_pk_bf16_f32 v100, v72, v73
    v_cvt_pk_bf16_f32 v101, v74, v75
    v_cvt_pk_bf16_f32 v102, v76, v77
    v_cvt_pk_bf16_f32 v103, v78, v79
    v_exp_f32 v80, v80
    v_exp_f32 v81, v81
    v_mfma_f32_32x32x16_bf16 v[32:47], v[148:151], v[100:103], v[32:47]
    s_add_u32 m0, s51, 72000
    s_add_u32 s40, s49, 0x21180
    buffer_load_dwordx4 v1, s[12:15], s40 offen offset:0 sc1 lds
    buffer_load_dwordx4 v1, s[12:15], s40 offen offset:1024 sc1 lds
    v_exp_f32 v82, v82
    v_exp_f32 v83, v83
    v_exp_f32 v84, v84
    v_exp_f32 v85, v85
    v_cvt_pk_bf16_f32 v96, v80, v81
    v_exp_f32 v86, v86
    v_exp_f32 v87, v87
    v_cvt_pk_bf16_f32 v97, v82, v83
    v_cvt_pk_bf16_f32 v98, v84, v85
    v_exp_f32 v88, v88
    v_exp_f32 v89, v89
    s_waitcnt lgkmcnt(0)
    v_cvt_pk_bf16_f32 v99, v86, v87
    v_exp_f32 v90, v90
    v_exp_f32 v91, v91
    v_exp_f32 v92, v92
    v_exp_f32 v93, v93
    v_mfma_f32_32x32x16_bf16 v[32:47], v[152:155], v[96:99], v[32:47]
    s_add_u32 m0, s51, 67584
    s_add_u32 s40, s49, 0x20000
    buffer_load_dwordx4 v1, s[12:15], s40 offen offset:0 sc1 lds
    buffer_load_dwordx4 v1, s[12:15], s40 offen offset:1024 sc1 lds
    s_add_u32 m0, s51, 69760
    s_add_u32 s40, s49, 0x20880
    buffer_load_dwordx4 v1, s[12:15], s40 offen offset:0 sc1 lds
    buffer_load_dwordx4 v1, s[12:15], s40 offen offset:1024 sc1 lds
    v_exp_f32 v94, v94
    v_exp_f32 v95, v95
    v_cvt_pk_bf16_f32 v100, v88, v89
    v_cvt_pk_bf16_f32 v101, v90, v91
    v_cvt_pk_bf16_f32 v102, v92, v93
    v_cvt_pk_bf16_f32 v103, v94, v95
    s_setprio 0
    s_nop 0
    v_mfma_f32_32x32x16_bf16 v[32:47], v[156:159], v[100:103], v[32:47]
    s_waitcnt vmcnt(10)
    ds_write_b32 v3, v4 offset:336
    ds_read_b128 v[128:131], v184 offset:0
    ds_read_b128 v[132:135], v183 offset:0
    s_nop 7
    v_max_f32 v176, v44, v60
    v_cmp_u_f32 s[64:65], v44, v60
    v_cmp_ngt_f32 vcc, 0x4e800000, v176
    s_mov_b32 s62, 0x71800000
    s_or_b64 vcc, vcc, s[64:65]
    s_and_b64 vcc, vcc, s[52:53]
    s_cbranch_scc1 L_slowH
    ds_read_b32 v5, v3 offset:416
    ds_read_b64_tr_b16 v[136:137], v185 offset:0
    ds_read_b64_tr_b16 v[138:139], v185 offset:128
    ds_read_b64_tr_b16 v[140:141], v185 offset:256
    ds_read_b64_tr_b16 v[142:143], v185 offset:384
    s_waitcnt lgkmcnt(5)
    v_mfma_f32_32x32x16_bf16 v[64:79], v[128:131], v[20:23], 0
    v_mfma_f32_32x32x16_bf16 v[64:79], v[132:135], v[16:19], v[64:79]
    ds_read_b128 v[104:107], v184 offset:512
    ds_read_b128 v[108:111], v183 offset:512
    ds_read_b128 v[160:163], v189 offset:0
    ds_read_b128 v[164:167], v189 offset:32
    ds_read_b128 v[168:171], v189 offset:64
    ds_read_b128 v[172:175], v189 offset:96
    s_nop 5
    v_exp_f32 v64, v64
    v_exp_f32 v65, v65
    v_exp_f32 v66, v66
    v_exp_f32 v67, v67
    v_exp_f32 v68, v68
    v_exp_f32 v69, v69
    v_cvt_pk_bf16_f32 v96, v64, v65
    v_mfma_f32_32x32x16_bf16 v[80:95], v[128:131], v[28:31], 0
    v_exp_f32 v70, v70
    v_exp_f32 v71, v71
    v_cvt_pk_bf16_f32 v97, v66, v67
    v_cvt_pk_bf16_f32 v98, v68, v69
    v_exp_f32 v72, v72
    v_exp_f32 v73, v73
    v_mfma_f32_32x32x16_bf16 v[80:95], v[132:135], v[24:27], v[80:95]
    s_waitcnt lgkmcnt(6)
    v_cvt_pk_bf16_f32 v99, v70, v71
    v_exp_f32 v74, v74
    v_exp_f32 v75, v75
    v_exp_f32 v76, v76
    v_exp_f32 v77, v77
    v_mfma_f32_32x32x16_bf16 v[32:47], v[136:139], v[96:99], v[32:47]
    v_cmp_ne_u32 vcc, 0x27800, v5
    s_cbranch_vccnz L_cs_94
L_cb_95:
    s_add_u32 m0, s60, 0
    s_nop 0
    buffer_load_dwordx4 v6, s[16:19], s57 offen lds
    s_add_u32 m0, s60, 1024
    s_nop 0
    buffer_load_dwordx4 v7, s[16:19], s57 offen lds
    v_exp_f32 v78, v78
    v_exp_f32 v79, v79
    v_cvt_pk_bf16_f32 v100, v72, v73
    v_cvt_pk_bf16_f32 v101, v74, v75
    v_cvt_pk_bf16_f32 v102, v76, v77
    v_cvt_pk_bf16_f32 v103, v78, v79
    v_exp_f32 v80, v80
    v_exp_f32 v81, v81
    v_mfma_f32_32x32x16_bf16 v[32:47], v[140:143], v[100:103], v[32:47]
    s_waitcnt lgkmcnt(4)
    v_exp_f32 v82, v82
    v_exp_f32 v83, v83
    v_exp_f32 v84, v84
    v_exp_f32 v85, v85
    v_cvt_pk_bf16_f32 v96, v80, v81
    v_mfma_f32_32x32x16_bf16 v[64:79], v[104:107], v[20:23], 0
    ds_read_b64_tr_b16 v[144:145], v185 offset:512
    ds_read_b64_tr_b16 v[146:147], v185 offset:640
    v_exp_f32 v86, v86
    v_exp_f32 v87, v87
    v_cvt_pk_bf16_f32 v97, v82, v83
    v_cvt_pk_bf16_f32 v98, v84, v85
    v_exp_f32 v88, v88
    v_exp_f32 v89, v89
    v_mfma_f32_32x32x16_bf16 v[64:79], v[108:111], v[16:19], v[64:79]
    ds_read_b64_tr_b16 v[148:149], v185 offset:768
    ds_read_b64_tr_b16 v[150:151], v185 offset:896
    v_cvt_pk_bf16_f32 v99, v86, v87
    v_exp_f32 v90, v90
    v_exp_f32 v91, v91
    v_exp_f32 v92, v92
    v_exp_f32 v93, v93
    v_mfma_f32_32x32x16_bf16 v[48:63], v[136:139], v[96:99], v[48:63]
    s_add_u32 m0, s60, 2048
    s_nop 0
    buffer_load_dwordx4 v8, s[16:19], s57 offen lds
    s_add_u32 m0, s60, 3072
    s_nop 0
    buffer_load_dwordx4 v9, s[16:19], s57 offen lds
    v_exp_f32 v94, v94
    v_exp_f32 v95, v95
    v_cvt_pk_bf16_f32 v100, v88, v89
    v_cvt_pk_bf16_f32 v101, v90, v91
    v_cvt_pk_bf16_f32 v102, v92, v93
    v_cvt_pk_bf16_f32 v103, v94, v95
    v_exp_f32 v64, v64
    v_exp_f32 v65, v65
    v_mfma_f32_32x32x16_bf16 v[48:63], v[140:143], v[100:103], v[48:63]
    ds_read_b128 v[112:115], v184 offset:1024
    ds_read_b128 v[116:119], v183 offset:1024
    v_exp_f32 v66, v66
    v_exp_f32 v67, v67
    v_exp_f32 v68, v68
    v_exp_f32 v69, v69
    v_cvt_pk_bf16_f32 v96, v64, v65
    v_mfma_f32_32x32x16_bf16 v[80:95], v[104:107], v[28:31], 0
    v_exp_f32 v70, v70
    v_exp_f32 v71, v71
    v_cvt_pk_bf16_f32 v97, v66, v67
    v_cvt_pk_bf16_f32 v98, v68, v69
    v_exp_f32 v72, v72
    v_exp_f32 v73, v73
    v_mfma_f32_32x32x16_bf16 v[80:95], v[108:111], v[24:27], v[80:95]
    s_waitcnt lgkmcnt(2)
    v_cvt_pk_bf16_f32 v99, v70, v71
    v_exp_f32 v74, v74
    v_exp_f32 v75, v75
    v_exp_f32 v76, v76
    v_exp_f32 v77, v77
    v_mfma_f32_32x32x16_bf16 v[32:47], v[144:147], v[96:99], v[32:47]
    s_add_u32 m0, s60, 4096
    s_nop 0
    buffer_load_dwordx4 v10, s[16:19], s57 offen lds
    s_add_u32 m0, s60, 5120
    s_nop 0
    buffer_load_dwordx4 v6, s[16:19], s58 offen lds
    v_exp_f32 v78, v78
    v_exp_f32 v79, v79
    v_cvt_pk_bf16_f32 v100, v72, v73
    v_cvt_pk_bf16_f32 v101, v74, v75
    v_cvt_pk_bf16_f32 v102, v76, v77
    v_cvt_pk_bf16_f32 v103, v78, v79
    v_exp_f32 v80, v80
    v_exp_f32 v81, v81
    v_mfma_f32_32x32x16_bf16 v[32:47], v[148:151], v[100:103], v[32:47]
    s_waitcnt lgkmcnt(0)
    v_exp_f32 v82, v82
    v_exp_f32 v83, v83
    v_exp_f32 v84, v84
    v_exp_f32 v85, v85
    v_cvt_pk_bf16_f32 v96, v80, v81
    v_mfma_f32_32x32x16_bf16 v[64:79], v[112:115], v[20:23], 0
    ds_read_b64_tr_b16 v[152:153], v185 offset:1024
    ds_read_b64_tr_b16 v[154:155], v185 offset:1152
    v_exp_f32 v86, v86
    v_exp_f32 v87, v87
    v_cvt_pk_bf16_f32 v97, v82, v83
    v_cvt_pk_bf16_f32 v98, v84, v85
    v_exp_f32 v88, v88
    v_exp_f32 v89, v89
    v_mfma_f32_32x32x16_bf16 v[64:79], v[116:119], v[16:19], v[64:79]
    ds_read_b64_tr_b16 v[156:157], v185 offset:1280
    ds_read_b64_tr_b16 v[158:159], v185 offset:1408
    v_cvt_pk_bf16_f32 v99, v86, v87
    v_exp_f32 v90, v90
    v_exp_f32 v91, v91
    v_exp_f32 v92, v92
    v_exp_f32 v93, v93
    v_mfma_f32_32x32x16_bf16 v[48:63], v[144:147], v[96:99], v[48:63]
    s_add_u32 m0, s60, 6144
    s_nop 0
    buffer_load_dwordx4 v7, s[16:19], s58 offen lds
    s_add_u32 m0, s60, 7168
    s_nop 0
    buffer_load_dwordx4 v8, s[16:19], s58 offen lds
    v_exp_f32 v94, v94
    v_exp_f32 v95, v95
    v_cvt_pk_bf16_f32 v100, v88, v89
    v_cvt_pk_bf16_f32 v101, v90, v91
    v_cvt_pk_bf16_f32 v102, v92, v93
    v_cvt_pk_bf16_f32 v103, v94, v95
    v_exp_f32 v64, v64
    v_exp_f32 v65, v65
    v_mfma_f32_32x32x16_bf16 v[48:63], v[148:151], v[100:103], v[48:63]
    s_waitcnt vmcnt(8)
    ds_write_b32 v3, v4 offset:352
    ds_read_b128 v[120:123], v184 offset:1536
    ds_read_b128 v[124:127], v183 offset:1536
    v_exp_f32 v66, v66
    v_exp_f32 v67, v67
    v_exp_f32 v68, v68
    v_exp_f32 v69, v69
    v_cvt_pk_bf16_f32 v96, v64, v65
    v_mfma_f32_32x32x16_bf16 v[80:95], v[112:115], v[28:31], 0
    v_exp_f32 v70, v70
    v_exp_f32 v71, v71
    v_cvt_pk_bf16_f32 v97, v66, v67
    v_cvt_pk_bf16_f32 v98, v68, v69
    v_exp_f32 v72, v72
    v_exp_f32 v73, v73
    v_mfma_f32_32x32x16_bf16 v[80:95], v[116:119], v[24:27], v[80:95]
    s_waitcnt lgkmcnt(3)
    v_cvt_pk_bf16_f32 v99, v70, v71
    v_exp_f32 v74, v74
    v_exp_f32 v75, v75
    v_exp_f32 v76, v76
    v_exp_f32 v77, v77
    v_mfma_f32_32x32x16_bf16 v[32:47], v[152:155], v[96:99], v[32:47]
    s_add_u32 m0, s60, 8192
    s_nop 0
    buffer_load_dwordx4 v9, s[16:19], s58 offen lds
    s_add_u32 m0, s60, 9216
    s_nop 0
    buffer_load_dwordx4 v10, s[16:19], s58 offen lds
    v_exp_f32 v78, v78
    v_exp_f32 v79, v79
    v_cvt_pk_bf16_f32 v100, v72, v73
    v_cvt_pk_bf16_f32 v101, v74, v75
    v_cvt_pk_bf16_f32 v102, v76, v77
    v_cvt_pk_bf16_f32 v103, v78, v79
    v_exp_f32 v80, v80
    v_exp_f32 v81, v81
    v_mfma_f32_32x32x16_bf16 v[32:47], v[156:159], v[100:103], v[32:47]
    s_waitcnt lgkmcnt(0)
    v_exp_f32 v82, v82
    v_exp_f32 v83, v83
    v_exp_f32 v84, v84
    v_exp_f32 v85, v85
    v_cvt_pk_bf16_f32 v96, v80, v81
    v_mfma_f32_32x32x16_bf16 v[64:79], v[120:123], v[20:23], 0
    ds_read_b64_tr_b16 v[136:137], v185 offset:1536
    ds_read_b64_tr_b16 v[138:139], v185 offset:1664
    v_exp_f32 v86, v86
    v_exp_f32 v87, v87
    v_cvt_pk_bf16_f32 v97, v82, v83
    v_cvt_pk_bf16_f32 v98, v84, v85
    v_exp_f32 v88, v88
    v_exp_f32 v89, v89
    v_mfma_f32_32x32x16_bf16 v[64:79], v[124:127], v[16:19], v[64:79]
    ds_read_b64_tr_b16 v[140:141], v185 offset:1792
    ds_read_b64_tr_b16 v[142:143], v185 offset:1920
    v_cvt_pk_bf16_f32 v99, v86, v87
    v_exp_f32 v90, v90
    v_exp_f32 v91, v91
    v_exp_f32 v92, v92
    v_exp_f32 v93, v93
    v_mfma_f32_32x32x16_bf16 v[48:63], v[152:155], v[96:99], v[48:63]
    s_add_u32 m0, s61, 0
    s_nop 0
    buffer_load_dwordx4 v11, s[16:19], s59 offen lds
    s_add_u32 m0, s61, 1024
    s_nop 0
    buffer_load_dwordx4 v12, s[16:19], s59 offen lds
    v_exp_f32 v94, v94
    v_exp_f32 v95, v95
    v_cvt_pk_bf16_f32 v100, v88, v89
    v_cvt_pk_bf16_f32 v101, v90, v91
    v_cvt_pk_bf16_f32 v102, v92, v93
    v_cvt_pk_bf16_f32 v103, v94, v95
    v_exp_f32 v64, v64
    v_exp_f32 v65, v65
    v_mfma_f32_32x32x16_bf16 v[48:63], v[156:159], v[100:103], v[48:63]
    ds_read_b128 v[128:131], v187 offset:1536
    ds_read_b128 v[132:135], v186 offset:1536
    v_exp_f32 v66, v66
    v_exp_f32 v67, v67
    v_exp_f32 v68, v68
    v_exp_f32 v69, v69
    v_cvt_pk_bf16_f32 v96, v64, v65
    v_mfma_f32_32x32x16_bf16 v[80:95], v[120:123], v[28:31], 0
    v_exp_f32 v70, v70
    v_exp_f32 v71, v71
    v_cvt_pk_bf16_f32 v97, v66, v67
    v_cvt_pk_bf16_f32 v98, v68, v69
    v_exp_f32 v72, v72
    v_exp_f32 v73, v73
    v_mfma_f32_32x32x16_bf16 v[80:95], v[124:127], v[24:27], v[80:95]
    s_waitcnt lgkmcnt(2)
    v_cvt_pk_bf16_f32 v99, v70, v71
    v_exp_f32 v74, v74
    v_exp_f32 v75, v75
    v_exp_f32 v76, v76
    v_exp_f32 v77, v77
    v_mfma_f32_32x32x16_bf16 v[32:47], v[136:139], v[96:99], v[32:47]
    s_add_u32 m0, s61, 2048
    s_nop 0
    buffer_load_dwordx4 v13, s[16:19], s59 offen lds
    s_add_u32 m0, s61, 3072
    s_nop 0
    buffer_load_dwordx4 v14, s[16:19], s59 offen lds
    v_exp_f32 v78, v78
    v_exp_f32 v79, v79
    v_cvt_pk_bf16_f32 v100, v72, v73
    v_cvt_pk_bf16_f32 v101, v74, v75
    v_cvt_pk_bf16_f32 v102, v76, v77
    v_cvt_pk_bf16_f32 v103, v78, v79
    v_exp_f32 v80, v80
    v_exp_f32 v81, v81
    v_mfma_f32_32x32x16_bf16 v[32:47], v[140:143], v[100:103], v[32:47]
    s_waitcnt lgkmcnt(0)
    v_exp_f32 v82, v82
    v_exp_f32 v83, v83
    v_exp_f32 v84, v84
    v_exp_f32 v85, v85
    v_cvt_pk_bf16_f32 v96, v80, v81
    v_mfma_f32_32x32x16_bf16 v[64:79], v[128:131], v[20:23], 0
    ds_read_b64_tr_b16 v[144:145], v188 offset:1536
    ds_read_b64_tr_b16 v[146:147], v188 offset:1664
    v_exp_f32 v86, v86
    v_exp_f32 v87, v87
    v_cvt_pk_bf16_f32 v97, v82, v83
    v_cvt_pk_bf16_f32 v98, v84, v85
    v_exp_f32 v88, v88
    v_exp_f32 v89, v89
    v_mfma_f32_32x32x16_bf16 v[64:79], v[132:135], v[16:19], v[64:79]
    ds_read_b64_tr_b16 v[148:149], v188 offset:1792
    ds_read_b64_tr_b16 v[150:151], v188 offset:1920
    v_cvt_pk_bf16_f32 v99, v86, v87
    v_exp_f32 v90, v90
    v_exp_f32 v91, v91
    v_exp_f32 v92, v92
    v_exp_f32 v93, v93
    v_mfma_f32_32x32x16_bf16 v[48:63], v[136:139], v[96:99], v[48:63]
    s_add_u32 m0, s61, 4096
    s_nop 0
    buffer_load_dwordx4 v15, s[16:19], s59 offen lds
    v_exp_f32 v94, v94
    v_exp_f32 v95, v95
    v_cvt_pk_bf16_f32 v100, v88, v89
    v_cvt_pk_bf16_f32 v101, v90, v91
    v_cvt_pk_bf16_f32 v102, v92, v93
    v_cvt_pk_bf16_f32 v103, v94, v95
    v_exp_f32 v64, v64
    v_exp_f32 v65, v65
    v_mfma_f32_32x32x16_bf16 v[48:63], v[140:143], v[100:103], v[48:63]
    ds_read_b128 v[104:107], v187 offset:1024
    ds_read_b128 v[108:111], v186 offset:1024
    v_exp_f32 v66, v66
    v_exp_f32 v67, v67
    v_exp_f32 v68, v68
    v_exp_f32 v69, v69
    v_cvt_pk_bf16_f32 v96, v64, v65
    v_mfma_f32_32x32x16_bf16 v[80:95], v[128:131], v[28:31], 0
    v_exp_f32 v70, v70
    v_exp_f32 v71, v71
    v_cvt_pk_bf16_f32 v97, v66, v67
    v_cvt_pk_bf16_f32 v98, v68, v69
    v_exp_f32 v72, v72
    v_exp_f32 v73, v73
    v_mfma_f32_32x32x16_bf16 v[80:95], v[132:135], v[24:27], v[80:95]
    s_waitcnt lgkmcnt(2)
    v_cvt_pk_bf16_f32 v99, v70, v71
    v_exp_f32 v74, v74
    v_exp_f32 v75, v75
    v_exp_f32 v76, v76
    v_exp_f32 v77, v77
    v_mfma_f32_32x32x16_bf16 v[32:47], v[144:147], v[96:99], v[32:47]
    v_exp_f32 v78, v78
    v_exp_f32 v79, v79
    v_cvt_pk_bf16_f32 v100, v72, v73
    v_cvt_pk_bf16_f32 v101, v74, v75
    v_cvt_pk_bf16_f32 v102, v76, v77
    v_cvt_pk_bf16_f32 v103, v78, v79
    v_exp_f32 v80, v80
    v_exp_f32 v81, v81
    v_mfma_f32_32x32x16_bf16 v[32:47], v[148:151], v[100:103], v[32:47]
    s_waitcnt lgkmcnt(0)
    v_exp_f32 v82, v82
    v_exp_f32 v83, v83
    v_exp_f32 v84, v84
    v_exp_f32 v85, v85
    v_cvt_pk_bf16_f32 v96, v80, v81
    v_mfma_f32_32x32x16_bf16 v[64:79], v[104:107], v[20:23], v[160:175]
    ds_read_b64_tr_b16 v[152:153], v188 offset:1024
    ds_read_b64_tr_b16 v[154:155], v188 offset:1152
    v_exp_f32 v86, v86
    v_exp_f32 v87, v87
    v_cvt_pk_bf16_f32 v97, v82, v83
    v_cvt_pk_bf16_f32 v98, v84, v85
    v_exp_f32 v88, v88
    v_exp_f32 v89, v89
    v_mfma_f32_32x32x16_bf16 v[64:79], v[108:111], v[16:19], v[64:79]
    ds_read_b64_tr_b16 v[156:157], v188 offset:1280
    ds_read_b64_tr_b16 v[158:159], v188 offset:1408
    v_cvt_pk_bf16_f32 v99, v86, v87
    v_exp_f32 v90, v90
    v_exp_f32 v91, v91
    v_exp_f32 v92, v92
    v_exp_f32 v93, v93
    v_mfma_f32_32x32x16_bf16 v[48:63], v[144:147], v[96:99], v[48:63]
    v_exp_f32 v94, v94
    v_exp_f32 v95, v95
    v_cvt_pk_bf16_f32 v100, v88, v89
    v_cvt_pk_bf16_f32 v101, v90, v91
    v_cvt_pk_bf16_f32 v102, v92, v93
    v_cvt_pk_bf16_f32 v103, v94, v95
    v_exp_f32 v64, v64
    v_exp_f32 v65, v65
    v_mfma_f32_32x32x16_bf16 v[48:63], v[148:151], v[100:103], v[48:63]
    ds_read_b128 v[112:115], v187 offset:512
    ds_read_b128 v[116:119], v186 offset:512
    buffer_load_dwordx2 v[192:193], v190, s[12:15], s56 offen sc1
    ds_read_b32 v5, v4 offset:400
    v_exp_f32 v66, v66
    v_exp_f32 v67, v67
    v_exp_f32 v68, v68
    v_exp_f32 v69, v69
    v_cvt_pk_bf16_f32 v96, v64, v65
    v_mfma_f32_32x32x16_bf16 v[80:95], v[104:107], v[28:31], 0
    v_exp_f32 v70, v70
    v_exp_f32 v71, v71
    v_cvt_pk_bf16_f32 v97, v66, v67
    v_cvt_pk_bf16_f32 v98, v68, v69
    v_exp_f32 v72, v72
    v_exp_f32 v73, v73
    v_mfma_f32_32x32x16_bf16 v[80:95], v[108:111], v[24:27], v[80:95]
    s_waitcnt lgkmcnt(3)
    v_cvt_pk_bf16_f32 v99, v70, v71
    v_exp_f32 v74, v74
    v_exp_f32 v75, v75
    v_exp_f32 v76, v76
    v_exp_f32 v77, v77
    v_mfma_f32_32x32x16_bf16 v[32:47], v[152:155], v[96:99], v[32:47]
    v_exp_f32 v78, v78
    v_exp_f32 v79, v79
    v_cvt_pk_bf16_f32 v100, v72, v73
    v_cvt_pk_bf16_f32 v101, v74, v75
    v_cvt_pk_bf16_f32 v102, v76, v77
    v_cvt_pk_bf16_f32 v103, v78, v79
    v_exp_f32 v80, v80
    v_exp_f32 v81, v81
    v_mfma_f32_32x32x16_bf16 v[32:47], v[156:159], v[100:103], v[32:47]
    s_waitcnt lgkmcnt(1)
    ds_read_b128 v[120:123], v187 offset:0
    ds_read_b128 v[124:127], v186 offset:0
    v_exp_f32 v82, v82
    v_exp_f32 v83, v83
    v_exp_f32 v84, v84
    v_exp_f32 v85, v85
    v_cvt_pk_bf16_f32 v96, v80, v81
    v_mfma_f32_32x32x16_bf16 v[64:79], v[112:115], v[28:31], 0
    ds_read_b64_tr_b16 v[136:137], v188 offset:512
    ds_read_b64_tr_b16 v[138:139], v188 offset:640
    v_exp_f32 v86, v86
    v_exp_f32 v87, v87
    v_cvt_pk_bf16_f32 v97, v82, v83
    v_cvt_pk_bf16_f32 v98, v84, v85
    v_exp_f32 v88, v88
    v_exp_f32 v89, v89
    v_mfma_f32_32x32x16_bf16 v[64:79], v[116:119], v[24:27], v[64:79]
    ds_read_b64_tr_b16 v[140:141], v188 offset:768
    ds_read_b64_tr_b16 v[142:143], v188 offset:896
    v_cvt_pk_bf16_f32 v99, v86, v87
    v_exp_f32 v90, v90
    v_exp_f32 v91, v91
    v_exp_f32 v92, v92
    v_exp_f32 v93, v93
    s_waitcnt lgkmcnt(6)
    v_cmp_ne_u32 vcc, 0x9e000, v5
    s_cbranch_vccnz L_cs_96
L_cb_97:
    v_cmp_ngt_f32 s[64:65], s62, v44
    s_cmp_lg_u64 s[64:65], 0
    s_cbranch_scc1 L_skH0
    v_rcp_f32 v177, v44
    s_add_u32 s40, s54, 81920
    s_add_u32 s41, s55, 81920
    v_mul_f32 v32, v32, v177
    v_mul_f32 v33, v33, v177
    v_mul_f32 v34, v34, v177
    v_mul_f32 v35, v35, v177
    v_mul_f32 v36, v36, v177
    v_mul_f32 v37, v37, v177
    v_mul_f32 v38, v38, v177
    v_mul_f32 v39, v39, v177
    v_mul_f32 v40, v40, v177
    v_mul_f32 v41, v41, v177
    v_mul_f32 v42, v42, v177
    v_mul_f32 v43, v43, v177
    v_cvt_pk_bf16_f32 v32, v32, v33
    v_cvt_pk_bf16_f32 v33, v34, v35
    v_cvt_pk_bf16_f32 v34, v36, v37
    v_cvt_pk_bf16_f32 v35, v38, v39
    v_cvt_pk_bf16_f32 v36, v40, v41
    v_cvt_pk_bf16_f32 v37, v42, v43
    v_min_u32 v32, 0xfffffffe, v32
    v_min_u32 v36, 0xfffffffe, v36
    buffer_store_dwordx4 v[32:35], v191, s[12:15], s40 offen sc1
    buffer_store_dwordx2 v[36:37], v2, s[12:15], s41 offen sc1
L_skipH0:
    v_mfma_f32_32x32x16_bf16 v[48:63], v[152:155], v[96:99], v[48:63]
    v_exp_f32 v94, v94
    v_exp_f32 v95, v95
    v_cvt_pk_bf16_f32 v100, v88, v89
    v_cvt_pk_bf16_f32 v101, v90, v91
    v_cvt_pk_bf16_f32 v102, v92, v93
    v_cvt_pk_bf16_f32 v103, v94, v95
    v_exp_f32 v64, v64
    v_exp_f32 v65, v65
    v_mfma_f32_32x32x16_bf16 v[48:63], v[156:159], v[100:103], v[48:63]
    s_waitcnt vmcnt(3)
    s_mov_b64 exec, 1
    ds_add_u32 v4, v4 offset:404
    s_mov_b64 exec, -1
    s_waitcnt lgkmcnt(5)
    v_exp_f32 v66, v66
    v_exp_f32 v67, v67
    v_exp_f32 v68, v68
    v_exp_f32 v69, v69
    v_cvt_pk_bf16_f32 v96, v64, v65
    v_mfma_f32_32x32x16_bf16 v[80:95], v[120:123], v[28:31], v[160:175]
    ds_read_b64_tr_b16 v[144:145], v188 offset:0
    ds_read_b64_tr_b16 v[146:147], v188 offset:128
    v_exp_f32 v70, v70
    v_exp_f32 v71, v71
    v_cvt_pk_bf16_f32 v97, v66, v67
    v_cvt_pk_bf16_f32 v98, v68, v69
    v_exp_f32 v72, v72
    v_exp_f32 v73, v73
    v_mfma_f32_32x32x16_bf16 v[80:95], v[124:127], v[24:27], v[80:95]
    s_waitcnt lgkmcnt(3)
    ds_read_b64_tr_b16 v[148:149], v188 offset:256
    ds_read_b64_tr_b16 v[150:151], v188 offset:384
    v_cvt_pk_bf16_f32 v99, v70, v71
    v_exp_f32 v74, v74
    v_exp_f32 v75, v75
    v_exp_f32 v76, v76
    v_exp_f32 v77, v77
    v_mfma_f32_32x32x16_bf16 v[48:63], v[136:139], v[96:99], v[48:63]
    v_exp_f32 v78, v78
    v_exp_f32 v79, v79
    v_cvt_pk_bf16_f32 v100, v72, v73
    v_cvt_pk_bf16_f32 v101, v74, v75
    v_cvt_pk_bf16_f32 v102, v76, v77
    v_cvt_pk_bf16_f32 v103, v78, v79
    v_exp_f32 v80, v80
    v_exp_f32 v81, v81
    v_mfma_f32_32x32x16_bf16 v[48:63], v[140:143], v[100:103], v[48:63]
    v_exp_f32 v82, v82
    v_exp_f32 v83, v83
    v_exp_f32 v84, v84
    v_exp_f32 v85, v85
    v_cvt_pk_bf16_f32 v96, v80, v81
    v_exp_f32 v86, v86
    v_exp_f32 v87, v87
    v_cvt_pk_bf16_f32 v97, v82, v83
    v_cvt_pk_bf16_f32 v98, v84, v85
    v_exp_f32 v88, v88
    v_exp_f32 v89, v89
    s_waitcnt lgkmcnt(0)
    v_cvt_pk_bf16_f32 v99, v86, v87
    v_exp_f32 v90, v90
    v_exp_f32 v91, v91
    v_exp_f32 v92, v92
    v_exp_f32 v93, v93
    v_mfma_f32_32x32x16_bf16 v[48:63], v[144:147], v[96:99], v[48:63]
    v_exp_f32 v94, v94
    v_exp_f32 v95, v95
    v_cvt_pk_bf16_f32 v100, v88, v89
    v_cvt_pk_bf16_f32 v101, v90, v91
    v_cvt_pk_bf16_f32 v102, v92, v93
    v_cvt_pk_bf16_f32 v103, v94, v95
    s_nop 1
    v_mfma_f32_32x32x16_bf16 v[48:63], v[148:151], v[100:103], v[48:63]
    s_nop 11
    v_cmp_ngt_f32 s[66:67], s62, v60
    s_cmp_lg_u64 s[66:67], 0
    s_cbranch_scc1 L_skH1
    v_rcp_f32 v177, v60
    s_add_u32 s40, s54, 0
    s_add_u32 s41, s55, 0
    v_mul_f32 v48, v48, v177
    v_mul_f32 v49, v49, v177
    v_mul_f32 v50, v50, v177
    v_mul_f32 v51, v51, v177
    v_mul_f32 v52, v52, v177
    v_mul_f32 v53, v53, v177
    v_mul_f32 v54, v54, v177
    v_mul_f32 v55, v55, v177
    v_mul_f32 v56, v56, v177
    v_mul_f32 v57, v57, v177
    v_mul_f32 v58, v58, v177
    v_mul_f32 v59, v59, v177
    v_cvt_pk_bf16_f32 v48, v48, v49
    v_cvt_pk_bf16_f32 v49, v50, v51
    v_cvt_pk_bf16_f32 v50, v52, v53
    v_cvt_pk_bf16_f32 v51, v54, v55
    v_cvt_pk_bf16_f32 v52, v56, v57
    v_cvt_pk_bf16_f32 v53, v58, v59
    v_min_u32 v48, 0xfffffffe, v48
    v_min_u32 v52, 0xfffffffe, v52
    buffer_store_dwordx4 v[48:51], v191, s[12:15], s40 offen sc1
    buffer_store_dwordx2 v[52:53], v2, s[12:15], s41 offen sc1
L_skipH1:
    s_or_b64 vcc, s[64:65], s[66:67]
    s_cbranch_scc1 L_fixH
L_fixdH:
    s_mov_b64 exec, 1
    ds_add_u32 v4, v4 offset:308
    s_mov_b64 exec, -1
    s_mov_b64 exec, 1
    ds_add_u32 v4, v4 offset:304
    s_mov_b64 exec, -1
    s_mov_b32 s62, 0
    s_bfe_u32 s42, s31, 0x10001
    s_and_b32 s44, s31, 1
    s_bfe_u32 s40, s31, 0x10002
    s_xor_b32 s40, s40, 1
    s_lshl1_add_u32 s44, s44, s40
    s_mul_i32 s40, s42, 20480
    s_sub_u32 s41, 20480, s40
    v_lshl_add_u32 v6, v0, 4, s40
    v_lshl_add_u32 v7, v0, 4, s41
    s_mul_i32 s40, s39, 163840
    s_add_u32 s40, s40, 0x640000
    s_mul_i32 s41, s44, 40960
    s_add_u32 s40, s40, s41
    s_lshl_b32 s41, s42, 13
    s_add_u32 s43, s40, s41
    s_add_u32 s41, s30, 0
    s_and_b32 s41, s41, 3
    s_lshl_b32 s41, s41, 11
    s_add_u32 s48, s43, s41
    s_add_u32 s41, s30, 1
    s_and_b32 s41, s41, 3
    s_lshl_b32 s41, s41, 11
    s_add_u32 s49, s43, s41
    s_add_u32 s41, s30, 2
    s_and_b32 s41, s41, 3
    s_lshl_b32 s41, s41, 11
    s_add_u32 s50, s43, s41
    s_add_u32 s41, s30, 3
    s_and_b32 s41, s41, 3
    s_lshl_b32 s41, s41, 11
    s_add_u32 s51, s43, s41
    s_lshl_b32 s41, s42, 11
    s_add_u32 s43, s40, s41
    s_add_u32 s43, s43, 16384
    s_bfe_u32 s41, s30, 0x10001
    s_lshl_b32 s41, s41, 10
    s_add_u32 s52, s43, s41
    s_xor_b32 s41, s41, 1024
    s_add_u32 s53, s43, s41
    v_lshrrev_b32 v16, 2, v0
    v_mul_u32_u24 v16, 160, v16
    v_and_b32 v17, 3, v0
    v_mul_u32_u24 v17, 40, v17
    s_mul_i32 s40, s42, 21504
    v_add3_u32 v15, v16, v17, s40
    s_mul_i32 s40, s42, 12288
    s_add_u32 s40, s40, 43008
    v_add3_u32 v14, v16, v17, s40
    s_mul_i32 s41, s28, 43008
    s_add_u32 s40, s41, 67584
    v_add_u32 v8, s40, v15
    s_sub_u32 s41, 110592, s41
    s_mul_i32 s40, s31, 5120
    s_add_u32 s40, s40, s41
    v_lshl_add_u32 v9, v0, 4, s40
    s_xor_b32 s40, s31, 2
    s_mul_i32 s40, s40, 5120
    s_add_u32 s40, s40, s41
    v_lshl_add_u32 v10, v0, 4, s40
    v_and_b32 v16, 15, v0
    v_lshrrev_b32 v17, 4, v0
    v_mul_u32_u24 v16, 2560, v16
    v_mad_u32_u24 v11, v17, 40, v16
    s_lshl_b32 s40, s29, 3
    s_lshl_b32 s41, s44, 1
    s_add_u32 s40, s40, s41
    s_add_u32 s40, s40, s42
    s_mul_i32 s57, s40, 40960
    s_mul_i32 s41, s28, 1280
    s_add_u32 s57, s57, s41
    s_mul_i32 s41, s30, 160
    s_add_u32 s57, s57, s41
    s_lshl_b32 s41, s44, 2
    v_add_u32 v12, s41, v4
    s_lshl2_add_u32 s3, s35, s44
    s_lshl1_add_u32 s3, s3, s42
    s_lshl_b32 s3, s3, 7
    s_add_u32 s3, s3, 0xb80000
    s_waitcnt vmcnt(4)
    v_cmp_ne_u64 vcc, s[32:33], v[192:193]
    s_cbranch_vccz L_cf_98
    s_mov_b32 s41, 32768
L_poll_99:
    buffer_load_dwordx2 v[192:193], v190, s[12:15], s56 offen sc1
    s_waitcnt vmcnt(0)
    v_cmp_ne_u64 vcc, s[32:33], v[192:193]
    s_nop 4
    s_cbranch_vccz L_pdone_100
    s_sub_u32 s41, s41, 1
    s_cmp_lg_u32 s41, 0
    s_cbranch_scc1 L_poll_99
L_pdone_100:
L_cf_98:
    ds_read_b32 v5, v4 offset:308
    s_waitcnt lgkmcnt(0)
    v_cmp_ne_u32 vcc, 0x13c000, v5
    s_cbranch_vccnz L_cs_101
L_cb_102:
    s_sleep 12
    s_nop 2
    s_branch L_p3w
L_cs_90:
    s_mov_b32 s47, 1048576
L_cs_90l:
    ds_read_b32 v5, v4 offset:184
    s_waitcnt lgkmcnt(0)
    v_cmp_ne_u32 vcc, 0x9e000, v5
    s_cbranch_vccz L_cb_91
    s_sub_u32 s47, s47, 1
    s_cmp_lg_u32 s47, 0
    s_cbranch_scc1 L_cs_90l
    s_branch L_cb_91
L_cs_94:
    s_mov_b32 s47, 1048576
L_cs_94l:
    ds_read_b32 v5, v3 offset:416
    s_waitcnt lgkmcnt(0)
    v_cmp_ne_u32 vcc, 0x27800, v5
    s_cbranch_vccz L_cb_95
    s_sub_u32 s47, s47, 1
    s_cmp_lg_u32 s47, 0
    s_cbranch_scc1 L_cs_94l
    s_branch L_cb_95
L_cs_96:
    s_mov_b32 s47, 1048576
L_cs_96l:
    ds_read_b32 v5, v4 offset:400
    s_waitcnt lgkmcnt(0)
    v_cmp_ne_u32 vcc, 0x9e000, v5
    s_cbranch_vccz L_cb_97
    s_sub_u32 s47, s47, 1
    s_cmp_lg_u32 s47, 0
    s_cbranch_scc1 L_cs_96l
    s_branch L_cb_97
L_cs_101:
    s_mov_b32 s47, 1048576
L_cs_101l:
    ds_read_b32 v5, v4 offset:308
    s_waitcnt lgkmcnt(0)
    v_cmp_ne_u32 vcc, 0x13c000, v5
    s_cbranch_vccz L_cb_102
    s_sub_u32 s47, s47, 1
    s_cmp_lg_u32 s47, 0
    s_cbranch_scc1 L_cs_101l
    s_branch L_cb_102
L_A_c:
    v_and_b32 v1, 3, v0
    v_lshrrev_b32 v2, 4, v0
    v_bfe_u32 v3, v0, 2, 2
    v_mul_u32_u24 v3, 40, v3
    v_mov_b32 v67, 960
    v_mad_u32_u24 v3, v2, v67, v3
    v_add_u32 v3, 156928, v3
    v_mov_b32 v67, 160768
    v_cmp_eq_u32 vcc, v1, v2
    s_nop 1
    v_cndmask_b32 v3, v67, v3, vcc
    ds_read_b64_tr_b16 v[96:97], v3 offset:0
    ds_read_b64_tr_b16 v[98:99], v3 offset:160
    ds_read_b64_tr_b16 v[100:101], v3 offset:320
    ds_read_b64_tr_b16 v[102:103], v3 offset:480
    ds_read_b64_tr_b16 v[104:105], v3 offset:640
    v_mov_b32 v106, 0
    v_mov_b32 v107, 0
    ds_read_b64_tr_b16 v[108:109], v3 offset:8
    ds_read_b64_tr_b16 v[110:111], v3 offset:168
    ds_read_b64_tr_b16 v[112:113], v3 offset:328
    ds_read_b64_tr_b16 v[114:115], v3 offset:488
    ds_read_b64_tr_b16 v[116:117], v3 offset:648
    v_mov_b32 v118, 0
    v_mov_b32 v119, 0
    ds_read_b64_tr_b16 v[120:121], v3 offset:16
    ds_read_b64_tr_b16 v[122:123], v3 offset:176
    ds_read_b64_tr_b16 v[124:125], v3 offset:336
    ds_read_b64_tr_b16 v[126:127], v3 offset:496
    ds_read_b64_tr_b16 v[128:129], v3 offset:656
    v_mov_b32 v130, 0
    v_mov_b32 v131, 0
    ds_read_b64_tr_b16 v[132:133], v3 offset:24
    ds_read_b64_tr_b16 v[134:135], v3 offset:184
    ds_read_b64_tr_b16 v[136:137], v3 offset:344
    ds_read_b64_tr_b16 v[138:139], v3 offset:504
    ds_read_b64_tr_b16 v[140:141], v3 offset:664
    v_mov_b32 v142, 0
    v_mov_b32 v143, 0
    ds_read_b64_tr_b16 v[144:145], v3 offset:32
    ds_read_b64_tr_b16 v[146:147], v3 offset:192
    ds_read_b64_tr_b16 v[148:149], v3 offset:352
    ds_read_b64_tr_b16 v[150:151], v3 offset:512
    ds_read_b64_tr_b16 v[152:153], v3 offset:672
    v_mov_b32 v154, 0
    v_mov_b32 v155, 0
    v_and_b32 v72, 3, v0
    v_bfe_u32 v74, v0, 2, 2
    v_lshlrev_b32 v72, 7, v72
    v_lshl_add_u32 v72, v74, 3, v72
    s_lshl_b32 s56, s39, 10
    s_bfe_u32 s41, s31, 0x10001
    s_lshl_b32 s41, s41, 9
    s_add_u32 s56, s56, s41
    s_add_u32 s56, s56, 0xb40000
    v_cvt_pk_bf16_f32 v16, v16, v17
    v_cvt_pk_bf16_f32 v17, v18, v19
    v_cvt_pk_bf16_f32 v18, v20, v21
    v_cvt_pk_bf16_f32 v19, v22, v23
    v_cvt_pk_bf16_f32 v20, v24, v25
    v_cvt_pk_bf16_f32 v21, v26, v27
    v_cvt_pk_bf16_f32 v22, v28, v29
    v_cvt_pk_bf16_f32 v23, v30, v31
    v_cvt_pk_bf16_f32 v24, v32, v33
    v_cvt_pk_bf16_f32 v25, v34, v35
    v_mov_b32 v26, 0
    v_mov_b32 v27, 0
    v_cvt_pk_bf16_f32 v36, v36, v37
    v_cvt_pk_bf16_f32 v37, v38, v39
    v_cvt_pk_bf16_f32 v38, v40, v41
    v_cvt_pk_bf16_f32 v39, v42, v43
    v_cvt_pk_bf16_f32 v40, v44, v45
    v_cvt_pk_bf16_f32 v41, v46, v47
    v_cvt_pk_bf16_f32 v42, v48, v49
    v_cvt_pk_bf16_f32 v43, v50, v51
    v_cvt_pk_bf16_f32 v44, v52, v53
    v_cvt_pk_bf16_f32 v45, v54, v55
    v_mov_b32 v46, 0
    v_mov_b32 v47, 0
    s_waitcnt lgkmcnt(0)
    v_mfma_f32_16x16x32_bf16 v[156:159], v[96:99], v[16:19], 0
    v_mfma_f32_16x16x32_bf16 v[156:159], v[100:103], v[20:23], v[156:159]
    v_mfma_f32_16x16x32_bf16 v[156:159], v[104:107], v[24:27], v[156:159]
    v_mfma_f32_16x16x32_bf16 v[160:163], v[108:111], v[16:19], 0
    v_mfma_f32_16x16x32_bf16 v[160:163], v[112:115], v[20:23], v[160:163]
    v_mfma_f32_16x16x32_bf16 v[160:163], v[116:119], v[24:27], v[160:163]
    v_mfma_f32_16x16x32_bf16 v[164:167], v[120:123], v[16:19], 0
    v_mfma_f32_16x16x32_bf16 v[164:167], v[124:127], v[20:23], v[164:167]
    v_mfma_f32_16x16x32_bf16 v[164:167], v[128:131], v[24:27], v[164:167]
    v_mfma_f32_16x16x32_bf16 v[168:171], v[132:135], v[16:19], 0
    v_mfma_f32_16x16x32_bf16 v[168:171], v[136:139], v[20:23], v[168:171]
    v_mfma_f32_16x16x32_bf16 v[168:171], v[140:143], v[24:27], v[168:171]
    v_mfma_f32_16x16x32_bf16 v[172:175], v[144:147], v[16:19], 0
    v_mfma_f32_16x16x32_bf16 v[172:175], v[148:151], v[20:23], v[172:175]
    v_mfma_f32_16x16x32_bf16 v[172:175], v[152:155], v[24:27], v[172:175]
    v_max3_f32 v196, v156, v157, v158
    v_min3_f32 v197, v156, v157, v158
    v_max3_f32 v196, v196, v159, v160
    v_min3_f32 v197, v197, v159, v160
    v_max3_f32 v196, v196, v161, v162
    v_min3_f32 v197, v197, v161, v162
    v_max3_f32 v196, v196, v163, v164
    v_min3_f32 v197, v197, v163, v164
    v_max3_f32 v196, v196, v165, v166
    v_min3_f32 v197, v197, v165, v166
    v_max3_f32 v196, v196, v167, v168
    v_min3_f32 v197, v197, v167, v168
    v_max3_f32 v196, v196, v169, v170
    v_min3_f32 v197, v197, v169, v170
    v_max3_f32 v196, v196, v171, v172
    v_min3_f32 v197, v197, v171, v172
    v_max3_f32 v196, v196, v173, v174
    v_min3_f32 v197, v197, v173, v174
    v_max_f32 v196, v196, v175
    v_min_f32 v197, v197, v175
    v_mul_f32 v196, 0xbfb8aa3b, v196
    v_mul_f32 v197, 0x3fb8aa3b, v197
    s_mov_b32 s44, 0x3fb8aa3b
    v_fma_f32 v176, v156, s44, v196
    v_fma_f32 v156, -v156, s44, v197
    v_fma_f32 v177, v157, s44, v196
    v_fma_f32 v157, -v157, s44, v197
    v_fma_f32 v178, v158, s44, v196
    v_fma_f32 v158, -v158, s44, v197
    v_fma_f32 v179, v159, s44, v196
    v_fma_f32 v159, -v159, s44, v197
    v_fma_f32 v180, v160, s44, v196
    v_fma_f32 v160, -v160, s44, v197
    v_fma_f32 v181, v161, s44, v196
    v_fma_f32 v161, -v161, s44, v197
    v_fma_f32 v182, v162, s44, v196
    v_fma_f32 v162, -v162, s44, v197
    v_fma_f32 v183, v163, s44, v196
    v_fma_f32 v163, -v163, s44, v197
    v_fma_f32 v184, v164, s44, v196
    v_fma_f32 v164, -v164, s44, v197
    v_fma_f32 v185, v165, s44, v196
    v_fma_f32 v165, -v165, s44, v197
    v_fma_f32 v186, v166, s44, v196
    v_fma_f32 v166, -v166, s44, v197
    v_fma_f32 v187, v167, s44, v196
    v_fma_f32 v167, -v167, s44, v197
    v_fma_f32 v188, v168, s44, v196
    v_fma_f32 v168, -v168, s44, v197
    v_fma_f32 v189, v169, s44, v196
    v_fma_f32 v169, -v169, s44, v197
    v_fma_f32 v190, v170, s44, v196
    v_fma_f32 v170, -v170, s44, v197
    v_fma_f32 v191, v171, s44, v196
    v_fma_f32 v171, -v171, s44, v197
    v_fma_f32 v192, v172, s44, v196
    v_fma_f32 v172, -v172, s44, v197
    v_fma_f32 v193, v173, s44, v196
    v_fma_f32 v173, -v173, s44, v197
    v_fma_f32 v194, v174, s44, v196
    v_fma_f32 v174, -v174, s44, v197
    v_fma_f32 v195, v175, s44, v196
    v_fma_f32 v175, -v175, s44, v197
    v_exp_f32 v176, v176
    v_exp_f32 v156, v156
    v_exp_f32 v177, v177
    v_exp_f32 v157, v157
    v_exp_f32 v178, v178
    v_exp_f32 v158, v158
    v_exp_f32 v179, v179
    v_exp_f32 v159, v159
    v_exp_f32 v180, v180
    v_exp_f32 v160, v160
    v_exp_f32 v181, v181
    v_exp_f32 v161, v161
    v_exp_f32 v182, v182
    v_exp_f32 v162, v162
    v_exp_f32 v183, v183
    v_exp_f32 v163, v163
    v_exp_f32 v184, v184
    v_exp_f32 v164, v164
    v_exp_f32 v185, v185
    v_exp_f32 v165, v165
    v_exp_f32 v186, v186
    v_exp_f32 v166, v166
    v_exp_f32 v187, v187
    v_exp_f32 v167, v167
    v_exp_f32 v188, v188
    v_exp_f32 v168, v168
    v_exp_f32 v189, v189
    v_exp_f32 v169, v169
    v_exp_f32 v190, v190
    v_exp_f32 v170, v170
    v_exp_f32 v191, v191
    v_exp_f32 v171, v171
    v_exp_f32 v192, v192
    v_exp_f32 v172, v172
    v_exp_f32 v193, v193
    v_exp_f32 v173, v173
    v_exp_f32 v194, v194
    v_exp_f32 v174, v174
    v_exp_f32 v195, v195
    v_exp_f32 v175, v175
    v_add_f32 v198, v176, v177
    v_add_f32 v199, v156, v157
    v_add_f32 v198, v198, v178
    v_add_f32 v199, v199, v158
    v_add_f32 v198, v198, v179
    v_add_f32 v199, v199, v159
    v_add_f32 v198, v198, v180
    v_add_f32 v199, v199, v160
    v_add_f32 v198, v198, v181
    v_add_f32 v199, v199, v161
    v_add_f32 v198, v198, v182
    v_add_f32 v199, v199, v162
    v_add_f32 v198, v198, v183
    v_add_f32 v199, v199, v163
    v_add_f32 v198, v198, v184
    v_add_f32 v199, v199, v164
    v_add_f32 v198, v198, v185
    v_add_f32 v199, v199, v165
    v_add_f32 v198, v198, v186
    v_add_f32 v199, v199, v166
    v_add_f32 v198, v198, v187
    v_add_f32 v199, v199, v167
    v_add_f32 v198, v198, v188
    v_add_f32 v199, v199, v168
    v_add_f32 v198, v198, v189
    v_add_f32 v199, v199, v169
    v_add_f32 v198, v198, v190
    v_add_f32 v199, v199, v170
    v_add_f32 v198, v198, v191
    v_add_f32 v199, v199, v171
    v_add_f32 v198, v198, v192
    v_add_f32 v199, v199, v172
    v_add_f32 v198, v198, v193
    v_add_f32 v199, v199, v173
    v_add_f32 v198, v198, v194
    v_add_f32 v199, v199, v174
    v_add_f32 v198, v198, v195
    v_add_f32 v199, v199, v175
    v_rcp_f32 v198, v198
    v_rcp_f32 v199, v199
    v_mul_f32 v176, v176, v198
    v_mul_f32 v177, v177, v198
    v_mul_f32 v178, v178, v198
    v_mul_f32 v179, v179, v198
    v_mul_f32 v180, v180, v198
    v_mul_f32 v181, v181, v198
    v_mul_f32 v182, v182, v198
    v_mul_f32 v183, v183, v198
    v_mul_f32 v184, v184, v198
    v_mul_f32 v185, v185, v198
    v_mul_f32 v186, v186, v198
    v_mul_f32 v187, v187, v198
    v_mul_f32 v188, v188, v198
    v_mul_f32 v189, v189, v198
    v_mul_f32 v190, v190, v198
    v_mul_f32 v191, v191, v198
    v_mul_f32 v192, v192, v198
    v_mul_f32 v193, v193, v198
    v_mul_f32 v194, v194, v198
    v_mul_f32 v195, v195, v198
    v_cvt_pk_bf16_f32 v216, v176, v177
    v_cvt_pk_bf16_f32 v217, v178, v179
    v_cvt_pk_bf16_f32 v218, v180, v181
    v_cvt_pk_bf16_f32 v219, v182, v183
    v_cvt_pk_bf16_f32 v220, v184, v185
    v_cvt_pk_bf16_f32 v221, v186, v187
    v_cvt_pk_bf16_f32 v222, v188, v189
    v_cvt_pk_bf16_f32 v223, v190, v191
    v_cvt_pk_bf16_f32 v224, v192, v193
    v_cvt_pk_bf16_f32 v225, v194, v195
    v_mul_f32 v156, v156, v199
    v_mul_f32 v157, v157, v199
    v_mul_f32 v158, v158, v199
    v_mul_f32 v159, v159, v199
    v_mul_f32 v160, v160, v199
    v_mul_f32 v161, v161, v199
    v_mul_f32 v162, v162, v199
    v_mul_f32 v163, v163, v199
    v_mul_f32 v164, v164, v199
    v_mul_f32 v165, v165, v199
    v_mul_f32 v166, v166, v199
    v_mul_f32 v167, v167, v199
    v_mul_f32 v168, v168, v199
    v_mul_f32 v169, v169, v199
    v_mul_f32 v170, v170, v199
    v_mul_f32 v171, v171, v199
    v_mul_f32 v172, v172, v199
    v_mul_f32 v173, v173, v199
    v_mul_f32 v174, v174, v199
    v_mul_f32 v175, v175, v199
    v_cvt_pk_bf16_f32 v226, v156, v157
    v_cvt_pk_bf16_f32 v227, v158, v159
    v_cvt_pk_bf16_f32 v228, v160, v161
    v_cvt_pk_bf16_f32 v229, v162, v163
    v_cvt_pk_bf16_f32 v230, v164, v165
    v_cvt_pk_bf16_f32 v231, v166, v167
    v_cvt_pk_bf16_f32 v232, v168, v169
    v_cvt_pk_bf16_f32 v233, v170, v171
    v_cvt_pk_bf16_f32 v234, v172, v173
    v_cvt_pk_bf16_f32 v235, v174, v175
    v_mfma_f32_16x16x32_bf16 v[156:159], v[96:99], v[36:39], 0
    v_mfma_f32_16x16x32_bf16 v[156:159], v[100:103], v[40:43], v[156:159]
    v_mfma_f32_16x16x32_bf16 v[156:159], v[104:107], v[44:47], v[156:159]
    v_mfma_f32_16x16x32_bf16 v[160:163], v[108:111], v[36:39], 0
    v_mfma_f32_16x16x32_bf16 v[160:163], v[112:115], v[40:43], v[160:163]
    v_mfma_f32_16x16x32_bf16 v[160:163], v[116:119], v[44:47], v[160:163]
    v_mfma_f32_16x16x32_bf16 v[164:167], v[120:123], v[36:39], 0
    v_mfma_f32_16x16x32_bf16 v[164:167], v[124:127], v[40:43], v[164:167]
    v_mfma_f32_16x16x32_bf16 v[164:167], v[128:131], v[44:47], v[164:167]
    v_mfma_f32_16x16x32_bf16 v[168:171], v[132:135], v[36:39], 0
    v_mfma_f32_16x16x32_bf16 v[168:171], v[136:139], v[40:43], v[168:171]
    v_mfma_f32_16x16x32_bf16 v[168:171], v[140:143], v[44:47], v[168:171]
    v_mfma_f32_16x16x32_bf16 v[172:175], v[144:147], v[36:39], 0
    v_mfma_f32_16x16x32_bf16 v[172:175], v[148:151], v[40:43], v[172:175]
    v_mfma_f32_16x16x32_bf16 v[172:175], v[152:155], v[44:47], v[172:175]
    v_max3_f32 v196, v156, v157, v158
    v_min3_f32 v197, v156, v157, v158
    v_max3_f32 v196, v196, v159, v160
    v_min3_f32 v197, v197, v159, v160
    v_max3_f32 v196, v196, v161, v162
    v_min3_f32 v197, v197, v161, v162
    v_max3_f32 v196, v196, v163, v164
    v_min3_f32 v197, v197, v163, v164
    v_max3_f32 v196, v196, v165, v166
    v_min3_f32 v197, v197, v165, v166
    v_max3_f32 v196, v196, v167, v168
    v_min3_f32 v197, v197, v167, v168
    v_max3_f32 v196, v196, v169, v170
    v_min3_f32 v197, v197, v169, v170
    v_max3_f32 v196, v196, v171, v172
    v_min3_f32 v197, v197, v171, v172
    v_max3_f32 v196, v196, v173, v174
    v_min3_f32 v197, v197, v173, v174
    v_max_f32 v196, v196, v175
    v_min_f32 v197, v197, v175
    v_mul_f32 v196, 0xbfb8aa3b, v196
    v_mul_f32 v197, 0x3fb8aa3b, v197
    s_mov_b32 s44, 0x3fb8aa3b
    v_fma_f32 v176, v156, s44, v196
    v_fma_f32 v156, -v156, s44, v197
    v_fma_f32 v177, v157, s44, v196
    v_fma_f32 v157, -v157, s44, v197
    v_fma_f32 v178, v158, s44, v196
    v_fma_f32 v158, -v158, s44, v197
    v_fma_f32 v179, v159, s44, v196
    v_fma_f32 v159, -v159, s44, v197
    v_fma_f32 v180, v160, s44, v196
    v_fma_f32 v160, -v160, s44, v197
    v_fma_f32 v181, v161, s44, v196
    v_fma_f32 v161, -v161, s44, v197
    v_fma_f32 v182, v162, s44, v196
    v_fma_f32 v162, -v162, s44, v197
    v_fma_f32 v183, v163, s44, v196
    v_fma_f32 v163, -v163, s44, v197
    v_fma_f32 v184, v164, s44, v196
    v_fma_f32 v164, -v164, s44, v197
    v_fma_f32 v185, v165, s44, v196
    v_fma_f32 v165, -v165, s44, v197
    v_fma_f32 v186, v166, s44, v196
    v_fma_f32 v166, -v166, s44, v197
    v_fma_f32 v187, v167, s44, v196
    v_fma_f32 v167, -v167, s44, v197
    v_fma_f32 v188, v168, s44, v196
    v_fma_f32 v168, -v168, s44, v197
    v_fma_f32 v189, v169, s44, v196
    v_fma_f32 v169, -v169, s44, v197
    v_fma_f32 v190, v170, s44, v196
    v_fma_f32 v170, -v170, s44, v197
    v_fma_f32 v191, v171, s44, v196
    v_fma_f32 v171, -v171, s44, v197
    v_fma_f32 v192, v172, s44, v196
    v_fma_f32 v172, -v172, s44, v197
    v_fma_f32 v193, v173, s44, v196
    v_fma_f32 v173, -v173, s44, v197
    v_fma_f32 v194, v174, s44, v196
    v_fma_f32 v174, -v174, s44, v197
    v_fma_f32 v195, v175, s44, v196
    v_fma_f32 v175, -v175, s44, v197
    v_exp_f32 v176, v176
    v_exp_f32 v156, v156
    v_exp_f32 v177, v177
    v_exp_f32 v157, v157
    v_exp_f32 v178, v178
    v_exp_f32 v158, v158
    v_exp_f32 v179, v179
    v_exp_f32 v159, v159
    v_exp_f32 v180, v180
    v_exp_f32 v160, v160
    v_exp_f32 v181, v181
    v_exp_f32 v161, v161
    v_exp_f32 v182, v182
    v_exp_f32 v162, v162
    v_exp_f32 v183, v183
    v_exp_f32 v163, v163
    v_exp_f32 v184, v184
    v_exp_f32 v164, v164
    v_exp_f32 v185, v185
    v_exp_f32 v165, v165
    v_exp_f32 v186, v186
    v_exp_f32 v166, v166
    v_exp_f32 v187, v187
    v_exp_f32 v167, v167
    v_exp_f32 v188, v188
    v_exp_f32 v168, v168
    v_exp_f32 v189, v189
    v_exp_f32 v169, v169
    v_exp_f32 v190, v190
    v_exp_f32 v170, v170
    v_exp_f32 v191, v191
    v_exp_f32 v171, v171
    v_exp_f32 v192, v192
    v_exp_f32 v172, v172
    v_exp_f32 v193, v193
    v_exp_f32 v173, v173
    v_exp_f32 v194, v194
    v_exp_f32 v174, v174
    v_exp_f32 v195, v195
    v_exp_f32 v175, v175
    v_add_f32 v198, v176, v177
    v_add_f32 v199, v156, v157
    v_add_f32 v198, v198, v178
    v_add_f32 v199, v199, v158
    v_add_f32 v198, v198, v179
    v_add_f32 v199, v199, v159
    v_add_f32 v198, v198, v180
    v_add_f32 v199, v199, v160
    v_add_f32 v198, v198, v181
    v_add_f32 v199, v199, v161
    v_add_f32 v198, v198, v182
    v_add_f32 v199, v199, v162
    v_add_f32 v198, v198, v183
    v_add_f32 v199, v199, v163
    v_add_f32 v198, v198, v184
    v_add_f32 v199, v199, v164
    v_add_f32 v198, v198, v185
    v_add_f32 v199, v199, v165
    v_add_f32 v198, v198, v186
    v_add_f32 v199, v199, v166
    v_add_f32 v198, v198, v187
    v_add_f32 v199, v199, v167
    v_add_f32 v198, v198, v188
    v_add_f32 v199, v199, v168
    v_add_f32 v198, v198, v189
    v_add_f32 v199, v199, v169
    v_add_f32 v198, v198, v190
    v_add_f32 v199, v199, v170
    v_add_f32 v198, v198, v191
    v_add_f32 v199, v199, v171
    v_add_f32 v198, v198, v192
    v_add_f32 v199, v199, v172
    v_add_f32 v198, v198, v193
    v_add_f32 v199, v199, v173
    v_add_f32 v198, v198, v194
    v_add_f32 v199, v199, v174
    v_add_f32 v198, v198, v195
    v_add_f32 v199, v199, v175
    v_rcp_f32 v198, v198
    v_rcp_f32 v199, v199
    v_mul_f32 v176, v176, v198
    v_mul_f32 v177, v177, v198
    v_mul_f32 v178, v178, v198
    v_mul_f32 v179, v179, v198
    v_mul_f32 v180, v180, v198
    v_mul_f32 v181, v181, v198
    v_mul_f32 v182, v182, v198
    v_mul_f32 v183, v183, v198
    v_mul_f32 v184, v184, v198
    v_mul_f32 v185, v185, v198
    v_mul_f32 v186, v186, v198
    v_mul_f32 v187, v187, v198
    v_mul_f32 v188, v188, v198
    v_mul_f32 v189, v189, v198
    v_mul_f32 v190, v190, v198
    v_mul_f32 v191, v191, v198
    v_mul_f32 v192, v192, v198
    v_mul_f32 v193, v193, v198
    v_mul_f32 v194, v194, v198
    v_mul_f32 v195, v195, v198
    v_cvt_pk_bf16_f32 v236, v176, v177
    v_cvt_pk_bf16_f32 v237, v178, v179
    v_cvt_pk_bf16_f32 v238, v180, v181
    v_cvt_pk_bf16_f32 v239, v182, v183
    v_cvt_pk_bf16_f32 v240, v184, v185
    v_cvt_pk_bf16_f32 v241, v186, v187
    v_cvt_pk_bf16_f32 v242, v188, v189
    v_cvt_pk_bf16_f32 v243, v190, v191
    v_cvt_pk_bf16_f32 v244, v192, v193
    v_cvt_pk_bf16_f32 v245, v194, v195
    v_mul_f32 v156, v156, v199
    v_mul_f32 v157, v157, v199
    v_mul_f32 v158, v158, v199
    v_mul_f32 v159, v159, v199
    v_mul_f32 v160, v160, v199
    v_mul_f32 v161, v161, v199
    v_mul_f32 v162, v162, v199
    v_mul_f32 v163, v163, v199
    v_mul_f32 v164, v164, v199
    v_mul_f32 v165, v165, v199
    v_mul_f32 v166, v166, v199
    v_mul_f32 v167, v167, v199
    v_mul_f32 v168, v168, v199
    v_mul_f32 v169, v169, v199
    v_mul_f32 v170, v170, v199
    v_mul_f32 v171, v171, v199
    v_mul_f32 v172, v172, v199
    v_mul_f32 v173, v173, v199
    v_mul_f32 v174, v174, v199
    v_mul_f32 v175, v175, v199
    v_cvt_pk_bf16_f32 v246, v156, v157
    v_cvt_pk_bf16_f32 v247, v158, v159
    v_cvt_pk_bf16_f32 v248, v160, v161
    v_cvt_pk_bf16_f32 v249, v162, v163
    v_cvt_pk_bf16_f32 v250, v164, v165
    v_cvt_pk_bf16_f32 v251, v166, v167
    v_cvt_pk_bf16_f32 v252, v168, v169
    v_cvt_pk_bf16_f32 v253, v170, v171
    v_cvt_pk_bf16_f32 v254, v172, v173
    v_cvt_pk_bf16_f32 v255, v174, v175
    v_mul_u32_u24 v64, 80, v1
    v_mov_b32 v67, 11584
    v_mad_u32_u24 v64, v2, v67, v64
    v_add_u32 v64, 110592, v64
    s_mov_b32 s78, 0x00f0000f
    s_mov_b32 s79, 0xf0000f00
    v_mov_b32 v67, 112640
    v_cndmask_b32 v64, v67, v64, s[78:79]
    v_and_b32 v67, 15, v0
    v_lshlrev_b32 v67, 4, v67
    v_lshl_add_u32 v65, v2, 9, v67
    v_bfe_u32 v66, v0, 4, 1
    v_mul_u32_u24 v66, 20480, v66
    v_lshrrev_b32 v68, 5, v0
    v_lshl_add_u32 v66, v68, 8, v66
    v_add_u32 v66, v66, v67
    s_mul_i32 s59, s39, 163840
    s_add_u32 s59, s59, 0x640000
    s_mul_i32 s41, s31, 40960
    s_add_u32 s59, s59, s41
    s_lshl_b32 s41, s30, 9
    s_add_u32 s61, s59, s41
    s_add_u32 s61, s61, 16384
    s_lshl_b32 s41, s30, 11
    s_add_u32 s59, s59, s41
    s_add_u32 s60, s59, 20480
    s_mov_b32 s62, 0
    s_bfe_u32 s42, s31, 0x10001
    s_and_b32 s44, s31, 1
    s_bfe_u32 s40, s31, 0x10002
    s_xor_b32 s40, s40, 1
    s_lshl1_add_u32 s44, s44, s40
    s_mul_i32 s40, s42, 20480
    s_sub_u32 s41, 20480, s40
    v_lshl_add_u32 v6, v0, 4, s40
    v_lshl_add_u32 v7, v0, 4, s41
    s_mul_i32 s40, s39, 163840
    s_add_u32 s40, s40, 0x640000
    s_mul_i32 s41, s44, 40960
    s_add_u32 s40, s40, s41
    s_lshl_b32 s41, s42, 13
    s_add_u32 s43, s40, s41
    s_add_u32 s41, s30, 0
    s_and_b32 s41, s41, 3
    s_lshl_b32 s41, s41, 11
    s_add_u32 s48, s43, s41
    s_add_u32 s41, s30, 1
    s_and_b32 s41, s41, 3
    s_lshl_b32 s41, s41, 11
    s_add_u32 s49, s43, s41
    s_add_u32 s41, s30, 2
    s_and_b32 s41, s41, 3
    s_lshl_b32 s41, s41, 11
    s_add_u32 s50, s43, s41
    s_add_u32 s41, s30, 3
    s_and_b32 s41, s41, 3
    s_lshl_b32 s41, s41, 11
    s_add_u32 s51, s43, s41
    s_lshl_b32 s41, s42, 11
    s_add_u32 s43, s40, s41
    s_add_u32 s43, s43, 16384
    s_bfe_u32 s41, s30, 0x10001
    s_lshl_b32 s41, s41, 10
    s_add_u32 s52, s43, s41
    s_xor_b32 s41, s41, 1024
    s_add_u32 s53, s43, s41
    v_lshrrev_b32 v16, 2, v0
    v_mul_u32_u24 v16, 160, v16
    v_and_b32 v17, 3, v0
    v_mul_u32_u24 v17, 40, v17
    s_mul_i32 s40, s42, 21504
    v_add3_u32 v15, v16, v17, s40
    s_mul_i32 s40, s42, 12288
    s_add_u32 s40, s40, 43008
    v_add3_u32 v14, v16, v17, s40
    s_mul_i32 s41, s28, 43008
    s_add_u32 s40, s41, 67584
    v_add_u32 v8, s40, v15
    s_sub_u32 s41, 110592, s41
    s_mul_i32 s40, s31, 5120
    s_add_u32 s40, s40, s41
    v_lshl_add_u32 v9, v0, 4, s40
    s_xor_b32 s40, s31, 2
    s_mul_i32 s40, s40, 5120
    s_add_u32 s40, s40, s41
    v_lshl_add_u32 v10, v0, 4, s40
    v_and_b32 v16, 15, v0
    v_lshrrev_b32 v17, 4, v0
    v_mul_u32_u24 v16, 2560, v16
    v_mad_u32_u24 v11, v17, 40, v16
    s_lshl_b32 s40, s29, 3
    s_lshl_b32 s41, s44, 1
    s_add_u32 s40, s40, s41
    s_add_u32 s40, s40, s42
    s_mul_i32 s57, s40, 40960
    s_mul_i32 s41, s28, 1280
    s_add_u32 s57, s57, s41
    s_mul_i32 s41, s30, 160
    s_add_u32 s57, s57, s41
    s_lshl_b32 s41, s44, 2
    v_add_u32 v12, s41, v4
    s_lshl2_add_u32 s3, s35, s44
    s_lshl1_add_u32 s3, s3, s42
    s_lshl_b32 s3, s3, 7
    s_add_u32 s3, s3, 0xb80000
    buffer_load_dwordx2 v[74:75], v72, s[12:15], s56 offen sc1
    ds_read_b32 v5, v4 offset:188
    s_waitcnt lgkmcnt(0)
    v_cmp_ne_u32 vcc, 0x9e000, v5
    s_cbranch_vccnz L_cs_103
L_cb_104:
    ds_read_b128 v[196:199], v64 offset:1600
    ds_read_b128 v[200:203], v64 offset:1616
    ds_read_b128 v[204:207], v64 offset:1632
    ds_read_b128 v[208:211], v64 offset:1648
    ds_read_b128 v[212:215], v64 offset:1664
    ds_read_b128 v[96:99], v64 offset:0
    ds_read_b128 v[100:103], v64 offset:16
    ds_read_b128 v[104:107], v64 offset:32
    ds_read_b128 v[108:111], v64 offset:48
    ds_read_b128 v[112:115], v64 offset:64
    ds_read_b128 v[116:119], v64 offset:320
    ds_read_b128 v[120:123], v64 offset:336
    ds_read_b128 v[124:127], v64 offset:352
    ds_read_b128 v[128:131], v64 offset:368
    ds_read_b128 v[132:135], v64 offset:384
    ds_read_b128 v[136:139], v64 offset:640
    ds_read_b128 v[140:143], v64 offset:656
    ds_read_b128 v[144:147], v64 offset:672
    ds_read_b128 v[148:151], v64 offset:688
    ds_read_b128 v[152:155], v64 offset:704
    ds_read_b128 v[156:159], v64 offset:960
    ds_read_b128 v[160:163], v64 offset:976
    ds_read_b128 v[164:167], v64 offset:992
    ds_read_b128 v[168:171], v64 offset:1008
    ds_read_b128 v[172:175], v64 offset:1024
    ds_read_b128 v[176:179], v64 offset:1280
    ds_read_b128 v[180:183], v64 offset:1296
    ds_read_b128 v[184:187], v64 offset:1312
    ds_read_b128 v[188:191], v64 offset:1328
    ds_read_b128 v[192:195], v64 offset:1344
    s_waitcnt lgkmcnt(15)
    v_mfma_f32_16x16x32_bf16 v[36:39], v[196:199], v[216:219], 0
    v_mfma_f32_16x16x32_bf16 v[60:63], v[196:199], v[236:239], 0
    v_mfma_f32_16x16x32_bf16 v[36:39], v[200:203], v[220:223], v[36:39]
    v_mfma_f32_16x16x32_bf16 v[60:63], v[200:203], v[240:243], v[60:63]
    v_mfma_f32_16x16x32_bf16 v[36:39], v[204:207], v[224:227], v[36:39]
    v_mfma_f32_16x16x32_bf16 v[60:63], v[204:207], v[244:247], v[60:63]
    v_mfma_f32_16x16x32_bf16 v[36:39], v[208:211], v[228:231], v[36:39]
    v_mfma_f32_16x16x32_bf16 v[60:63], v[208:211], v[248:251], v[60:63]
    v_mfma_f32_16x16x32_bf16 v[36:39], v[212:215], v[232:235], v[36:39]
    v_mfma_f32_16x16x32_bf16 v[60:63], v[212:215], v[252:255], v[60:63]
    v_mfma_f32_16x16x32_bf16 v[16:19], v[96:99], v[216:219], 0
    v_mfma_f32_16x16x32_bf16 v[40:43], v[96:99], v[236:239], 0
    v_mfma_f32_16x16x32_bf16 v[16:19], v[100:103], v[220:223], v[16:19]
    v_mfma_f32_16x16x32_bf16 v[40:43], v[100:103], v[240:243], v[40:43]
    v_mfma_f32_16x16x32_bf16 v[16:19], v[104:107], v[224:227], v[16:19]
    v_mfma_f32_16x16x32_bf16 v[40:43], v[104:107], v[244:247], v[40:43]
    v_mfma_f32_16x16x32_bf16 v[16:19], v[108:111], v[228:231], v[16:19]
    v_mfma_f32_16x16x32_bf16 v[40:43], v[108:111], v[248:251], v[40:43]
    v_mfma_f32_16x16x32_bf16 v[16:19], v[112:115], v[232:235], v[16:19]
    v_mfma_f32_16x16x32_bf16 v[40:43], v[112:115], v[252:255], v[40:43]
    v_add_f32 v36, s38, v36
    v_rcp_f32 v36, v36
    v_add_f32 v60, s38, v60
    v_rcp_f32 v60, v60
    v_mfma_f32_16x16x32_bf16 v[20:23], v[116:119], v[216:219], 0
    v_mfma_f32_16x16x32_bf16 v[44:47], v[116:119], v[236:239], 0
    v_mfma_f32_16x16x32_bf16 v[20:23], v[120:123], v[220:223], v[20:23]
    v_mfma_f32_16x16x32_bf16 v[44:47], v[120:123], v[240:243], v[44:47]
    v_mfma_f32_16x16x32_bf16 v[20:23], v[124:127], v[224:227], v[20:23]
    v_mfma_f32_16x16x32_bf16 v[44:47], v[124:127], v[244:247], v[44:47]
    v_mfma_f32_16x16x32_bf16 v[20:23], v[128:131], v[228:231], v[20:23]
    v_mfma_f32_16x16x32_bf16 v[44:47], v[128:131], v[248:251], v[44:47]
    v_mfma_f32_16x16x32_bf16 v[20:23], v[132:135], v[232:235], v[20:23]
    v_mfma_f32_16x16x32_bf16 v[44:47], v[132:135], v[252:255], v[44:47]
    v_mul_f32 v16, v16, v36
    v_mul_f32 v17, v17, v36
    v_mul_f32 v18, v18, v36
    v_mul_f32 v19, v19, v36
    v_mul_f32 v40, v40, v60
    v_mul_f32 v41, v41, v60
    v_mul_f32 v42, v42, v60
    v_mul_f32 v43, v43, v60
    s_waitcnt lgkmcnt(14)
    v_mfma_f32_16x16x32_bf16 v[24:27], v[136:139], v[216:219], 0
    v_mfma_f32_16x16x32_bf16 v[48:51], v[136:139], v[236:239], 0
    s_waitcnt lgkmcnt(13)
    v_mfma_f32_16x16x32_bf16 v[24:27], v[140:143], v[220:223], v[24:27]
    v_mfma_f32_16x16x32_bf16 v[48:51], v[140:143], v[240:243], v[48:51]
    s_waitcnt lgkmcnt(12)
    v_mfma_f32_16x16x32_bf16 v[24:27], v[144:147], v[224:227], v[24:27]
    v_mfma_f32_16x16x32_bf16 v[48:51], v[144:147], v[244:247], v[48:51]
    s_waitcnt lgkmcnt(11)
    v_mfma_f32_16x16x32_bf16 v[24:27], v[148:151], v[228:231], v[24:27]
    v_mfma_f32_16x16x32_bf16 v[48:51], v[148:151], v[248:251], v[48:51]
    s_waitcnt lgkmcnt(10)
    v_mfma_f32_16x16x32_bf16 v[24:27], v[152:155], v[232:235], v[24:27]
    v_mfma_f32_16x16x32_bf16 v[48:51], v[152:155], v[252:255], v[48:51]
    v_mul_f32 v20, v20, v36
    v_mul_f32 v21, v21, v36
    v_mul_f32 v22, v22, v36
    v_mul_f32 v23, v23, v36
    v_mul_f32 v44, v44, v60
    v_mul_f32 v45, v45, v60
    v_mul_f32 v46, v46, v60
    v_mul_f32 v47, v47, v60
    v_cvt_pk_bf16_f32 v16, v16, v17
    v_cvt_pk_bf16_f32 v17, v18, v19
    v_cvt_pk_bf16_f32 v18, v20, v21
    v_cvt_pk_bf16_f32 v19, v22, v23
    v_min_u32 v16, 0xfffffffe, v16
    buffer_store_dwordx4 v[16:19], v65, s[12:15], s59 offen offset:0 sc1
    v_cvt_pk_bf16_f32 v40, v40, v41
    v_cvt_pk_bf16_f32 v41, v42, v43
    v_cvt_pk_bf16_f32 v42, v44, v45
    v_cvt_pk_bf16_f32 v43, v46, v47
    v_min_u32 v40, 0xfffffffe, v40
    buffer_store_dwordx4 v[40:43], v65, s[12:15], s60 offen offset:0 sc1
    s_waitcnt lgkmcnt(9)
    v_mfma_f32_16x16x32_bf16 v[28:31], v[156:159], v[216:219], 0
    v_mfma_f32_16x16x32_bf16 v[52:55], v[156:159], v[236:239], 0
    s_waitcnt lgkmcnt(8)
    v_mfma_f32_16x16x32_bf16 v[28:31], v[160:163], v[220:223], v[28:31]
    v_mfma_f32_16x16x32_bf16 v[52:55], v[160:163], v[240:243], v[52:55]
    s_waitcnt lgkmcnt(7)
    v_mfma_f32_16x16x32_bf16 v[28:31], v[164:167], v[224:227], v[28:31]
    v_mfma_f32_16x16x32_bf16 v[52:55], v[164:167], v[244:247], v[52:55]
    s_waitcnt lgkmcnt(6)
    v_mfma_f32_16x16x32_bf16 v[28:31], v[168:171], v[228:231], v[28:31]
    v_mfma_f32_16x16x32_bf16 v[52:55], v[168:171], v[248:251], v[52:55]
    s_waitcnt lgkmcnt(5)
    v_mfma_f32_16x16x32_bf16 v[28:31], v[172:175], v[232:235], v[28:31]
    v_mfma_f32_16x16x32_bf16 v[52:55], v[172:175], v[252:255], v[52:55]
    v_mul_f32 v24, v24, v36
    v_mul_f32 v25, v25, v36
    v_mul_f32 v26, v26, v36
    v_mul_f32 v27, v27, v36
    v_mul_f32 v48, v48, v60
    v_mul_f32 v49, v49, v60
    v_mul_f32 v50, v50, v60
    v_mul_f32 v51, v51, v60
    s_waitcnt lgkmcnt(4)
    v_mfma_f32_16x16x32_bf16 v[32:35], v[176:179], v[216:219], 0
    v_mfma_f32_16x16x32_bf16 v[56:59], v[176:179], v[236:239], 0
    s_waitcnt lgkmcnt(3)
    v_mfma_f32_16x16x32_bf16 v[32:35], v[180:183], v[220:223], v[32:35]
    v_mfma_f32_16x16x32_bf16 v[56:59], v[180:183], v[240:243], v[56:59]
    s_waitcnt lgkmcnt(2)
    v_mfma_f32_16x16x32_bf16 v[32:35], v[184:187], v[224:227], v[32:35]
    v_mfma_f32_16x16x32_bf16 v[56:59], v[184:187], v[244:247], v[56:59]
    s_waitcnt lgkmcnt(1)
    v_mfma_f32_16x16x32_bf16 v[32:35], v[188:191], v[228:231], v[32:35]
    v_mfma_f32_16x16x32_bf16 v[56:59], v[188:191], v[248:251], v[56:59]
    s_waitcnt lgkmcnt(0)
    v_mfma_f32_16x16x32_bf16 v[32:35], v[192:195], v[232:235], v[32:35]
    v_mfma_f32_16x16x32_bf16 v[56:59], v[192:195], v[252:255], v[56:59]
    v_mul_f32 v28, v28, v36
    v_mul_f32 v29, v29, v36
    v_mul_f32 v30, v30, v36
    v_mul_f32 v31, v31, v36
    v_mul_f32 v52, v52, v60
    v_mul_f32 v53, v53, v60
    v_mul_f32 v54, v54, v60
    v_mul_f32 v55, v55, v60
    v_cvt_pk_bf16_f32 v24, v24, v25
    v_cvt_pk_bf16_f32 v25, v26, v27
    v_cvt_pk_bf16_f32 v26, v28, v29
    v_cvt_pk_bf16_f32 v27, v30, v31
    v_min_u32 v24, 0xfffffffe, v24
    buffer_store_dwordx4 v[24:27], v65, s[12:15], s59 offen offset:256 sc1
    v_cvt_pk_bf16_f32 v48, v48, v49
    v_cvt_pk_bf16_f32 v49, v50, v51
    v_cvt_pk_bf16_f32 v50, v52, v53
    v_cvt_pk_bf16_f32 v51, v54, v55
    v_min_u32 v48, 0xfffffffe, v48
    buffer_store_dwordx4 v[48:51], v65, s[12:15], s60 offen offset:256 sc1
    v_mul_f32 v32, v32, v36
    v_mul_f32 v33, v33, v36
    v_mul_f32 v34, v34, v36
    v_mul_f32 v35, v35, v36
    v_mul_f32 v56, v56, v60
    v_mul_f32 v57, v57, v60
    v_mul_f32 v58, v58, v60
    v_mul_f32 v59, v59, v60
    v_cvt_pk_bf16_f32 v68, v32, v33
    v_cvt_pk_bf16_f32 v69, v34, v35
    v_cvt_pk_bf16_f32 v70, v56, v57
    v_cvt_pk_bf16_f32 v71, v58, v59
    s_nop 0
    v_permlane16_swap_b32 v68, v70
    v_permlane16_swap_b32 v69, v71
    v_min_u32 v68, 0xfffffffe, v68
    v_min_u32 v70, 0xfffffffe, v70
    buffer_store_dwordx4 v[68:71], v66, s[12:15], s61 offen sc1
    s_mov_b64 exec, 1
    ds_add_u32 v4, v4 offset:304
    s_mov_b64 exec, -1
    s_waitcnt vmcnt(5)
    v_cmp_ne_u64 vcc, s[32:33], v[74:75]
    s_cbranch_vccz L_cf_105
    s_mov_b32 s41, 32768
L_poll_106:
    buffer_load_dwordx2 v[74:75], v72, s[12:15], s56 offen sc1
    s_waitcnt vmcnt(0)
    v_cmp_ne_u64 vcc, s[32:33], v[74:75]
    s_nop 4
    s_cbranch_vccz L_pdone_107
    s_sub_u32 s41, s41, 1
    s_cmp_lg_u32 s41, 0
    s_cbranch_scc1 L_poll_106
L_pdone_107:
L_cf_105:
    s_branch L_p3a
L_cs_103:
    s_mov_b32 s47, 1048576
L_cs_103l:
    ds_read_b32 v5, v4 offset:188
    s_waitcnt lgkmcnt(0)
    v_cmp_ne_u32 vcc, 0x9e000, v5
    s_cbranch_vccz L_cb_104
    s_sub_u32 s47, s47, 1
    s_cmp_lg_u32 s47, 0
    s_cbranch_scc1 L_cs_103l
    s_branch L_cb_104
L_p3h:
    v_and_b32 v72, 3, v0
    v_bfe_u32 v74, v0, 2, 2
    v_lshlrev_b32 v72, 7, v72
    v_lshl_add_u32 v72, v74, 3, v72
    s_lshl_b32 s56, s39, 10
    s_bfe_u32 s41, s31, 0x10001
    s_lshl_b32 s41, s41, 9
    s_add_u32 s56, s56, s41
    s_add_u32 s56, s56, 0xb40000
    s_mov_b64 exec, 1
    ds_add_u32 v4, v4 offset:404
    s_mov_b64 exec, -1
    s_and_b32 s41, s37, 2
    s_add_u32 s41, s41, s37
    s_lshl1_add_u32 s40, s41, 4
    s_lshl_b32 s41, s30, 1
    s_add_u32 s41, s41, s40
    s_and_b32 s41, s41, 7
    s_and_b32 s42, s40, 8
    s_add_u32 s42, s42, s41
    s_mul_i32 s42, s42, 51200
    s_mul_i32 s40, s37, 10752
    s_add_u32 m0, s40, 0
    s_nop 0
    buffer_load_dwordx4 v6, s[16:19], s42 offen lds
    s_add_u32 m0, s40, 1024
    s_nop 0
    buffer_load_dwordx4 v7, s[16:19], s42 offen lds
    s_add_u32 m0, s40, 2048
    s_nop 0
    buffer_load_dwordx4 v8, s[16:19], s42 offen lds
    s_add_u32 m0, s40, 3072
    s_nop 0
    buffer_load_dwordx4 v9, s[16:19], s42 offen lds
    s_add_u32 m0, s40, 4096
    s_nop 0
    buffer_load_dwordx4 v10, s[16:19], s42 offen lds
    s_and_b32 s41, s37, 2
    s_add_u32 s41, s41, s37
    s_lshl1_add_u32 s40, s41, 5
    s_lshl_b32 s41, s30, 1
    s_add_u32 s41, s41, s40
    s_and_b32 s41, s41, 7
    s_and_b32 s42, s40, 8
    s_add_u32 s42, s42, s41
    s_mul_i32 s42, s42, 51200
    s_mul_i32 s40, s37, 10752
    s_add_u32 m0, s40, 5120
    s_nop 0
    buffer_load_dwordx4 v6, s[16:19], s42 offen lds
    s_add_u32 m0, s40, 6144
    s_nop 0
    buffer_load_dwordx4 v7, s[16:19], s42 offen lds
    s_add_u32 m0, s40, 7168
    s_nop 0
    buffer_load_dwordx4 v8, s[16:19], s42 offen lds
    s_add_u32 m0, s40, 8192
    s_nop 0
    buffer_load_dwordx4 v9, s[16:19], s42 offen lds
    s_add_u32 m0, s40, 9216
    s_nop 0
    buffer_load_dwordx4 v10, s[16:19], s42 offen lds
    buffer_load_dwordx2 v[74:75], v72, s[12:15], s56 offen sc1
    s_mov_b32 s62, 0
    s_bfe_u32 s42, s31, 0x10001
    s_and_b32 s44, s31, 1
    s_bfe_u32 s40, s31, 0x10002
    s_xor_b32 s40, s40, 1
    s_lshl1_add_u32 s44, s44, s40
    s_mul_i32 s40, s42, 20480
    s_sub_u32 s41, 20480, s40
    v_lshl_add_u32 v6, v0, 4, s40
    v_lshl_add_u32 v7, v0, 4, s41
    s_mul_i32 s40, s39, 163840
    s_add_u32 s40, s40, 0x640000
    s_mul_i32 s41, s44, 40960
    s_add_u32 s40, s40, s41
    s_lshl_b32 s41, s42, 13
    s_add_u32 s43, s40, s41
    s_add_u32 s41, s30, 0
    s_and_b32 s41, s41, 3
    s_lshl_b32 s41, s41, 11
    s_add_u32 s48, s43, s41
    s_add_u32 s41, s30, 1
    s_and_b32 s41, s41, 3
    s_lshl_b32 s41, s41, 11
    s_add_u32 s49, s43, s41
    s_add_u32 s41, s30, 2
    s_and_b32 s41, s41, 3
    s_lshl_b32 s41, s41, 11
    s_add_u32 s50, s43, s41
    s_add_u32 s41, s30, 3
    s_and_b32 s41, s41, 3
    s_lshl_b32 s41, s41, 11
    s_add_u32 s51, s43, s41
    s_lshl_b32 s41, s42, 11
    s_add_u32 s43, s40, s41
    s_add_u32 s43, s43, 16384
    s_bfe_u32 s41, s30, 0x10001
    s_lshl_b32 s41, s41, 10
    s_add_u32 s52, s43, s41
    s_xor_b32 s41, s41, 1024
    s_add_u32 s53, s43, s41
    v_lshrrev_b32 v16, 2, v0
    v_mul_u32_u24 v16, 160, v16
    v_and_b32 v17, 3, v0
    v_mul_u32_u24 v17, 40, v17
    s_mul_i32 s40, s42, 21504
    v_add3_u32 v15, v16, v17, s40
    s_mul_i32 s40, s42, 12288
    s_add_u32 s40, s40, 43008
    v_add3_u32 v14, v16, v17, s40
    s_mul_i32 s41, s28, 43008
    s_add_u32 s40, s41, 67584
    v_add_u32 v8, s40, v15
    s_sub_u32 s41, 110592, s41
    s_mul_i32 s40, s31, 5120
    s_add_u32 s40, s40, s41
    v_lshl_add_u32 v9, v0, 4, s40
    s_xor_b32 s40, s31, 2
    s_mul_i32 s40, s40, 5120
    s_add_u32 s40, s40, s41
    v_lshl_add_u32 v10, v0, 4, s40
    v_and_b32 v16, 15, v0
    v_lshrrev_b32 v17, 4, v0
    v_mul_u32_u24 v16, 2560, v16
    v_mad_u32_u24 v11, v17, 40, v16
    s_lshl_b32 s40, s29, 3
    s_lshl_b32 s41, s44, 1
    s_add_u32 s40, s40, s41
    s_add_u32 s40, s40, s42
    s_mul_i32 s57, s40, 40960
    s_mul_i32 s41, s28, 1280
    s_add_u32 s57, s57, s41
    s_mul_i32 s41, s30, 160
    s_add_u32 s57, s57, s41
    s_lshl_b32 s41, s44, 2
    v_add_u32 v12, s41, v4
    s_lshl2_add_u32 s3, s35, s44
    s_lshl1_add_u32 s3, s3, s42
    s_lshl_b32 s3, s3, 7
    s_add_u32 s3, s3, 0xb80000
    s_waitcnt vmcnt(0)
    v_cmp_ne_u64 vcc, s[32:33], v[74:75]
    s_cbranch_vccz L_cf_108
    s_mov_b32 s41, 32768
L_poll_109:
    buffer_load_dwordx2 v[74:75], v72, s[12:15], s56 offen sc1
    s_waitcnt vmcnt(0)
    v_cmp_ne_u64 vcc, s[32:33], v[74:75]
    s_nop 4
    s_cbranch_vccz L_pdone_110
    s_sub_u32 s41, s41, 1
    s_cmp_lg_u32 s41, 0
    s_cbranch_scc1 L_poll_109
L_pdone_110:
L_cf_108:
    s_mov_b64 exec, 1
    ds_add_u32 v4, v4 offset:304
    s_mov_b64 exec, -1
L_p3a:
    ds_read_b32 v5, v4 offset:304
    s_waitcnt lgkmcnt(0)
    v_cmp_ne_u32 vcc, 0x13c000, v5
    s_cbranch_vccnz L_cs_111
L_cb_112:
    s_sleep 12
L_p3w:
    buffer_load_dwordx4 v[16:19], v6, s[12:15], s48 offen offset:0 sc1
    buffer_load_dwordx4 v[20:23], v7, s[12:15], s48 offen offset:0 sc1
    buffer_load_dwordx4 v[24:27], v6, s[12:15], s48 offen offset:1024 sc1
    buffer_load_dwordx4 v[28:31], v7, s[12:15], s48 offen offset:1024 sc1
    buffer_load_dwordx4 v[32:35], v6, s[12:15], s49 offen offset:0 sc1
    buffer_load_dwordx4 v[36:39], v7, s[12:15], s49 offen offset:0 sc1
    buffer_load_dwordx4 v[40:43], v6, s[12:15], s49 offen offset:1024 sc1
    buffer_load_dwordx4 v[44:47], v7, s[12:15], s49 offen offset:1024 sc1
    buffer_load_dwordx4 v[80:83], v6, s[12:15], s52 offen offset:0 sc1
    buffer_load_dwordx4 v[84:87], v7, s[12:15], s52 offen offset:0 sc1
    buffer_load_dwordx4 v[88:91], v6, s[12:15], s53 offen offset:0 sc1
    buffer_load_dwordx4 v[92:95], v7, s[12:15], s53 offen offset:0 sc1
    buffer_load_dwordx4 v[48:51], v6, s[12:15], s50 offen offset:0 sc1
    buffer_load_dwordx4 v[52:55], v7, s[12:15], s50 offen offset:0 sc1
    buffer_load_dwordx4 v[56:59], v6, s[12:15], s50 offen offset:1024 sc1
    buffer_load_dwordx4 v[60:63], v7, s[12:15], s50 offen offset:1024 sc1
    buffer_load_dwordx4 v[64:67], v6, s[12:15], s51 offen offset:0 sc1
    buffer_load_dwordx4 v[68:71], v7, s[12:15], s51 offen offset:0 sc1
    buffer_load_dwordx4 v[72:75], v6, s[12:15], s51 offen offset:1024 sc1
    buffer_load_dwordx4 v[76:79], v7, s[12:15], s51 offen offset:1024 sc1
    s_cmp_lg_u32 s62, 0
    s_cbranch_scc1 L_stg
L_stgd:
    ds_read_b32 v5, v4 offset:404
    s_waitcnt lgkmcnt(0)
    v_cmp_ne_u32 vcc, 0x9e000, v5
    s_cbranch_vccnz L_cs_113
L_cb_114:
    s_mov_b32 s77, 4096
    ds_read_b64_tr_b16 v[136:137], v8 offset:0
    ds_read_b64_tr_b16 v[138:139], v8 offset:2560
    ds_read_b64_tr_b16 v[140:141], v8 offset:8
    ds_read_b64_tr_b16 v[142:143], v8 offset:2568
    ds_read_b64_tr_b16 v[144:145], v8 offset:16
    ds_read_b64_tr_b16 v[146:147], v8 offset:2576
    ds_read_b64_tr_b16 v[148:149], v8 offset:24
    ds_read_b64_tr_b16 v[150:151], v8 offset:2584
    ds_read_b64_tr_b16 v[152:153], v8 offset:32
    ds_read_b64_tr_b16 v[154:155], v8 offset:2592
    ds_read_b64_tr_b16 v[156:157], v8 offset:5120
    ds_read_b64_tr_b16 v[158:159], v8 offset:7680
    ds_read_b64_tr_b16 v[160:161], v8 offset:5128
    ds_read_b64_tr_b16 v[162:163], v8 offset:7688
    ds_read_b64_tr_b16 v[164:165], v8 offset:5136
    ds_read_b64_tr_b16 v[166:167], v8 offset:7696
    ds_read_b64_tr_b16 v[168:169], v8 offset:5144
    ds_read_b64_tr_b16 v[170:171], v8 offset:7704
    ds_read_b64_tr_b16 v[172:173], v8 offset:5152
    ds_read_b64_tr_b16 v[174:175], v8 offset:7712
    ds_read_b64_tr_b16 v[176:177], v8 offset:10752
    ds_read_b64_tr_b16 v[178:179], v8 offset:13312
    ds_read_b64_tr_b16 v[180:181], v8 offset:10760
    ds_read_b64_tr_b16 v[182:183], v8 offset:13320
    ds_read_b64_tr_b16 v[184:185], v8 offset:10768
    ds_read_b64_tr_b16 v[186:187], v8 offset:13328
    ds_read_b64_tr_b16 v[188:189], v8 offset:10776
    ds_read_b64_tr_b16 v[190:191], v8 offset:13336
    ds_read_b64_tr_b16 v[192:193], v8 offset:10784
    ds_read_b64_tr_b16 v[194:195], v8 offset:13344
    ds_read_b64_tr_b16 v[236:237], v8 offset:15872
    ds_read_b64_tr_b16 v[238:239], v8 offset:18432
    ds_read_b64_tr_b16 v[240:241], v8 offset:15880
    ds_read_b64_tr_b16 v[242:243], v8 offset:18440
    ds_read_b64_tr_b16 v[244:245], v8 offset:15888
    ds_read_b64_tr_b16 v[246:247], v8 offset:18448
    ds_read_b64_tr_b16 v[248:249], v8 offset:15896
    ds_read_b64_tr_b16 v[250:251], v8 offset:18456
    s_waitcnt vmcnt(16)
L_oc0:
    v_max3_u32 v13, v16, v20, v24
    v_max_u32 v13, v13, v28
    v_cmp_eq_u32 vcc, -1, v13
    s_mov_b32 s58, 0
    s_cbranch_vccnz L_oretry
L_og0:
    s_waitcnt lgkmcnt(15)
    v_mfma_f32_16x16x32_bf16 v[96:99], v[136:139], v[16:19], 0
    ds_read_b64_tr_b16 v[252:253], v8 offset:15904
    v_mfma_f32_16x16x32_bf16 v[116:119], v[136:139], v[20:23], 0
    ds_read_b64_tr_b16 v[254:255], v8 offset:18464
    v_mfma_f32_16x16x32_bf16 v[100:103], v[140:143], v[16:19], 0
    ds_read_b64_tr_b16 v[136:137], v14 offset:0
    v_mfma_f32_16x16x32_bf16 v[120:123], v[140:143], v[20:23], 0
    ds_read_b64_tr_b16 v[138:139], v14 offset:2560
    v_mfma_f32_16x16x32_bf16 v[104:107], v[144:147], v[16:19], 0
    ds_read_b64_tr_b16 v[140:141], v14 offset:8
    v_mfma_f32_16x16x32_bf16 v[124:127], v[144:147], v[20:23], 0
    ds_read_b64_tr_b16 v[142:143], v14 offset:2568
    v_mfma_f32_16x16x32_bf16 v[108:111], v[148:151], v[16:19], 0
    ds_read_b64_tr_b16 v[144:145], v14 offset:16
    v_mfma_f32_16x16x32_bf16 v[128:131], v[148:151], v[20:23], 0
    ds_read_b64_tr_b16 v[146:147], v14 offset:2576
    v_mfma_f32_16x16x32_bf16 v[112:115], v[152:155], v[16:19], 0
    ds_read_b64_tr_b16 v[148:149], v14 offset:24
    v_mfma_f32_16x16x32_bf16 v[132:135], v[152:155], v[20:23], 0
    ds_read_b64_tr_b16 v[150:151], v14 offset:2584
    v_mfma_f32_16x16x32_bf16 v[96:99], v[156:159], v[24:27], v[96:99]
    ds_read_b64_tr_b16 v[152:153], v14 offset:32
    v_mfma_f32_16x16x32_bf16 v[116:119], v[156:159], v[28:31], v[116:119]
    ds_read_b64_tr_b16 v[154:155], v14 offset:2592
    ds_read_b32 v5, v4 offset:304
    v_mfma_f32_16x16x32_bf16 v[100:103], v[160:163], v[24:27], v[100:103]
    ds_read_b64_tr_b16 v[156:157], v14 offset:6144
    v_mfma_f32_16x16x32_bf16 v[120:123], v[160:163], v[28:31], v[120:123]
    ds_read_b64_tr_b16 v[158:159], v14 offset:8704
    v_mfma_f32_16x16x32_bf16 v[104:107], v[164:167], v[24:27], v[104:107]
    ds_read_b64_tr_b16 v[160:161], v14 offset:6152
    v_mfma_f32_16x16x32_bf16 v[124:127], v[164:167], v[28:31], v[124:127]
    ds_read_b64_tr_b16 v[162:163], v14 offset:8712
    v_mfma_f32_16x16x32_bf16 v[108:111], v[168:171], v[24:27], v[108:111]
    ds_read_b64_tr_b16 v[164:165], v14 offset:6160
    s_waitcnt vmcnt(12)
    v_max3_u32 v13, v32, v36, v40
    v_mfma_f32_16x16x32_bf16 v[128:131], v[168:171], v[28:31], v[128:131]
    ds_read_b64_tr_b16 v[166:167], v14 offset:8720
    v_max_u32 v13, v13, v44
    v_mfma_f32_16x16x32_bf16 v[112:115], v[172:175], v[24:27], v[112:115]
    ds_read_b64_tr_b16 v[168:169], v14 offset:6168
    v_cmp_eq_u32 vcc, -1, v13
    v_mfma_f32_16x16x32_bf16 v[132:135], v[172:175], v[28:31], v[132:135]
    ds_read_b64_tr_b16 v[170:171], v14 offset:8728
    s_mov_b32 s58, 1
    s_cbranch_vccnz L_oretry
L_og1:
    v_mfma_f32_16x16x32_bf16 v[96:99], v[176:179], v[32:35], v[96:99]
    ds_read_b64_tr_b16 v[172:173], v14 offset:6176
    v_mfma_f32_16x16x32_bf16 v[116:119], v[176:179], v[36:39], v[116:119]
    ds_read_b64_tr_b16 v[174:175], v14 offset:8736
    s_waitcnt lgkmcnt(10)
    v_cmp_ne_u32 vcc, 0x13c000, v5
    s_cbranch_vccnz L_cs_115
L_cb_116:
    v_mfma_f32_16x16x32_bf16 v[100:103], v[180:183], v[32:35], v[100:103]
    ds_read_b64_tr_b16 v[176:177], v15 offset:0
    v_mfma_f32_16x16x32_bf16 v[120:123], v[180:183], v[36:39], v[120:123]
    ds_read_b64_tr_b16 v[178:179], v15 offset:2560
    v_mfma_f32_16x16x32_bf16 v[104:107], v[184:187], v[32:35], v[104:107]
    ds_read_b64_tr_b16 v[180:181], v15 offset:8
    v_mfma_f32_16x16x32_bf16 v[124:127], v[184:187], v[36:39], v[124:127]
    ds_read_b64_tr_b16 v[182:183], v15 offset:2568
    v_mfma_f32_16x16x32_bf16 v[108:111], v[188:191], v[32:35], v[108:111]
    ds_read_b64_tr_b16 v[184:185], v15 offset:16
    v_mfma_f32_16x16x32_bf16 v[128:131], v[188:191], v[36:39], v[128:131]
    ds_read_b64_tr_b16 v[186:187], v15 offset:2576
    v_mfma_f32_16x16x32_bf16 v[112:115], v[192:195], v[32:35], v[112:115]
    ds_read_b64_tr_b16 v[188:189], v15 offset:24
    v_mfma_f32_16x16x32_bf16 v[132:135], v[192:195], v[36:39], v[132:135]
    ds_read_b64_tr_b16 v[190:191], v15 offset:2584
    v_mfma_f32_16x16x32_bf16 v[96:99], v[236:239], v[40:43], v[96:99]
    ds_read_b64_tr_b16 v[192:193], v15 offset:32
    v_mfma_f32_16x16x32_bf16 v[116:119], v[236:239], v[44:47], v[116:119]
    ds_read_b64_tr_b16 v[194:195], v15 offset:2592
    v_mfma_f32_16x16x32_bf16 v[100:103], v[240:243], v[40:43], v[100:103]
    ds_read_b64_tr_b16 v[236:237], v15 offset:5120
    v_mfma_f32_16x16x32_bf16 v[120:123], v[240:243], v[44:47], v[120:123]
    ds_read_b64_tr_b16 v[238:239], v15 offset:7680
    v_mfma_f32_16x16x32_bf16 v[104:107], v[244:247], v[40:43], v[104:107]
    ds_read_b64_tr_b16 v[240:241], v15 offset:5128
    v_mfma_f32_16x16x32_bf16 v[124:127], v[244:247], v[44:47], v[124:127]
    ds_read_b64_tr_b16 v[242:243], v15 offset:7688
    v_mfma_f32_16x16x32_bf16 v[108:111], v[248:251], v[40:43], v[108:111]
    ds_read_b64_tr_b16 v[244:245], v15 offset:5136
    s_waitcnt vmcnt(10)
    v_max3_u32 v13, v80, v82, v84
    v_mfma_f32_16x16x32_bf16 v[128:131], v[248:251], v[44:47], v[128:131]
    ds_read_b64_tr_b16 v[246:247], v15 offset:7696
    v_max_u32 v13, v13, v86
    v_mfma_f32_16x16x32_bf16 v[112:115], v[252:255], v[40:43], v[112:115]
    ds_read_b64_tr_b16 v[248:249], v15 offset:5144
    v_cmp_eq_u32 vcc, -1, v13
    v_mfma_f32_16x16x32_bf16 v[132:135], v[252:255], v[44:47], v[132:135]
    ds_read_b64_tr_b16 v[250:251], v15 offset:7704
    s_mov_b32 s58, 2
    s_cbranch_vccnz L_oretry
L_og2:
    v_mfma_f32_16x16x32_bf16 v[96:99], v[136:139], v[80:83], v[96:99]
    ds_read_b64_tr_b16 v[252:253], v15 offset:5152
    v_mfma_f32_16x16x32_bf16 v[116:119], v[136:139], v[84:87], v[116:119]
    ds_read_b64_tr_b16 v[254:255], v15 offset:7712
    v_mfma_f32_16x16x32_bf16 v[100:103], v[140:143], v[80:83], v[100:103]
    ds_read_b64_tr_b16 v[136:137], v15 offset:10752
    v_mfma_f32_16x16x32_bf16 v[120:123], v[140:143], v[84:87], v[120:123]
    ds_read_b64_tr_b16 v[138:139], v15 offset:13312
    v_mfma_f32_16x16x32_bf16 v[104:107], v[144:147], v[80:83], v[104:107]
    ds_read_b64_tr_b16 v[140:141], v15 offset:10760
    v_mfma_f32_16x16x32_bf16 v[124:127], v[144:147], v[84:87], v[124:127]
    ds_read_b64_tr_b16 v[142:143], v15 offset:13320
    v_mfma_f32_16x16x32_bf16 v[108:111], v[148:151], v[80:83], v[108:111]
    ds_read_b64_tr_b16 v[144:145], v15 offset:10768
    s_waitcnt vmcnt(8)
    v_max3_u32 v13, v88, v90, v92
    v_mfma_f32_16x16x32_bf16 v[128:131], v[148:151], v[84:87], v[128:131]
    ds_read_b64_tr_b16 v[146:147], v15 offset:13328
    v_max_u32 v13, v13, v94
    v_mfma_f32_16x16x32_bf16 v[112:115], v[152:155], v[80:83], v[112:115]
    ds_read_b64_tr_b16 v[148:149], v15 offset:10776
    v_cmp_eq_u32 vcc, -1, v13
    v_mfma_f32_16x16x32_bf16 v[132:135], v[152:155], v[84:87], v[132:135]
    ds_read_b64_tr_b16 v[150:151], v15 offset:13336
    s_mov_b32 s58, 3
    s_cbranch_vccnz L_oretry
L_og3:
    s_waitcnt lgkmcnt(15)
    v_mfma_f32_16x16x32_bf16 v[96:99], v[156:159], v[88:91], v[96:99]
    ds_read_b64_tr_b16 v[152:153], v15 offset:10784
    v_mfma_f32_16x16x32_bf16 v[116:119], v[156:159], v[92:95], v[116:119]
    ds_read_b64_tr_b16 v[154:155], v15 offset:13344
    v_mfma_f32_16x16x32_bf16 v[100:103], v[160:163], v[88:91], v[100:103]
    ds_read_b64_tr_b16 v[156:157], v15 offset:15872
    v_mfma_f32_16x16x32_bf16 v[120:123], v[160:163], v[92:95], v[120:123]
    ds_read_b64_tr_b16 v[158:159], v15 offset:18432
    v_mfma_f32_16x16x32_bf16 v[104:107], v[164:167], v[88:91], v[104:107]
    ds_read_b64_tr_b16 v[160:161], v15 offset:15880
    v_mfma_f32_16x16x32_bf16 v[124:127], v[164:167], v[92:95], v[124:127]
    ds_read_b64_tr_b16 v[162:163], v15 offset:18440
    v_mfma_f32_16x16x32_bf16 v[108:111], v[168:171], v[88:91], v[108:111]
    ds_read_b64_tr_b16 v[164:165], v15 offset:15888
    s_waitcnt vmcnt(4)
    v_max3_u32 v13, v48, v52, v56
    v_mfma_f32_16x16x32_bf16 v[128:131], v[168:171], v[92:95], v[128:131]
    ds_read_b64_tr_b16 v[166:167], v15 offset:18448
    v_max_u32 v13, v13, v60
    v_mfma_f32_16x16x32_bf16 v[112:115], v[172:175], v[88:91], v[112:115]
    ds_read_b64_tr_b16 v[168:169], v15 offset:15896
    v_cmp_eq_u32 vcc, -1, v13
    v_mfma_f32_16x16x32_bf16 v[132:135], v[172:175], v[92:95], v[132:135]
    ds_read_b64_tr_b16 v[170:171], v15 offset:18456
    s_mov_b32 s58, 4
    s_cbranch_vccnz L_oretry
L_og4:
    v_mfma_f32_16x16x32_bf16 v[96:99], v[176:179], v[48:51], v[96:99]
    ds_read_b64_tr_b16 v[172:173], v15 offset:15904
    v_mfma_f32_16x16x32_bf16 v[116:119], v[176:179], v[52:55], v[116:119]
    ds_read_b64_tr_b16 v[174:175], v15 offset:18464
    v_mfma_f32_16x16x32_bf16 v[100:103], v[180:183], v[48:51], v[100:103]
    v_mfma_f32_16x16x32_bf16 v[120:123], v[180:183], v[52:55], v[120:123]
    v_mfma_f32_16x16x32_bf16 v[104:107], v[184:187], v[48:51], v[104:107]
    v_mfma_f32_16x16x32_bf16 v[124:127], v[184:187], v[52:55], v[124:127]
    v_mfma_f32_16x16x32_bf16 v[108:111], v[188:191], v[48:51], v[108:111]
    v_mfma_f32_16x16x32_bf16 v[128:131], v[188:191], v[52:55], v[128:131]
    v_mfma_f32_16x16x32_bf16 v[112:115], v[192:195], v[48:51], v[112:115]
    v_mfma_f32_16x16x32_bf16 v[132:135], v[192:195], v[52:55], v[132:135]
    v_mfma_f32_16x16x32_bf16 v[96:99], v[236:239], v[56:59], v[96:99]
    v_mfma_f32_16x16x32_bf16 v[116:119], v[236:239], v[60:63], v[116:119]
    s_waitcnt lgkmcnt(15)
    v_mfma_f32_16x16x32_bf16 v[100:103], v[240:243], v[56:59], v[100:103]
    v_mfma_f32_16x16x32_bf16 v[120:123], v[240:243], v[60:63], v[120:123]
    v_mfma_f32_16x16x32_bf16 v[104:107], v[244:247], v[56:59], v[104:107]
    v_mfma_f32_16x16x32_bf16 v[124:127], v[244:247], v[60:63], v[124:127]
    v_mfma_f32_16x16x32_bf16 v[108:111], v[248:251], v[56:59], v[108:111]
    s_waitcnt vmcnt(0)
    v_max3_u32 v13, v64, v68, v72
    v_mfma_f32_16x16x32_bf16 v[128:131], v[248:251], v[60:63], v[128:131]
    v_max_u32 v13, v13, v76
    v_mfma_f32_16x16x32_bf16 v[112:115], v[252:255], v[56:59], v[112:115]
    v_cmp_eq_u32 vcc, -1, v13
    v_mfma_f32_16x16x32_bf16 v[132:135], v[252:255], v[60:63], v[132:135]
    s_mov_b32 s58, 5
    s_cbranch_vccnz L_oretry
L_og5:
    v_mfma_f32_16x16x32_bf16 v[96:99], v[136:139], v[64:67], v[96:99]
    v_mfma_f32_16x16x32_bf16 v[116:119], v[136:139], v[68:71], v[116:119]
    v_mfma_f32_16x16x32_bf16 v[100:103], v[140:143], v[64:67], v[100:103]
    v_mfma_f32_16x16x32_bf16 v[120:123], v[140:143], v[68:71], v[120:123]
    s_waitcnt lgkmcnt(14)
    v_mfma_f32_16x16x32_bf16 v[104:107], v[144:147], v[64:67], v[104:107]
    v_mfma_f32_16x16x32_bf16 v[124:127], v[144:147], v[68:71], v[124:127]
    s_waitcnt lgkmcnt(12)
    v_mfma_f32_16x16x32_bf16 v[108:111], v[148:151], v[64:67], v[108:111]
    v_mfma_f32_16x16x32_bf16 v[128:131], v[148:151], v[68:71], v[128:131]
    s_waitcnt lgkmcnt(10)
    v_mfma_f32_16x16x32_bf16 v[112:115], v[152:155], v[64:67], v[112:115]
    v_mfma_f32_16x16x32_bf16 v[132:135], v[152:155], v[68:71], v[132:135]
    s_waitcnt lgkmcnt(0)
    v_mfma_f32_16x16x32_bf16 v[116:119], v[156:159], v[76:79], v[116:119]
    v_mfma_f32_16x16x32_bf16 v[120:123], v[160:163], v[76:79], v[120:123]
    v_mfma_f32_16x16x32_bf16 v[124:127], v[164:167], v[76:79], v[124:127]
    v_mfma_f32_16x16x32_bf16 v[128:131], v[168:171], v[76:79], v[128:131]
    v_mfma_f32_16x16x32_bf16 v[132:135], v[172:175], v[76:79], v[132:135]
    v_mfma_f32_16x16x32_bf16 v[96:99], v[156:159], v[72:75], v[96:99]
    s_nop 2
    ds_write_b128 v9, v[116:119] offset:0
    v_mfma_f32_16x16x32_bf16 v[100:103], v[160:163], v[72:75], v[100:103]
    ds_write_b128 v9, v[120:123] offset:1024
    v_mfma_f32_16x16x32_bf16 v[104:107], v[164:167], v[72:75], v[104:107]
    ds_write_b128 v9, v[124:127] offset:2048
    v_mfma_f32_16x16x32_bf16 v[108:111], v[168:171], v[72:75], v[108:111]
    ds_write_b128 v9, v[128:131] offset:3072
    v_mfma_f32_16x16x32_bf16 v[112:115], v[172:175], v[72:75], v[112:115]
    ds_write_b128 v9, v[132:135] offset:4096
    s_mov_b64 exec, 1
    ds_add_u32 v12, v4 offset:368
    s_mov_b64 exec, -1
    ds_read_b32 v5, v12 offset:368
    s_waitcnt lgkmcnt(0)
    v_cmp_ne_u32 vcc, 0x4f000, v5
    s_cbranch_vccnz L_cs_117
L_cb_118:
    ds_read_b128 v[116:119], v10 offset:0
    ds_read_b128 v[120:123], v10 offset:1024
    ds_read_b128 v[124:127], v10 offset:2048
    ds_read_b128 v[128:131], v10 offset:3072
    ds_read_b128 v[132:135], v10 offset:4096
    s_waitcnt lgkmcnt(4)
    v_add_f32 v96, v96, v116
    v_add_f32 v97, v97, v117
    v_add_f32 v98, v98, v118
    v_add_f32 v99, v99, v119
    v_cvt_pk_bf16_f32 v16, v96, v97
    v_cvt_pk_bf16_f32 v17, v98, v99
    s_waitcnt lgkmcnt(3)
    v_add_f32 v100, v100, v120
    v_add_f32 v101, v101, v121
    v_add_f32 v102, v102, v122
    v_add_f32 v103, v103, v123
    v_cvt_pk_bf16_f32 v18, v100, v101
    v_cvt_pk_bf16_f32 v19, v102, v103
    buffer_store_dwordx4 v[16:19], v11, s[20:23], s57 offen
    s_waitcnt lgkmcnt(2)
    v_add_f32 v104, v104, v124
    v_add_f32 v105, v105, v125
    v_add_f32 v106, v106, v126
    v_add_f32 v107, v107, v127
    v_cvt_pk_bf16_f32 v20, v104, v105
    v_cvt_pk_bf16_f32 v21, v106, v107
    s_waitcnt lgkmcnt(1)
    v_add_f32 v108, v108, v128
    v_add_f32 v109, v109, v129
    v_add_f32 v110, v110, v130
    v_add_f32 v111, v111, v131
    v_cvt_pk_bf16_f32 v22, v108, v109
    v_cvt_pk_bf16_f32 v23, v110, v111
    buffer_store_dwordx4 v[20:23], v11, s[20:23], s57 offen offset:16
    s_waitcnt lgkmcnt(0)
    v_add_f32 v112, v112, v132
    v_add_f32 v113, v113, v133
    v_add_f32 v114, v114, v134
    v_add_f32 v115, v115, v135
    v_cvt_pk_bf16_f32 v24, v112, v113
    v_cvt_pk_bf16_f32 v25, v114, v115
    buffer_store_dwordx2 v[24:25], v11, s[20:23], s57 offen offset:32
    s_nop 0
    s_branch L_fin
L_stg:
    ds_read_b32 v5, v4 offset:308
    s_waitcnt lgkmcnt(0)
    v_cmp_ne_u32 vcc, 0x13c000, v5
    s_cbranch_vccnz L_cs_119
L_cb_120:
    ds_write_b128 v1, v[196:199] offset:0
    ds_write_b128 v1, v[200:203] offset:1024
    ds_write_b128 v1, v[204:207] offset:2048
    ds_write_b128 v1, v[208:211] offset:3072
    ds_write_b128 v1, v[212:215] offset:4096
    ds_write_b128 v1, v[216:219] offset:5120
    ds_write_b128 v1, v[220:223] offset:6144
    ds_write_b128 v1, v[224:227] offset:7168
    ds_write_b128 v1, v[228:231] offset:8192
    ds_write_b128 v1, v[232:235] offset:9216
    s_mov_b64 exec, 1
    ds_add_u32 v4, v4 offset:304
    s_mov_b64 exec, -1
    s_branch L_stgd
L_oretry:
    s_nop 7
    s_sub_u32 s77, s77, 1
    s_cbranch_scc1 L_ogive
    s_waitcnt vmcnt(0)
    v_max3_u32 v13, v16, v20, v24
    v_max_u32 v13, v13, v28
    v_cmp_eq_u32 vcc, -1, v13
    s_cbranch_vccz L_rs_121
    buffer_load_dwordx4 v[16:19], v6, s[12:15], s48 offen offset:0 sc1
    buffer_load_dwordx4 v[20:23], v7, s[12:15], s48 offen offset:0 sc1
    buffer_load_dwordx4 v[24:27], v6, s[12:15], s48 offen offset:1024 sc1
    buffer_load_dwordx4 v[28:31], v7, s[12:15], s48 offen offset:1024 sc1
L_rs_121:
    v_max3_u32 v13, v32, v36, v40
    v_max_u32 v13, v13, v44
    v_cmp_eq_u32 vcc, -1, v13
    s_cbranch_vccz L_rs_122
    buffer_load_dwordx4 v[32:35], v6, s[12:15], s49 offen offset:0 sc1
    buffer_load_dwordx4 v[36:39], v7, s[12:15], s49 offen offset:0 sc1
    buffer_load_dwordx4 v[40:43], v6, s[12:15], s49 offen offset:1024 sc1
    buffer_load_dwordx4 v[44:47], v7, s[12:15], s49 offen offset:1024 sc1
L_rs_122:
    v_max3_u32 v13, v80, v82, v84
    v_max_u32 v13, v13, v86
    v_cmp_eq_u32 vcc, -1, v13
    s_cbranch_vccz L_rs_123
    buffer_load_dwordx4 v[80:83], v6, s[12:15], s52 offen offset:0 sc1
    buffer_load_dwordx4 v[84:87], v7, s[12:15], s52 offen offset:0 sc1
L_rs_123:
    v_max3_u32 v13, v88, v90, v92
    v_max_u32 v13, v13, v94
    v_cmp_eq_u32 vcc, -1, v13
    s_cbranch_vccz L_rs_124
    buffer_load_dwordx4 v[88:91], v6, s[12:15], s53 offen offset:0 sc1
    buffer_load_dwordx4 v[92:95], v7, s[12:15], s53 offen offset:0 sc1
L_rs_124:
    v_max3_u32 v13, v48, v52, v56
    v_max_u32 v13, v13, v60
    v_cmp_eq_u32 vcc, -1, v13
    s_cbranch_vccz L_rs_125
    buffer_load_dwordx4 v[48:51], v6, s[12:15], s50 offen offset:0 sc1
    buffer_load_dwordx4 v[52:55], v7, s[12:15], s50 offen offset:0 sc1
    buffer_load_dwordx4 v[56:59], v6, s[12:15], s50 offen offset:1024 sc1
    buffer_load_dwordx4 v[60:63], v7, s[12:15], s50 offen offset:1024 sc1
L_rs_125:
    v_max3_u32 v13, v64, v68, v72
    v_max_u32 v13, v13, v76
    v_cmp_eq_u32 vcc, -1, v13
    s_cbranch_vccz L_rs_126
    buffer_load_dwordx4 v[64:67], v6, s[12:15], s51 offen offset:0 sc1
    buffer_load_dwordx4 v[68:71], v7, s[12:15], s51 offen offset:0 sc1
    buffer_load_dwordx4 v[72:75], v6, s[12:15], s51 offen offset:1024 sc1
    buffer_load_dwordx4 v[76:79], v7, s[12:15], s51 offen offset:1024 sc1
L_rs_126:
    s_waitcnt vmcnt(0)
    s_cmp_eq_u32 s58, 0
    s_cbranch_scc1 L_oc0
    s_cmp_eq_u32 s58, 1
    s_cbranch_scc1 L_oc1
    s_cmp_eq_u32 s58, 2
    s_cbranch_scc1 L_oc2
    s_cmp_eq_u32 s58, 3
    s_cbranch_scc1 L_oc3
    s_cmp_eq_u32 s58, 4
    s_cbranch_scc1 L_oc4
    s_cmp_eq_u32 s58, 5
    s_cbranch_scc1 L_oc5
L_ogive:
    s_mov_b32 s77, 0
    s_cmp_eq_u32 s58, 0
    s_cbranch_scc1 L_og0
    s_cmp_eq_u32 s58, 1
    s_cbranch_scc1 L_og1
    s_cmp_eq_u32 s58, 2
    s_cbranch_scc1 L_og2
    s_cmp_eq_u32 s58, 3
    s_cbranch_scc1 L_og3
    s_cmp_eq_u32 s58, 4
    s_cbranch_scc1 L_og4
    s_cmp_eq_u32 s58, 5
    s_cbranch_scc1 L_og5
    s_branch L_fin
L_oc1:
    v_max3_u32 v13, v32, v36, v40
    v_max_u32 v13, v13, v44
    v_cmp_eq_u32 vcc, -1, v13
    s_cbranch_vccnz L_oretry
    s_branch L_og1
L_oc2:
    v_max3_u32 v13, v80, v82, v84
    v_max_u32 v13, v13, v86
    v_cmp_eq_u32 vcc, -1, v13
    s_cbranch_vccnz L_oretry
    s_branch L_og2
L_oc3:
    v_max3_u32 v13, v88, v90, v92
    v_max_u32 v13, v13, v94
    v_cmp_eq_u32 vcc, -1, v13
    s_cbranch_vccnz L_oretry
    s_branch L_og3
L_oc4:
    v_max3_u32 v13, v48, v52, v56
    v_max_u32 v13, v13, v60
    v_cmp_eq_u32 vcc, -1, v13
    s_cbranch_vccnz L_oretry
    s_branch L_og4
L_oc5:
    v_max3_u32 v13, v64, v68, v72
    v_max_u32 v13, v13, v76
    v_cmp_eq_u32 vcc, -1, v13
    s_cbranch_vccnz L_oretry
    s_branch L_og5
L_cs_111:
    s_mov_b32 s47, 1048576
L_cs_111l:
    ds_read_b32 v5, v4 offset:304
    s_waitcnt lgkmcnt(0)
    v_cmp_ne_u32 vcc, 0x13c000, v5
    s_cbranch_vccz L_cb_112
    s_sub_u32 s47, s47, 1
    s_cmp_lg_u32 s47, 0
    s_cbranch_scc1 L_cs_111l
    s_branch L_cb_112
L_cs_113:
    s_mov_b32 s47, 1048576
L_cs_113l:
    ds_read_b32 v5, v4 offset:404
    s_waitcnt lgkmcnt(0)
    v_cmp_ne_u32 vcc, 0x9e000, v5
    s_cbranch_vccz L_cb_114
    s_sub_u32 s47, s47, 1
    s_cmp_lg_u32 s47, 0
    s_cbranch_scc1 L_cs_113l
    s_branch L_cb_114
L_cs_115:
    s_mov_b32 s47, 1048576
L_cs_115l:
    ds_read_b32 v5, v4 offset:304
    s_waitcnt lgkmcnt(0)
    v_cmp_ne_u32 vcc, 0x13c000, v5
    s_cbranch_vccz L_cb_116
    s_sub_u32 s47, s47, 1
    s_cmp_lg_u32 s47, 0
    s_cbranch_scc1 L_cs_115l
    s_branch L_cb_116
L_cs_117:
    s_mov_b32 s47, 1048576
L_cs_117l:
    ds_read_b32 v5, v12 offset:368
    s_waitcnt lgkmcnt(0)
    v_cmp_ne_u32 vcc, 0x4f000, v5
    s_cbranch_vccz L_cb_118
    s_sub_u32 s47, s47, 1
    s_cmp_lg_u32 s47, 0
    s_cbranch_scc1 L_cs_117l
    s_branch L_cb_118
L_cs_119:
    s_mov_b32 s47, 1048576
L_cs_119l:
    ds_read_b32 v5, v4 offset:308
    s_waitcnt lgkmcnt(0)
    v_cmp_ne_u32 vcc, 0x13c000, v5
    s_cbranch_vccz L_cb_120
    s_sub_u32 s47, s47, 1
    s_cmp_lg_u32 s47, 0
    s_cbranch_scc1 L_cs_119l
    s_branch L_cb_120
L_fin:
L_end:
    s_endpgm
L_skC0:
    s_waitcnt vmcnt(0)
    s_nop 15
    s_branch L_skipC0
L_skC1:
    s_waitcnt vmcnt(0)
    s_nop 15
    s_branch L_skipC1
L_slowC:
    s_waitcnt lgkmcnt(0)
    s_nop 15
    v_mov_b32 v176, 0xff61b1e6
    v_mov_b32 v178, 0xff61b1e6
    ds_read_b128 v[104:107], v181 offset:0
    ds_read_b128 v[108:111], v180 offset:0
    s_waitcnt lgkmcnt(0)
    v_mfma_f32_32x32x16_bf16 v[64:79], v[104:107], v[20:23], 0
    v_mfma_f32_32x32x16_bf16 v[64:79], v[108:111], v[16:19], v[64:79]
    s_nop 11
    v_max3_f32 v176, v176, v64, v65
    v_max3_f32 v176, v176, v66, v67
    v_max3_f32 v176, v176, v68, v69
    v_max3_f32 v176, v176, v70, v71
    v_max3_f32 v176, v176, v72, v73
    v_max3_f32 v176, v176, v74, v75
    v_max3_f32 v176, v176, v76, v77
    v_max3_f32 v176, v176, v78, v79
    ds_read_b128 v[112:115], v181 offset:0
    ds_read_b128 v[116:119], v180 offset:0
    s_waitcnt lgkmcnt(0)
    v_mfma_f32_32x32x16_bf16 v[80:95], v[112:115], v[28:31], 0
    v_mfma_f32_32x32x16_bf16 v[80:95], v[116:119], v[24:27], v[80:95]
    s_nop 11
    v_max3_f32 v178, v178, v80, v81
    v_max3_f32 v178, v178, v82, v83
    v_max3_f32 v178, v178, v84, v85
    v_max3_f32 v178, v178, v86, v87
    v_max3_f32 v178, v178, v88, v89
    v_max3_f32 v178, v178, v90, v91
    v_max3_f32 v178, v178, v92, v93
    v_max3_f32 v178, v178, v94, v95
    ds_read_b128 v[104:107], v181 offset:512
    ds_read_b128 v[108:111], v180 offset:512
    s_waitcnt lgkmcnt(0)
    v_mfma_f32_32x32x16_bf16 v[64:79], v[104:107], v[20:23], 0
    v_mfma_f32_32x32x16_bf16 v[64:79], v[108:111], v[16:19], v[64:79]
    s_nop 11
    v_max3_f32 v176, v176, v64, v65
    v_max3_f32 v176, v176, v66, v67
    v_max3_f32 v176, v176, v68, v69
    v_max3_f32 v176, v176, v70, v71
    v_max3_f32 v176, v176, v72, v73
    v_max3_f32 v176, v176, v74, v75
    v_max3_f32 v176, v176, v76, v77
    v_max3_f32 v176, v176, v78, v79
    ds_read_b128 v[112:115], v181 offset:512
    ds_read_b128 v[116:119], v180 offset:512
    s_waitcnt lgkmcnt(0)
    v_mfma_f32_32x32x16_bf16 v[80:95], v[112:115], v[28:31], v[160:175]
    v_mfma_f32_32x32x16_bf16 v[80:95], v[116:119], v[24:27], v[80:95]
    s_nop 11
    v_max3_f32 v178, v178, v80, v81
    v_max3_f32 v178, v178, v82, v83
    v_max3_f32 v178, v178, v84, v85
    v_max3_f32 v178, v178, v86, v87
    v_max3_f32 v178, v178, v88, v89
    v_max3_f32 v178, v178, v90, v91
    v_max3_f32 v178, v178, v92, v93
    v_max3_f32 v178, v178, v94, v95
    ds_read_b128 v[104:107], v181 offset:1024
    ds_read_b128 v[108:111], v180 offset:1024
    s_waitcnt lgkmcnt(0)
    v_mfma_f32_32x32x16_bf16 v[64:79], v[104:107], v[20:23], 0
    v_mfma_f32_32x32x16_bf16 v[64:79], v[108:111], v[16:19], v[64:79]
    s_nop 11
    v_max3_f32 v176, v176, v64, v65
    v_max3_f32 v176, v176, v66, v67
    v_max3_f32 v176, v176, v68, v69
    v_max3_f32 v176, v176, v70, v71
    v_max3_f32 v176, v176, v72, v73
    v_max3_f32 v176, v176, v74, v75
    v_max3_f32 v176, v176, v76, v77
    v_max3_f32 v176, v176, v78, v79
    ds_read_b128 v[112:115], v181 offset:1536
    ds_read_b128 v[116:119], v180 offset:1536
    s_waitcnt lgkmcnt(0)
    v_mfma_f32_32x32x16_bf16 v[80:95], v[112:115], v[20:23], v[160:175]
    v_mfma_f32_32x32x16_bf16 v[80:95], v[116:119], v[16:19], v[80:95]
    s_nop 11
    v_max3_f32 v176, v176, v80, v81
    v_max3_f32 v176, v176, v82, v83
    v_max3_f32 v176, v176, v84, v85
    v_max3_f32 v176, v176, v86, v87
    v_max3_f32 v176, v176, v88, v89
    v_max3_f32 v176, v176, v90, v91
    v_max3_f32 v176, v176, v92, v93
    v_max3_f32 v176, v176, v94, v95
    v_mov_b32 v177, v176
    s_nop 1
    v_permlane32_swap_b32 v177, v176
    v_max_f32 v176, v176, v177
    v_sub_f32 v176, 0xc1a00000, v176
    v_lshlrev_b32 v177, 16, v20
    v_add_f32 v176, v176, v177
    v_and_b32 v177, 0xffff0000, v20
    v_add_f32 v176, v176, v177
    v_and_b32 v177, 0xffff0000, v176
    v_sub_f32 v176, v176, v177
    v_and_b32 v176, 0xffff0000, v176
    v_lshrrev_b32 v177, 16, v177
    v_or_b32 v177, v177, v176
    v_cndmask_b32 v20, v20, v177, s[80:81]
    v_mov_b32 v179, v178
    s_nop 1
    v_permlane32_swap_b32 v179, v178
    v_max_f32 v178, v178, v179
    v_sub_f32 v178, 0xc1a00000, v178
    v_lshlrev_b32 v179, 16, v28
    v_add_f32 v178, v178, v179
    v_and_b32 v179, 0xffff0000, v28
    v_add_f32 v178, v178, v179
    v_and_b32 v179, 0xffff0000, v178
    v_sub_f32 v178, v178, v179
    v_and_b32 v178, 0xffff0000, v178
    v_lshrrev_b32 v179, 16, v179
    v_or_b32 v179, v179, v178
    v_cndmask_b32 v28, v28, v179, s[80:81]
    s_mov_b64 s[52:53], 0
    s_nop 0
    s_branch L_mainC
L_fixC:
    s_waitcnt lgkmcnt(0)
    s_nop 15
    v_mov_b32 v176, 0xff61b1e6
    v_mov_b32 v178, 0xff61b1e6
    ds_read_b128 v[104:107], v184 offset:0
    ds_read_b128 v[108:111], v183 offset:0
    s_waitcnt lgkmcnt(0)
    v_mfma_f32_32x32x16_bf16 v[64:79], v[104:107], v[20:23], 0
    v_mfma_f32_32x32x16_bf16 v[64:79], v[108:111], v[16:19], v[64:79]
    s_nop 11
    v_max3_f32 v176, v176, v64, v65
    v_max3_f32 v176, v176, v66, v67
    v_max3_f32 v176, v176, v68, v69
    v_max3_f32 v176, v176, v70, v71
    v_max3_f32 v176, v176, v72, v73
    v_max3_f32 v176, v176, v74, v75
    v_max3_f32 v176, v176, v76, v77
    v_max3_f32 v176, v176, v78, v79
    ds_read_b128 v[112:115], v184 offset:0
    ds_read_b128 v[116:119], v183 offset:0
    s_waitcnt lgkmcnt(0)
    v_mfma_f32_32x32x16_bf16 v[80:95], v[112:115], v[28:31], 0
    v_mfma_f32_32x32x16_bf16 v[80:95], v[116:119], v[24:27], v[80:95]
    s_nop 11
    v_max3_f32 v178, v178, v80, v81
    v_max3_f32 v178, v178, v82, v83
    v_max3_f32 v178, v178, v84, v85
    v_max3_f32 v178, v178, v86, v87
    v_max3_f32 v178, v178, v88, v89
    v_max3_f32 v178, v178, v90, v91
    v_max3_f32 v178, v178, v92, v93
    v_max3_f32 v178, v178, v94, v95
    ds_read_b128 v[104:107], v184 offset:512
    ds_read_b128 v[108:111], v183 offset:512
    s_waitcnt lgkmcnt(0)
    v_mfma_f32_32x32x16_bf16 v[64:79], v[104:107], v[20:23], 0
    v_mfma_f32_32x32x16_bf16 v[64:79], v[108:111], v[16:19], v[64:79]
    s_nop 11
    v_max3_f32 v176, v176, v64, v65
    v_max3_f32 v176, v176, v66, v67
    v_max3_f32 v176, v176, v68, v69
    v_max3_f32 v176, v176, v70, v71
    v_max3_f32 v176, v176, v72, v73
    v_max3_f32 v176, v176, v74, v75
    v_max3_f32 v176, v176, v76, v77
    v_max3_f32 v176, v176, v78, v79
    ds_read_b128 v[112:115], v184 offset:512
    ds_read_b128 v[116:119], v183 offset:512
    s_waitcnt lgkmcnt(0)
    v_mfma_f32_32x32x16_bf16 v[80:95], v[112:115], v[28:31], 0
    v_mfma_f32_32x32x16_bf16 v[80:95], v[116:119], v[24:27], v[80:95]
    s_nop 11
    v_max3_f32 v178, v178, v80, v81
    v_max3_f32 v178, v178, v82, v83
    v_max3_f32 v178, v178, v84, v85
    v_max3_f32 v178, v178, v86, v87
    v_max3_f32 v178, v178, v88, v89
    v_max3_f32 v178, v178, v90, v91
    v_max3_f32 v178, v178, v92, v93
    v_max3_f32 v178, v178, v94, v95
    ds_read_b128 v[104:107], v184 offset:1024
    ds_read_b128 v[108:111], v183 offset:1024
    s_waitcnt lgkmcnt(0)
    v_mfma_f32_32x32x16_bf16 v[64:79], v[104:107], v[20:23], 0
    v_mfma_f32_32x32x16_bf16 v[64:79], v[108:111], v[16:19], v[64:79]
    s_nop 11
    v_max3_f32 v176, v176, v64, v65
    v_max3_f32 v176, v176, v66, v67
    v_max3_f32 v176, v176, v68, v69
    v_max3_f32 v176, v176, v70, v71
    v_max3_f32 v176, v176, v72, v73
    v_max3_f32 v176, v176, v74, v75
    v_max3_f32 v176, v176, v76, v77
    v_max3_f32 v176, v176, v78, v79
    ds_read_b128 v[112:115], v184 offset:1024
    ds_read_b128 v[116:119], v183 offset:1024
    s_waitcnt lgkmcnt(0)
    v_mfma_f32_32x32x16_bf16 v[80:95], v[112:115], v[28:31], 0
    v_mfma_f32_32x32x16_bf16 v[80:95], v[116:119], v[24:27], v[80:95]
    s_nop 11
    v_max3_f32 v178, v178, v80, v81
    v_max3_f32 v178, v178, v82, v83
    v_max3_f32 v178, v178, v84, v85
    v_max3_f32 v178, v178, v86, v87
    v_max3_f32 v178, v178, v88, v89
    v_max3_f32 v178, v178, v90, v91
    v_max3_f32 v178, v178, v92, v93
    v_max3_f32 v178, v178, v94, v95
    ds_read_b128 v[104:107], v184 offset:1536
    ds_read_b128 v[108:111], v183 offset:1536
    s_waitcnt lgkmcnt(0)
    v_mfma_f32_32x32x16_bf16 v[64:79], v[104:107], v[20:23], 0
    v_mfma_f32_32x32x16_bf16 v[64:79], v[108:111], v[16:19], v[64:79]
    s_nop 11
    v_max3_f32 v176, v176, v64, v65
    v_max3_f32 v176, v176, v66, v67
    v_max3_f32 v176, v176, v68, v69
    v_max3_f32 v176, v176, v70, v71
    v_max3_f32 v176, v176, v72, v73
    v_max3_f32 v176, v176, v74, v75
    v_max3_f32 v176, v176, v76, v77
    v_max3_f32 v176, v176, v78, v79
    ds_read_b128 v[112:115], v184 offset:1536
    ds_read_b128 v[116:119], v183 offset:1536
    s_waitcnt lgkmcnt(0)
    v_mfma_f32_32x32x16_bf16 v[80:95], v[112:115], v[28:31], 0
    v_mfma_f32_32x32x16_bf16 v[80:95], v[116:119], v[24:27], v[80:95]
    s_nop 11
    v_max3_f32 v178, v178, v80, v81
    v_max3_f32 v178, v178, v82, v83
    v_max3_f32 v178, v178, v84, v85
    v_max3_f32 v178, v178, v86, v87
    v_max3_f32 v178, v178, v88, v89
    v_max3_f32 v178, v178, v90, v91
    v_max3_f32 v178, v178, v92, v93
    v_max3_f32 v178, v178, v94, v95
    ds_read_b128 v[104:107], v187 offset:1536
    ds_read_b128 v[108:111], v186 offset:1536
    s_waitcnt lgkmcnt(0)
    v_mfma_f32_32x32x16_bf16 v[64:79], v[104:107], v[20:23], v[160:175]
    v_mfma_f32_32x32x16_bf16 v[64:79], v[108:111], v[16:19], v[64:79]
    s_nop 11
    v_max3_f32 v176, v176, v64, v65
    v_max3_f32 v176, v176, v66, v67
    v_max3_f32 v176, v176, v68, v69
    v_max3_f32 v176, v176, v70, v71
    v_max3_f32 v176, v176, v72, v73
    v_max3_f32 v176, v176, v74, v75
    v_max3_f32 v176, v176, v76, v77
    v_max3_f32 v176, v176, v78, v79
    ds_read_b128 v[112:115], v187 offset:1536
    ds_read_b128 v[116:119], v186 offset:1536
    s_waitcnt lgkmcnt(0)
    v_mfma_f32_32x32x16_bf16 v[80:95], v[112:115], v[28:31], 0
    v_mfma_f32_32x32x16_bf16 v[80:95], v[116:119], v[24:27], v[80:95]
    s_nop 11
    v_max3_f32 v178, v178, v80, v81
    v_max3_f32 v178, v178, v82, v83
    v_max3_f32 v178, v178, v84, v85
    v_max3_f32 v178, v178, v86, v87
    v_max3_f32 v178, v178, v88, v89
    v_max3_f32 v178, v178, v90, v91
    v_max3_f32 v178, v178, v92, v93
    v_max3_f32 v178, v178, v94, v95
    ds_read_b128 v[104:107], v187 offset:1024
    ds_read_b128 v[108:111], v186 offset:1024
    s_waitcnt lgkmcnt(0)
    v_mfma_f32_32x32x16_bf16 v[64:79], v[104:107], v[28:31], 0
    v_mfma_f32_32x32x16_bf16 v[64:79], v[108:111], v[24:27], v[64:79]
    s_nop 11
    v_max3_f32 v178, v178, v64, v65
    v_max3_f32 v178, v178, v66, v67
    v_max3_f32 v178, v178, v68, v69
    v_max3_f32 v178, v178, v70, v71
    v_max3_f32 v178, v178, v72, v73
    v_max3_f32 v178, v178, v74, v75
    v_max3_f32 v178, v178, v76, v77
    v_max3_f32 v178, v178, v78, v79
    ds_read_b128 v[112:115], v187 offset:512
    ds_read_b128 v[116:119], v186 offset:512
    s_waitcnt lgkmcnt(0)
    v_mfma_f32_32x32x16_bf16 v[80:95], v[112:115], v[28:31], v[160:175]
    v_mfma_f32_32x32x16_bf16 v[80:95], v[116:119], v[24:27], v[80:95]
    s_nop 11
    v_max3_f32 v178, v178, v80, v81
    v_max3_f32 v178, v178, v82, v83
    v_max3_f32 v178, v178, v84, v85
    v_max3_f32 v178, v178, v86, v87
    v_max3_f32 v178, v178, v88, v89
    v_max3_f32 v178, v178, v90, v91
    v_max3_f32 v178, v178, v92, v93
    v_max3_f32 v178, v178, v94, v95
    v_mov_b32 v177, v176
    s_nop 1
    v_permlane32_swap_b32 v177, v176
    v_max_f32 v176, v176, v177
    v_sub_f32 v176, 0xc1a00000, v176
    v_lshlrev_b32 v177, 16, v20
    v_add_f32 v176, v176, v177
    v_and_b32 v177, 0xffff0000, v20
    v_add_f32 v176, v176, v177
    v_and_b32 v177, 0xffff0000, v176
    v_sub_f32 v176, v176, v177
    v_and_b32 v176, 0xffff0000, v176
    v_lshrrev_b32 v177, 16, v177
    v_or_b32 v177, v177, v176
    v_cndmask_b32 v20, v20, v177, s[80:81]
    v_mov_b32 v179, v178
    s_nop 1
    v_permlane32_swap_b32 v179, v178
    v_max_f32 v178, v178, v179
    v_sub_f32 v178, 0xc1a00000, v178
    v_lshlrev_b32 v179, 16, v28
    v_add_f32 v178, v178, v179
    v_and_b32 v179, 0xffff0000, v28
    v_add_f32 v178, v178, v179
    v_and_b32 v179, 0xffff0000, v178
    v_sub_f32 v178, v178, v179
    v_and_b32 v178, 0xffff0000, v178
    v_lshrrev_b32 v179, 16, v179
    v_or_b32 v179, v179, v178
    v_cndmask_b32 v28, v28, v179, s[80:81]
    s_cmp_eq_u64 s[64:65], 0
    s_nop 0
    s_cbranch_scc1 L_fxC0
    ds_read_b128 v[104:107], v184 offset:0
    ds_read_b128 v[108:111], v183 offset:0
    ds_read_b64_tr_b16 v[136:137], v185 offset:0
    ds_read_b64_tr_b16 v[138:139], v185 offset:128
    ds_read_b64_tr_b16 v[140:141], v185 offset:256
    ds_read_b64_tr_b16 v[142:143], v185 offset:384
    s_waitcnt lgkmcnt(4)
    v_mfma_f32_32x32x16_bf16 v[64:79], v[104:107], v[20:23], 0
    v_mfma_f32_32x32x16_bf16 v[64:79], v[108:111], v[16:19], v[64:79]
    s_nop 11
    v_exp_f32 v64, v64
    v_exp_f32 v65, v65
    v_exp_f32 v66, v66
    v_exp_f32 v67, v67
    v_exp_f32 v68, v68
    v_exp_f32 v69, v69
    v_exp_f32 v70, v70
    v_exp_f32 v71, v71
    v_exp_f32 v72, v72
    v_exp_f32 v73, v73
    v_exp_f32 v74, v74
    v_exp_f32 v75, v75
    v_exp_f32 v76, v76
    v_exp_f32 v77, v77
    v_exp_f32 v78, v78
    v_exp_f32 v79, v79
    v_cvt_pk_bf16_f32 v96, v64, v65
    v_cvt_pk_bf16_f32 v97, v66, v67
    v_cvt_pk_bf16_f32 v98, v68, v69
    v_cvt_pk_bf16_f32 v99, v70, v71
    v_cvt_pk_bf16_f32 v100, v72, v73
    v_cvt_pk_bf16_f32 v101, v74, v75
    v_cvt_pk_bf16_f32 v102, v76, v77
    v_cvt_pk_bf16_f32 v103, v78, v79
    s_waitcnt lgkmcnt(0)
    v_mfma_f32_32x32x16_bf16 v[80:95], v[136:139], v[96:99], 0
    v_mfma_f32_32x32x16_bf16 v[80:95], v[140:143], v[100:103], v[80:95]
    ds_read_b128 v[104:107], v184 offset:512
    ds_read_b128 v[108:111], v183 offset:512
    ds_read_b64_tr_b16 v[136:137], v185 offset:512
    ds_read_b64_tr_b16 v[138:139], v185 offset:640
    ds_read_b64_tr_b16 v[140:141], v185 offset:768
    ds_read_b64_tr_b16 v[142:143], v185 offset:896
    s_waitcnt lgkmcnt(4)
    v_mfma_f32_32x32x16_bf16 v[64:79], v[104:107], v[20:23], 0
    v_mfma_f32_32x32x16_bf16 v[64:79], v[108:111], v[16:19], v[64:79]
    s_nop 11
    v_exp_f32 v64, v64
    v_exp_f32 v65, v65
    v_exp_f32 v66, v66
    v_exp_f32 v67, v67
    v_exp_f32 v68, v68
    v_exp_f32 v69, v69
    v_exp_f32 v70, v70
    v_exp_f32 v71, v71
    v_exp_f32 v72, v72
    v_exp_f32 v73, v73
    v_exp_f32 v74, v74
    v_exp_f32 v75, v75
    v_exp_f32 v76, v76
    v_exp_f32 v77, v77
    v_exp_f32 v78, v78
    v_exp_f32 v79, v79
    v_cvt_pk_bf16_f32 v96, v64, v65
    v_cvt_pk_bf16_f32 v97, v66, v67
    v_cvt_pk_bf16_f32 v98, v68, v69
    v_cvt_pk_bf16_f32 v99, v70, v71
    v_cvt_pk_bf16_f32 v100, v72, v73
    v_cvt_pk_bf16_f32 v101, v74, v75
    v_cvt_pk_bf16_f32 v102, v76, v77
    v_cvt_pk_bf16_f32 v103, v78, v79
    s_waitcnt lgkmcnt(0)
    v_mfma_f32_32x32x16_bf16 v[80:95], v[136:139], v[96:99], v[80:95]
    v_mfma_f32_32x32x16_bf16 v[80:95], v[140:143], v[100:103], v[80:95]
    ds_read_b128 v[104:107], v184 offset:1024
    ds_read_b128 v[108:111], v183 offset:1024
    ds_read_b64_tr_b16 v[136:137], v185 offset:1024
    ds_read_b64_tr_b16 v[138:139], v185 offset:1152
    ds_read_b64_tr_b16 v[140:141], v185 offset:1280
    ds_read_b64_tr_b16 v[142:143], v185 offset:1408
    s_waitcnt lgkmcnt(4)
    v_mfma_f32_32x32x16_bf16 v[64:79], v[104:107], v[20:23], 0
    v_mfma_f32_32x32x16_bf16 v[64:79], v[108:111], v[16:19], v[64:79]
    s_nop 11
    v_exp_f32 v64, v64
    v_exp_f32 v65, v65
    v_exp_f32 v66, v66
    v_exp_f32 v67, v67
    v_exp_f32 v68, v68
    v_exp_f32 v69, v69
    v_exp_f32 v70, v70
    v_exp_f32 v71, v71
    v_exp_f32 v72, v72
    v_exp_f32 v73, v73
    v_exp_f32 v74, v74
    v_exp_f32 v75, v75
    v_exp_f32 v76, v76
    v_exp_f32 v77, v77
    v_exp_f32 v78, v78
    v_exp_f32 v79, v79
    v_cvt_pk_bf16_f32 v96, v64, v65
    v_cvt_pk_bf16_f32 v97, v66, v67
    v_cvt_pk_bf16_f32 v98, v68, v69
    v_cvt_pk_bf16_f32 v99, v70, v71
    v_cvt_pk_bf16_f32 v100, v72, v73
    v_cvt_pk_bf16_f32 v101, v74, v75
    v_cvt_pk_bf16_f32 v102, v76, v77
    v_cvt_pk_bf16_f32 v103, v78, v79
    s_waitcnt lgkmcnt(0)
    v_mfma_f32_32x32x16_bf16 v[80:95], v[136:139], v[96:99], v[80:95]
    v_mfma_f32_32x32x16_bf16 v[80:95], v[140:143], v[100:103], v[80:95]
    ds_read_b128 v[104:107], v184 offset:1536
    ds_read_b128 v[108:111], v183 offset:1536
    ds_read_b64_tr_b16 v[136:137], v185 offset:1536
    ds_read_b64_tr_b16 v[138:139], v185 offset:1664
    ds_read_b64_tr_b16 v[140:141], v185 offset:1792
    ds_read_b64_tr_b16 v[142:143], v185 offset:1920
    s_waitcnt lgkmcnt(4)
    v_mfma_f32_32x32x16_bf16 v[64:79], v[104:107], v[20:23], 0
    v_mfma_f32_32x32x16_bf16 v[64:79], v[108:111], v[16:19], v[64:79]
    s_nop 11
    v_exp_f32 v64, v64
    v_exp_f32 v65, v65
    v_exp_f32 v66, v66
    v_exp_f32 v67, v67
    v_exp_f32 v68, v68
    v_exp_f32 v69, v69
    v_exp_f32 v70, v70
    v_exp_f32 v71, v71
    v_exp_f32 v72, v72
    v_exp_f32 v73, v73
    v_exp_f32 v74, v74
    v_exp_f32 v75, v75
    v_exp_f32 v76, v76
    v_exp_f32 v77, v77
    v_exp_f32 v78, v78
    v_exp_f32 v79, v79
    v_cvt_pk_bf16_f32 v96, v64, v65
    v_cvt_pk_bf16_f32 v97, v66, v67
    v_cvt_pk_bf16_f32 v98, v68, v69
    v_cvt_pk_bf16_f32 v99, v70, v71
    v_cvt_pk_bf16_f32 v100, v72, v73
    v_cvt_pk_bf16_f32 v101, v74, v75
    v_cvt_pk_bf16_f32 v102, v76, v77
    v_cvt_pk_bf16_f32 v103, v78, v79
    s_waitcnt lgkmcnt(0)
    v_mfma_f32_32x32x16_bf16 v[80:95], v[136:139], v[96:99], v[80:95]
    v_mfma_f32_32x32x16_bf16 v[80:95], v[140:143], v[100:103], v[80:95]
    ds_read_b128 v[104:107], v187 offset:1536
    ds_read_b128 v[108:111], v186 offset:1536
    ds_read_b64_tr_b16 v[136:137], v188 offset:1536
    ds_read_b64_tr_b16 v[138:139], v188 offset:1664
    ds_read_b64_tr_b16 v[140:141], v188 offset:1792
    ds_read_b64_tr_b16 v[142:143], v188 offset:1920
    s_waitcnt lgkmcnt(4)
    v_mfma_f32_32x32x16_bf16 v[64:79], v[104:107], v[20:23], v[160:175]
    v_mfma_f32_32x32x16_bf16 v[64:79], v[108:111], v[16:19], v[64:79]
    s_nop 11
    v_exp_f32 v64, v64
    v_exp_f32 v65, v65
    v_exp_f32 v66, v66
    v_exp_f32 v67, v67
    v_exp_f32 v68, v68
    v_exp_f32 v69, v69
    v_exp_f32 v70, v70
    v_exp_f32 v71, v71
    v_exp_f32 v72, v72
    v_exp_f32 v73, v73
    v_exp_f32 v74, v74
    v_exp_f32 v75, v75
    v_exp_f32 v76, v76
    v_exp_f32 v77, v77
    v_exp_f32 v78, v78
    v_exp_f32 v79, v79
    v_cvt_pk_bf16_f32 v96, v64, v65
    v_cvt_pk_bf16_f32 v97, v66, v67
    v_cvt_pk_bf16_f32 v98, v68, v69
    v_cvt_pk_bf16_f32 v99, v70, v71
    v_cvt_pk_bf16_f32 v100, v72, v73
    v_cvt_pk_bf16_f32 v101, v74, v75
    v_cvt_pk_bf16_f32 v102, v76, v77
    v_cvt_pk_bf16_f32 v103, v78, v79
    s_waitcnt lgkmcnt(0)
    v_mfma_f32_32x32x16_bf16 v[80:95], v[136:139], v[96:99], v[80:95]
    v_mfma_f32_32x32x16_bf16 v[80:95], v[140:143], v[100:103], v[80:95]
    s_nop 11
    v_cndmask_b32 v32, v32, v80, s[64:65]
    v_cndmask_b32 v33, v33, v81, s[64:65]
    v_cndmask_b32 v34, v34, v82, s[64:65]
    v_cndmask_b32 v35, v35, v83, s[64:65]
    v_cndmask_b32 v36, v36, v84, s[64:65]
    v_cndmask_b32 v37, v37, v85, s[64:65]
    v_cndmask_b32 v38, v38, v86, s[64:65]
    v_cndmask_b32 v39, v39, v87, s[64:65]
    v_cndmask_b32 v40, v40, v88, s[64:65]
    v_cndmask_b32 v41, v41, v89, s[64:65]
    v_cndmask_b32 v42, v42, v90, s[64:65]
    v_cndmask_b32 v43, v43, v91, s[64:65]
    v_cndmask_b32 v44, v44, v92, s[64:65]
    v_rcp_f32 v177, v44
    s_add_u32 s40, s54, 122880
    s_add_u32 s41, s55, 122880
    v_mul_f32 v32, v32, v177
    v_mul_f32 v33, v33, v177
    v_mul_f32 v34, v34, v177
    v_mul_f32 v35, v35, v177
    v_mul_f32 v36, v36, v177
    v_mul_f32 v37, v37, v177
    v_mul_f32 v38, v38, v177
    v_mul_f32 v39, v39, v177
    v_mul_f32 v40, v40, v177
    v_mul_f32 v41, v41, v177
    v_mul_f32 v42, v42, v177
    v_mul_f32 v43, v43, v177
    v_cvt_pk_bf16_f32 v32, v32, v33
    v_cvt_pk_bf16_f32 v33, v34, v35
    v_cvt_pk_bf16_f32 v34, v36, v37
    v_cvt_pk_bf16_f32 v35, v38, v39
    v_cvt_pk_bf16_f32 v36, v40, v41
    v_cvt_pk_bf16_f32 v37, v42, v43
    v_min_u32 v32, 0xfffffffe, v32
    v_min_u32 v36, 0xfffffffe, v36
    buffer_store_dwordx4 v[32:35], v191, s[12:15], s40 offen sc1
    buffer_store_dwordx2 v[36:37], v2, s[12:15], s41 offen sc1
    s_nop 0
L_fxC0:
    s_cmp_eq_u64 s[66:67], 0
    s_cbranch_scc1 L_fxC1
    ds_read_b128 v[104:107], v184 offset:0
    ds_read_b128 v[108:111], v183 offset:0
    ds_read_b64_tr_b16 v[136:137], v185 offset:0
    ds_read_b64_tr_b16 v[138:139], v185 offset:128
    ds_read_b64_tr_b16 v[140:141], v185 offset:256
    ds_read_b64_tr_b16 v[142:143], v185 offset:384
    s_waitcnt lgkmcnt(4)
    v_mfma_f32_32x32x16_bf16 v[64:79], v[104:107], v[28:31], 0
    v_mfma_f32_32x32x16_bf16 v[64:79], v[108:111], v[24:27], v[64:79]
    s_nop 11
    v_exp_f32 v64, v64
    v_exp_f32 v65, v65
    v_exp_f32 v66, v66
    v_exp_f32 v67, v67
    v_exp_f32 v68, v68
    v_exp_f32 v69, v69
    v_exp_f32 v70, v70
    v_exp_f32 v71, v71
    v_exp_f32 v72, v72
    v_exp_f32 v73, v73
    v_exp_f32 v74, v74
    v_exp_f32 v75, v75
    v_exp_f32 v76, v76
    v_exp_f32 v77, v77
    v_exp_f32 v78, v78
    v_exp_f32 v79, v79
    v_cvt_pk_bf16_f32 v96, v64, v65
    v_cvt_pk_bf16_f32 v97, v66, v67
    v_cvt_pk_bf16_f32 v98, v68, v69
    v_cvt_pk_bf16_f32 v99, v70, v71
    v_cvt_pk_bf16_f32 v100, v72, v73
    v_cvt_pk_bf16_f32 v101, v74, v75
    v_cvt_pk_bf16_f32 v102, v76, v77
    v_cvt_pk_bf16_f32 v103, v78, v79
    s_waitcnt lgkmcnt(0)
    v_mfma_f32_32x32x16_bf16 v[80:95], v[136:139], v[96:99], 0
    v_mfma_f32_32x32x16_bf16 v[80:95], v[140:143], v[100:103], v[80:95]
    ds_read_b128 v[104:107], v184 offset:512
    ds_read_b128 v[108:111], v183 offset:512
    ds_read_b64_tr_b16 v[136:137], v185 offset:512
    ds_read_b64_tr_b16 v[138:139], v185 offset:640
    ds_read_b64_tr_b16 v[140:141], v185 offset:768
    ds_read_b64_tr_b16 v[142:143], v185 offset:896
    s_waitcnt lgkmcnt(4)
    v_mfma_f32_32x32x16_bf16 v[64:79], v[104:107], v[28:31], 0
    v_mfma_f32_32x32x16_bf16 v[64:79], v[108:111], v[24:27], v[64:79]
    s_nop 11
    v_exp_f32 v64, v64
    v_exp_f32 v65, v65
    v_exp_f32 v66, v66
    v_exp_f32 v67, v67
    v_exp_f32 v68, v68
    v_exp_f32 v69, v69
    v_exp_f32 v70, v70
    v_exp_f32 v71, v71
    v_exp_f32 v72, v72
    v_exp_f32 v73, v73
    v_exp_f32 v74, v74
    v_exp_f32 v75, v75
    v_exp_f32 v76, v76
    v_exp_f32 v77, v77
    v_exp_f32 v78, v78
    v_exp_f32 v79, v79
    v_cvt_pk_bf16_f32 v96, v64, v65
    v_cvt_pk_bf16_f32 v97, v66, v67
    v_cvt_pk_bf16_f32 v98, v68, v69
    v_cvt_pk_bf16_f32 v99, v70, v71
    v_cvt_pk_bf16_f32 v100, v72, v73
    v_cvt_pk_bf16_f32 v101, v74, v75
    v_cvt_pk_bf16_f32 v102, v76, v77
    v_cvt_pk_bf16_f32 v103, v78, v79
    s_waitcnt lgkmcnt(0)
    v_mfma_f32_32x32x16_bf16 v[80:95], v[136:139], v[96:99], v[80:95]
    v_mfma_f32_32x32x16_bf16 v[80:95], v[140:143], v[100:103], v[80:95]
    ds_read_b128 v[104:107], v184 offset:1024
    ds_read_b128 v[108:111], v183 offset:1024
    ds_read_b64_tr_b16 v[136:137], v185 offset:1024
    ds_read_b64_tr_b16 v[138:139], v185 offset:1152
    ds_read_b64_tr_b16 v[140:141], v185 offset:1280
    ds_read_b64_tr_b16 v[142:143], v185 offset:1408
    s_waitcnt lgkmcnt(4)
    v_mfma_f32_32x32x16_bf16 v[64:79], v[104:107], v[28:31], 0
    v_mfma_f32_32x32x16_bf16 v[64:79], v[108:111], v[24:27], v[64:79]
    s_nop 11
    v_exp_f32 v64, v64
    v_exp_f32 v65, v65
    v_exp_f32 v66, v66
    v_exp_f32 v67, v67
    v_exp_f32 v68, v68
    v_exp_f32 v69, v69
    v_exp_f32 v70, v70
    v_exp_f32 v71, v71
    v_exp_f32 v72, v72
    v_exp_f32 v73, v73
    v_exp_f32 v74, v74
    v_exp_f32 v75, v75
    v_exp_f32 v76, v76
    v_exp_f32 v77, v77
    v_exp_f32 v78, v78
    v_exp_f32 v79, v79
    v_cvt_pk_bf16_f32 v96, v64, v65
    v_cvt_pk_bf16_f32 v97, v66, v67
    v_cvt_pk_bf16_f32 v98, v68, v69
    v_cvt_pk_bf16_f32 v99, v70, v71
    v_cvt_pk_bf16_f32 v100, v72, v73
    v_cvt_pk_bf16_f32 v101, v74, v75
    v_cvt_pk_bf16_f32 v102, v76, v77
    v_cvt_pk_bf16_f32 v103, v78, v79
    s_waitcnt lgkmcnt(0)
    v_mfma_f32_32x32x16_bf16 v[80:95], v[136:139], v[96:99], v[80:95]
    v_mfma_f32_32x32x16_bf16 v[80:95], v[140:143], v[100:103], v[80:95]
    ds_read_b128 v[104:107], v184 offset:1536
    ds_read_b128 v[108:111], v183 offset:1536
    ds_read_b64_tr_b16 v[136:137], v185 offset:1536
    ds_read_b64_tr_b16 v[138:139], v185 offset:1664
    ds_read_b64_tr_b16 v[140:141], v185 offset:1792
    ds_read_b64_tr_b16 v[142:143], v185 offset:1920
    s_waitcnt lgkmcnt(4)
    v_mfma_f32_32x32x16_bf16 v[64:79], v[104:107], v[28:31], 0
    v_mfma_f32_32x32x16_bf16 v[64:79], v[108:111], v[24:27], v[64:79]
    s_nop 11
    v_exp_f32 v64, v64
    v_exp_f32 v65, v65
    v_exp_f32 v66, v66
    v_exp_f32 v67, v67
    v_exp_f32 v68, v68
    v_exp_f32 v69, v69
    v_exp_f32 v70, v70
    v_exp_f32 v71, v71
    v_exp_f32 v72, v72
    v_exp_f32 v73, v73
    v_exp_f32 v74, v74
    v_exp_f32 v75, v75
    v_exp_f32 v76, v76
    v_exp_f32 v77, v77
    v_exp_f32 v78, v78
    v_exp_f32 v79, v79
    v_cvt_pk_bf16_f32 v96, v64, v65
    v_cvt_pk_bf16_f32 v97, v66, v67
    v_cvt_pk_bf16_f32 v98, v68, v69
    v_cvt_pk_bf16_f32 v99, v70, v71
    v_cvt_pk_bf16_f32 v100, v72, v73
    v_cvt_pk_bf16_f32 v101, v74, v75
    v_cvt_pk_bf16_f32 v102, v76, v77
    v_cvt_pk_bf16_f32 v103, v78, v79
    s_waitcnt lgkmcnt(0)
    v_mfma_f32_32x32x16_bf16 v[80:95], v[136:139], v[96:99], v[80:95]
    v_mfma_f32_32x32x16_bf16 v[80:95], v[140:143], v[100:103], v[80:95]
    ds_read_b128 v[104:107], v187 offset:1536
    ds_read_b128 v[108:111], v186 offset:1536
    ds_read_b64_tr_b16 v[136:137], v188 offset:1536
    ds_read_b64_tr_b16 v[138:139], v188 offset:1664
    ds_read_b64_tr_b16 v[140:141], v188 offset:1792
    ds_read_b64_tr_b16 v[142:143], v188 offset:1920
    s_waitcnt lgkmcnt(4)
    v_mfma_f32_32x32x16_bf16 v[64:79], v[104:107], v[28:31], 0
    v_mfma_f32_32x32x16_bf16 v[64:79], v[108:111], v[24:27], v[64:79]
    s_nop 11
    v_exp_f32 v64, v64
    v_exp_f32 v65, v65
    v_exp_f32 v66, v66
    v_exp_f32 v67, v67
    v_exp_f32 v68, v68
    v_exp_f32 v69, v69
    v_exp_f32 v70, v70
    v_exp_f32 v71, v71
    v_exp_f32 v72, v72
    v_exp_f32 v73, v73
    v_exp_f32 v74, v74
    v_exp_f32 v75, v75
    v_exp_f32 v76, v76
    v_exp_f32 v77, v77
    v_exp_f32 v78, v78
    v_exp_f32 v79, v79
    v_cvt_pk_bf16_f32 v96, v64, v65
    v_cvt_pk_bf16_f32 v97, v66, v67
    v_cvt_pk_bf16_f32 v98, v68, v69
    v_cvt_pk_bf16_f32 v99, v70, v71
    v_cvt_pk_bf16_f32 v100, v72, v73
    v_cvt_pk_bf16_f32 v101, v74, v75
    v_cvt_pk_bf16_f32 v102, v76, v77
    v_cvt_pk_bf16_f32 v103, v78, v79
    s_waitcnt lgkmcnt(0)
    v_mfma_f32_32x32x16_bf16 v[80:95], v[136:139], v[96:99], v[80:95]
    v_mfma_f32_32x32x16_bf16 v[80:95], v[140:143], v[100:103], v[80:95]
    ds_read_b128 v[104:107], v187 offset:1024
    ds_read_b128 v[108:111], v186 offset:1024
    ds_read_b64_tr_b16 v[136:137], v188 offset:1024
    ds_read_b64_tr_b16 v[138:139], v188 offset:1152
    ds_read_b64_tr_b16 v[140:141], v188 offset:1280
    ds_read_b64_tr_b16 v[142:143], v188 offset:1408
    s_waitcnt lgkmcnt(4)
    v_mfma_f32_32x32x16_bf16 v[64:79], v[104:107], v[28:31], 0
    v_mfma_f32_32x32x16_bf16 v[64:79], v[108:111], v[24:27], v[64:79]
    s_nop 11
    v_exp_f32 v64, v64
    v_exp_f32 v65, v65
    v_exp_f32 v66, v66
    v_exp_f32 v67, v67
    v_exp_f32 v68, v68
    v_exp_f32 v69, v69
    v_exp_f32 v70, v70
    v_exp_f32 v71, v71
    v_exp_f32 v72, v72
    v_exp_f32 v73, v73
    v_exp_f32 v74, v74
    v_exp_f32 v75, v75
    v_exp_f32 v76, v76
    v_exp_f32 v77, v77
    v_exp_f32 v78, v78
    v_exp_f32 v79, v79
    v_cvt_pk_bf16_f32 v96, v64, v65
    v_cvt_pk_bf16_f32 v97, v66, v67
    v_cvt_pk_bf16_f32 v98, v68, v69
    v_cvt_pk_bf16_f32 v99, v70, v71
    v_cvt_pk_bf16_f32 v100, v72, v73
    v_cvt_pk_bf16_f32 v101, v74, v75
    v_cvt_pk_bf16_f32 v102, v76, v77
    v_cvt_pk_bf16_f32 v103, v78, v79
    s_waitcnt lgkmcnt(0)
    v_mfma_f32_32x32x16_bf16 v[80:95], v[136:139], v[96:99], v[80:95]
    v_mfma_f32_32x32x16_bf16 v[80:95], v[140:143], v[100:103], v[80:95]
    ds_read_b128 v[104:107], v187 offset:512
    ds_read_b128 v[108:111], v186 offset:512
    ds_read_b64_tr_b16 v[136:137], v188 offset:512
    ds_read_b64_tr_b16 v[138:139], v188 offset:640
    ds_read_b64_tr_b16 v[140:141], v188 offset:768
    ds_read_b64_tr_b16 v[142:143], v188 offset:896
    s_waitcnt lgkmcnt(4)
    v_mfma_f32_32x32x16_bf16 v[64:79], v[104:107], v[28:31], v[160:175]
    v_mfma_f32_32x32x16_bf16 v[64:79], v[108:111], v[24:27], v[64:79]
    s_nop 11
    v_exp_f32 v64, v64
    v_exp_f32 v65, v65
    v_exp_f32 v66, v66
    v_exp_f32 v67, v67
    v_exp_f32 v68, v68
    v_exp_f32 v69, v69
    v_exp_f32 v70, v70
    v_exp_f32 v71, v71
    v_exp_f32 v72, v72
    v_exp_f32 v73, v73
    v_exp_f32 v74, v74
    v_exp_f32 v75, v75
    v_exp_f32 v76, v76
    v_exp_f32 v77, v77
    v_exp_f32 v78, v78
    v_exp_f32 v79, v79
    v_cvt_pk_bf16_f32 v96, v64, v65
    v_cvt_pk_bf16_f32 v97, v66, v67
    v_cvt_pk_bf16_f32 v98, v68, v69
    v_cvt_pk_bf16_f32 v99, v70, v71
    v_cvt_pk_bf16_f32 v100, v72, v73
    v_cvt_pk_bf16_f32 v101, v74, v75
    v_cvt_pk_bf16_f32 v102, v76, v77
    v_cvt_pk_bf16_f32 v103, v78, v79
    s_waitcnt lgkmcnt(0)
    v_mfma_f32_32x32x16_bf16 v[80:95], v[136:139], v[96:99], v[80:95]
    v_mfma_f32_32x32x16_bf16 v[80:95], v[140:143], v[100:103], v[80:95]
    s_nop 11
    v_cndmask_b32 v48, v48, v80, s[66:67]
    v_cndmask_b32 v49, v49, v81, s[66:67]
    v_cndmask_b32 v50, v50, v82, s[66:67]
    v_cndmask_b32 v51, v51, v83, s[66:67]
    v_cndmask_b32 v52, v52, v84, s[66:67]
    v_cndmask_b32 v53, v53, v85, s[66:67]
    v_cndmask_b32 v54, v54, v86, s[66:67]
    v_cndmask_b32 v55, v55, v87, s[66:67]
    v_cndmask_b32 v56, v56, v88, s[66:67]
    v_cndmask_b32 v57, v57, v89, s[66:67]
    v_cndmask_b32 v58, v58, v90, s[66:67]
    v_cndmask_b32 v59, v59, v91, s[66:67]
    v_cndmask_b32 v60, v60, v92, s[66:67]
    v_rcp_f32 v177, v60
    s_add_u32 s40, s54, 40960
    s_add_u32 s41, s55, 40960
    v_mul_f32 v48, v48, v177
    v_mul_f32 v49, v49, v177
    v_mul_f32 v50, v50, v177
    v_mul_f32 v51, v51, v177
    v_mul_f32 v52, v52, v177
    v_mul_f32 v53, v53, v177
    v_mul_f32 v54, v54, v177
    v_mul_f32 v55, v55, v177
    v_mul_f32 v56, v56, v177
    v_mul_f32 v57, v57, v177
    v_mul_f32 v58, v58, v177
    v_mul_f32 v59, v59, v177
    v_cvt_pk_bf16_f32 v48, v48, v49
    v_cvt_pk_bf16_f32 v49, v50, v51
    v_cvt_pk_bf16_f32 v50, v52, v53
    v_cvt_pk_bf16_f32 v51, v54, v55
    v_cvt_pk_bf16_f32 v52, v56, v57
    v_cvt_pk_bf16_f32 v53, v58, v59
    v_min_u32 v48, 0xfffffffe, v48
    v_min_u32 v52, 0xfffffffe, v52
    buffer_store_dwordx4 v[48:51], v191, s[12:15], s40 offen sc1
    buffer_store_dwordx2 v[52:53], v2, s[12:15], s41 offen sc1
    s_nop 0
L_fxC1:
    s_waitcnt vmcnt(0)
    s_branch L_fixdC
L_skH0:
    s_waitcnt vmcnt(0)
    s_nop 15
    s_branch L_skipH0
L_skH1:
    s_waitcnt vmcnt(0)
    s_nop 15
    s_branch L_skipH1
L_slowH:
    s_waitcnt lgkmcnt(0)
    s_nop 15
    v_mov_b32 v176, 0xff61b1e6
    v_mov_b32 v178, 0xff61b1e6
    ds_read_b128 v[104:107], v181 offset:0
    ds_read_b128 v[108:111], v180 offset:0
    s_waitcnt lgkmcnt(0)
    v_mfma_f32_32x32x16_bf16 v[64:79], v[104:107], v[20:23], 0
    v_mfma_f32_32x32x16_bf16 v[64:79], v[108:111], v[16:19], v[64:79]
    s_nop 11
    v_max3_f32 v176, v176, v64, v65
    v_max3_f32 v176, v176, v66, v67
    v_max3_f32 v176, v176, v68, v69
    v_max3_f32 v176, v176, v70, v71
    v_max3_f32 v176, v176, v72, v73
    v_max3_f32 v176, v176, v74, v75
    v_max3_f32 v176, v176, v76, v77
    v_max3_f32 v176, v176, v78, v79
    ds_read_b128 v[112:115], v181 offset:0
    ds_read_b128 v[116:119], v180 offset:0
    s_waitcnt lgkmcnt(0)
    v_mfma_f32_32x32x16_bf16 v[80:95], v[112:115], v[28:31], v[160:175]
    v_mfma_f32_32x32x16_bf16 v[80:95], v[116:119], v[24:27], v[80:95]
    s_nop 11
    v_max3_f32 v178, v178, v80, v81
    v_max3_f32 v178, v178, v82, v83
    v_max3_f32 v178, v178, v84, v85
    v_max3_f32 v178, v178, v86, v87
    v_max3_f32 v178, v178, v88, v89
    v_max3_f32 v178, v178, v90, v91
    v_max3_f32 v178, v178, v92, v93
    v_max3_f32 v178, v178, v94, v95
    ds_read_b128 v[104:107], v181 offset:512
    ds_read_b128 v[108:111], v180 offset:512
    s_waitcnt lgkmcnt(0)
    v_mfma_f32_32x32x16_bf16 v[64:79], v[104:107], v[20:23], 0
    v_mfma_f32_32x32x16_bf16 v[64:79], v[108:111], v[16:19], v[64:79]
    s_nop 11
    v_max3_f32 v176, v176, v64, v65
    v_max3_f32 v176, v176, v66, v67
    v_max3_f32 v176, v176, v68, v69
    v_max3_f32 v176, v176, v70, v71
    v_max3_f32 v176, v176, v72, v73
    v_max3_f32 v176, v176, v74, v75
    v_max3_f32 v176, v176, v76, v77
    v_max3_f32 v176, v176, v78, v79
    ds_read_b128 v[112:115], v181 offset:1024
    ds_read_b128 v[116:119], v180 offset:1024
    s_waitcnt lgkmcnt(0)
    v_mfma_f32_32x32x16_bf16 v[80:95], v[112:115], v[20:23], v[160:175]
    v_mfma_f32_32x32x16_bf16 v[80:95], v[116:119], v[16:19], v[80:95]
    s_nop 11
    v_max3_f32 v176, v176, v80, v81
    v_max3_f32 v176, v176, v82, v83
    v_max3_f32 v176, v176, v84, v85
    v_max3_f32 v176, v176, v86, v87
    v_max3_f32 v176, v176, v88, v89
    v_max3_f32 v176, v176, v90, v91
    v_max3_f32 v176, v176, v92, v93
    v_max3_f32 v176, v176, v94, v95
    v_mov_b32 v177, v176
    s_nop 1
    v_permlane32_swap_b32 v177, v176
    v_max_f32 v176, v176, v177
    v_sub_f32 v176, 0xc1a00000, v176
    v_lshlrev_b32 v177, 16, v20
    v_add_f32 v176, v176, v177
    v_and_b32 v177, 0xffff0000, v20
    v_add_f32 v176, v176, v177
    v_and_b32 v177, 0xffff0000, v176
    v_sub_f32 v176, v176, v177
    v_and_b32 v176, 0xffff0000, v176
    v_lshrrev_b32 v177, 16, v177
    v_or_b32 v177, v177, v176
    v_cndmask_b32 v20, v20, v177, s[80:81]
    v_mov_b32 v179, v178
    s_nop 1
    v_permlane32_swap_b32 v179, v178
    v_max_f32 v178, v178, v179
    v_sub_f32 v178, 0xc1a00000, v178
    v_lshlrev_b32 v179, 16, v28
    v_add_f32 v178, v178, v179
    v_and_b32 v179, 0xffff0000, v28
    v_add_f32 v178, v178, v179
    v_and_b32 v179, 0xffff0000, v178
    v_sub_f32 v178, v178, v179
    v_and_b32 v178, 0xffff0000, v178
    v_lshrrev_b32 v179, 16, v179
    v_or_b32 v179, v179, v178
    v_cndmask_b32 v28, v28, v179, s[80:81]
    s_mov_b64 s[52:53], 0
    s_nop 0
    s_branch L_mainH
L_fixH:
    s_waitcnt lgkmcnt(0)
    s_nop 15
    v_mov_b32 v176, 0xff61b1e6
    v_mov_b32 v178, 0xff61b1e6
    ds_read_b128 v[104:107], v184 offset:0
    ds_read_b128 v[108:111], v183 offset:0
    s_waitcnt lgkmcnt(0)
    v_mfma_f32_32x32x16_bf16 v[64:79], v[104:107], v[20:23], 0
    v_mfma_f32_32x32x16_bf16 v[64:79], v[108:111], v[16:19], v[64:79]
    s_nop 11
    v_max3_f32 v176, v176, v64, v65
    v_max3_f32 v176, v176, v66, v67
    v_max3_f32 v176, v176, v68, v69
    v_max3_f32 v176, v176, v70, v71
    v_max3_f32 v176, v176, v72, v73
    v_max3_f32 v176, v176, v74, v75
    v_max3_f32 v176, v176, v76, v77
    v_max3_f32 v176, v176, v78, v79
    ds_read_b128 v[112:115], v184 offset:0
    ds_read_b128 v[116:119], v183 offset:0
    s_waitcnt lgkmcnt(0)
    v_mfma_f32_32x32x16_bf16 v[80:95], v[112:115], v[28:31], 0
    v_mfma_f32_32x32x16_bf16 v[80:95], v[116:119], v[24:27], v[80:95]
    s_nop 11
    v_max3_f32 v178, v178, v80, v81
    v_max3_f32 v178, v178, v82, v83
    v_max3_f32 v178, v178, v84, v85
    v_max3_f32 v178, v178, v86, v87
    v_max3_f32 v178, v178, v88, v89
    v_max3_f32 v178, v178, v90, v91
    v_max3_f32 v178, v178, v92, v93
    v_max3_f32 v178, v178, v94, v95
    ds_read_b128 v[104:107], v184 offset:512
    ds_read_b128 v[108:111], v183 offset:512
    s_waitcnt lgkmcnt(0)
    v_mfma_f32_32x32x16_bf16 v[64:79], v[104:107], v[20:23], 0
    v_mfma_f32_32x32x16_bf16 v[64:79], v[108:111], v[16:19], v[64:79]
    s_nop 11
    v_max3_f32 v176, v176, v64, v65
    v_max3_f32 v176, v176, v66, v67
    v_max3_f32 v176, v176, v68, v69
    v_max3_f32 v176, v176, v70, v71
    v_max3_f32 v176, v176, v72, v73
    v_max3_f32 v176, v176, v74, v75
    v_max3_f32 v176, v176, v76, v77
    v_max3_f32 v176, v176, v78, v79
    ds_read_b128 v[112:115], v184 offset:512
    ds_read_b128 v[116:119], v183 offset:512
    s_waitcnt lgkmcnt(0)
    v_mfma_f32_32x32x16_bf16 v[80:95], v[112:115], v[28:31], 0
    v_mfma_f32_32x32x16_bf16 v[80:95], v[116:119], v[24:27], v[80:95]
    s_nop 11
    v_max3_f32 v178, v178, v80, v81
    v_max3_f32 v178, v178, v82, v83
    v_max3_f32 v178, v178, v84, v85
    v_max3_f32 v178, v178, v86, v87
    v_max3_f32 v178, v178, v88, v89
    v_max3_f32 v178, v178, v90, v91
    v_max3_f32 v178, v178, v92, v93
    v_max3_f32 v178, v178, v94, v95
    ds_read_b128 v[104:107], v184 offset:1024
    ds_read_b128 v[108:111], v183 offset:1024
    s_waitcnt lgkmcnt(0)
    v_mfma_f32_32x32x16_bf16 v[64:79], v[104:107], v[20:23], 0
    v_mfma_f32_32x32x16_bf16 v[64:79], v[108:111], v[16:19], v[64:79]
    s_nop 11
    v_max3_f32 v176, v176, v64, v65
    v_max3_f32 v176, v176, v66, v67
    v_max3_f32 v176, v176, v68, v69
    v_max3_f32 v176, v176, v70, v71
    v_max3_f32 v176, v176, v72, v73
    v_max3_f32 v176, v176, v74, v75
    v_max3_f32 v176, v176, v76, v77
    v_max3_f32 v176, v176, v78, v79
    ds_read_b128 v[112:115], v184 offset:1024
    ds_read_b128 v[116:119], v183 offset:1024
    s_waitcnt lgkmcnt(0)
    v_mfma_f32_32x32x16_bf16 v[80:95], v[112:115], v[28:31], 0
    v_mfma_f32_32x32x16_bf16 v[80:95], v[116:119], v[24:27], v[80:95]
    s_nop 11
    v_max3_f32 v178, v178, v80, v81
    v_max3_f32 v178, v178, v82, v83
    v_max3_f32 v178, v178, v84, v85
    v_max3_f32 v178, v178, v86, v87
    v_max3_f32 v178, v178, v88, v89
    v_max3_f32 v178, v178, v90, v91
    v_max3_f32 v178, v178, v92, v93
    v_max3_f32 v178, v178, v94, v95
    ds_read_b128 v[104:107], v184 offset:1536
    ds_read_b128 v[108:111], v183 offset:1536
    s_waitcnt lgkmcnt(0)
    v_mfma_f32_32x32x16_bf16 v[64:79], v[104:107], v[20:23], 0
    v_mfma_f32_32x32x16_bf16 v[64:79], v[108:111], v[16:19], v[64:79]
    s_nop 11
    v_max3_f32 v176, v176, v64, v65
    v_max3_f32 v176, v176, v66, v67
    v_max3_f32 v176, v176, v68, v69
    v_max3_f32 v176, v176, v70, v71
    v_max3_f32 v176, v176, v72, v73
    v_max3_f32 v176, v176, v74, v75
    v_max3_f32 v176, v176, v76, v77
    v_max3_f32 v176, v176, v78, v79
    ds_read_b128 v[112:115], v184 offset:1536
    ds_read_b128 v[116:119], v183 offset:1536
    s_waitcnt lgkmcnt(0)
    v_mfma_f32_32x32x16_bf16 v[80:95], v[112:115], v[28:31], 0
    v_mfma_f32_32x32x16_bf16 v[80:95], v[116:119], v[24:27], v[80:95]
    s_nop 11
    v_max3_f32 v178, v178, v80, v81
    v_max3_f32 v178, v178, v82, v83
    v_max3_f32 v178, v178, v84, v85
    v_max3_f32 v178, v178, v86, v87
    v_max3_f32 v178, v178, v88, v89
    v_max3_f32 v178, v178, v90, v91
    v_max3_f32 v178, v178, v92, v93
    v_max3_f32 v178, v178, v94, v95
    ds_read_b128 v[104:107], v187 offset:1536
    ds_read_b128 v[108:111], v186 offset:1536
    s_waitcnt lgkmcnt(0)
    v_mfma_f32_32x32x16_bf16 v[64:79], v[104:107], v[20:23], 0
    v_mfma_f32_32x32x16_bf16 v[64:79], v[108:111], v[16:19], v[64:79]
    s_nop 11
    v_max3_f32 v176, v176, v64, v65
    v_max3_f32 v176, v176, v66, v67
    v_max3_f32 v176, v176, v68, v69
    v_max3_f32 v176, v176, v70, v71
    v_max3_f32 v176, v176, v72, v73
    v_max3_f32 v176, v176, v74, v75
    v_max3_f32 v176, v176, v76, v77
    v_max3_f32 v176, v176, v78, v79
    ds_read_b128 v[112:115], v187 offset:1536
    ds_read_b128 v[116:119], v186 offset:1536
    s_waitcnt lgkmcnt(0)
    v_mfma_f32_32x32x16_bf16 v[80:95], v[112:115], v[28:31], 0
    v_mfma_f32_32x32x16_bf16 v[80:95], v[116:119], v[24:27], v[80:95]
    s_nop 11
    v_max3_f32 v178, v178, v80, v81
    v_max3_f32 v178, v178, v82, v83
    v_max3_f32 v178, v178, v84, v85
    v_max3_f32 v178, v178, v86, v87
    v_max3_f32 v178, v178, v88, v89
    v_max3_f32 v178, v178, v90, v91
    v_max3_f32 v178, v178, v92, v93
    v_max3_f32 v178, v178, v94, v95
    ds_read_b128 v[104:107], v187 offset:1024
    ds_read_b128 v[108:111], v186 offset:1024
    s_waitcnt lgkmcnt(0)
    v_mfma_f32_32x32x16_bf16 v[64:79], v[104:107], v[20:23], v[160:175]
    v_mfma_f32_32x32x16_bf16 v[64:79], v[108:111], v[16:19], v[64:79]
    s_nop 11
    v_max3_f32 v176, v176, v64, v65
    v_max3_f32 v176, v176, v66, v67
    v_max3_f32 v176, v176, v68, v69
    v_max3_f32 v176, v176, v70, v71
    v_max3_f32 v176, v176, v72, v73
    v_max3_f32 v176, v176, v74, v75
    v_max3_f32 v176, v176, v76, v77
    v_max3_f32 v176, v176, v78, v79
    ds_read_b128 v[112:115], v187 offset:1024
    ds_read_b128 v[116:119], v186 offset:1024
    s_waitcnt lgkmcnt(0)
    v_mfma_f32_32x32x16_bf16 v[80:95], v[112:115], v[28:31], 0
    v_mfma_f32_32x32x16_bf16 v[80:95], v[116:119], v[24:27], v[80:95]
    s_nop 11
    v_max3_f32 v178, v178, v80, v81
    v_max3_f32 v178, v178, v82, v83
    v_max3_f32 v178, v178, v84, v85
    v_max3_f32 v178, v178, v86, v87
    v_max3_f32 v178, v178, v88, v89
    v_max3_f32 v178, v178, v90, v91
    v_max3_f32 v178, v178, v92, v93
    v_max3_f32 v178, v178, v94, v95
    ds_read_b128 v[104:107], v187 offset:512
    ds_read_b128 v[108:111], v186 offset:512
    s_waitcnt lgkmcnt(0)
    v_mfma_f32_32x32x16_bf16 v[64:79], v[104:107], v[28:31], 0
    v_mfma_f32_32x32x16_bf16 v[64:79], v[108:111], v[24:27], v[64:79]
    s_nop 11
    v_max3_f32 v178, v178, v64, v65
    v_max3_f32 v178, v178, v66, v67
    v_max3_f32 v178, v178, v68, v69
    v_max3_f32 v178, v178, v70, v71
    v_max3_f32 v178, v178, v72, v73
    v_max3_f32 v178, v178, v74, v75
    v_max3_f32 v178, v178, v76, v77
    v_max3_f32 v178, v178, v78, v79
    ds_read_b128 v[112:115], v187 offset:0
    ds_read_b128 v[116:119], v186 offset:0
    s_waitcnt lgkmcnt(0)
    v_mfma_f32_32x32x16_bf16 v[80:95], v[112:115], v[28:31], v[160:175]
    v_mfma_f32_32x32x16_bf16 v[80:95], v[116:119], v[24:27], v[80:95]
    s_nop 11
    v_max3_f32 v178, v178, v80, v81
    v_max3_f32 v178, v178, v82, v83
    v_max3_f32 v178, v178, v84, v85
    v_max3_f32 v178, v178, v86, v87
    v_max3_f32 v178, v178, v88, v89
    v_max3_f32 v178, v178, v90, v91
    v_max3_f32 v178, v178, v92, v93
    v_max3_f32 v178, v178, v94, v95
    v_mov_b32 v177, v176
    s_nop 1
    v_permlane32_swap_b32 v177, v176
    v_max_f32 v176, v176, v177
    v_sub_f32 v176, 0xc1a00000, v176
    v_lshlrev_b32 v177, 16, v20
    v_add_f32 v176, v176, v177
    v_and_b32 v177, 0xffff0000, v20
    v_add_f32 v176, v176, v177
    v_and_b32 v177, 0xffff0000, v176
    v_sub_f32 v176, v176, v177
    v_and_b32 v176, 0xffff0000, v176
    v_lshrrev_b32 v177, 16, v177
    v_or_b32 v177, v177, v176
    v_cndmask_b32 v20, v20, v177, s[80:81]
    v_mov_b32 v179, v178
    s_nop 1
    v_permlane32_swap_b32 v179, v178
    v_max_f32 v178, v178, v179
    v_sub_f32 v178, 0xc1a00000, v178
    v_lshlrev_b32 v179, 16, v28
    v_add_f32 v178, v178, v179
    v_and_b32 v179, 0xffff0000, v28
    v_add_f32 v178, v178, v179
    v_and_b32 v179, 0xffff0000, v178
    v_sub_f32 v178, v178, v179
    v_and_b32 v178, 0xffff0000, v178
    v_lshrrev_b32 v179, 16, v179
    v_or_b32 v179, v179, v178
    v_cndmask_b32 v28, v28, v179, s[80:81]
    s_cmp_eq_u64 s[64:65], 0
    s_nop 0
    s_cbranch_scc1 L_fxH0
    ds_read_b128 v[104:107], v184 offset:0
    ds_read_b128 v[108:111], v183 offset:0
    ds_read_b64_tr_b16 v[136:137], v185 offset:0
    ds_read_b64_tr_b16 v[138:139], v185 offset:128
    ds_read_b64_tr_b16 v[140:141], v185 offset:256
    ds_read_b64_tr_b16 v[142:143], v185 offset:384
    s_waitcnt lgkmcnt(4)
    v_mfma_f32_32x32x16_bf16 v[64:79], v[104:107], v[20:23], 0
    v_mfma_f32_32x32x16_bf16 v[64:79], v[108:111], v[16:19], v[64:79]
    s_nop 11
    v_exp_f32 v64, v64
    v_exp_f32 v65, v65
    v_exp_f32 v66, v66
    v_exp_f32 v67, v67
    v_exp_f32 v68, v68
    v_exp_f32 v69, v69
    v_exp_f32 v70, v70
    v_exp_f32 v71, v71
    v_exp_f32 v72, v72
    v_exp_f32 v73, v73
    v_exp_f32 v74, v74
    v_exp_f32 v75, v75
    v_exp_f32 v76, v76
    v_exp_f32 v77, v77
    v_exp_f32 v78, v78
    v_exp_f32 v79, v79
    v_cvt_pk_bf16_f32 v96, v64, v65
    v_cvt_pk_bf16_f32 v97, v66, v67
    v_cvt_pk_bf16_f32 v98, v68, v69
    v_cvt_pk_bf16_f32 v99, v70, v71
    v_cvt_pk_bf16_f32 v100, v72, v73
    v_cvt_pk_bf16_f32 v101, v74, v75
    v_cvt_pk_bf16_f32 v102, v76, v77
    v_cvt_pk_bf16_f32 v103, v78, v79
    s_waitcnt lgkmcnt(0)
    v_mfma_f32_32x32x16_bf16 v[80:95], v[136:139], v[96:99], 0
    v_mfma_f32_32x32x16_bf16 v[80:95], v[140:143], v[100:103], v[80:95]
    ds_read_b128 v[104:107], v184 offset:512
    ds_read_b128 v[108:111], v183 offset:512
    ds_read_b64_tr_b16 v[136:137], v185 offset:512
    ds_read_b64_tr_b16 v[138:139], v185 offset:640
    ds_read_b64_tr_b16 v[140:141], v185 offset:768
    ds_read_b64_tr_b16 v[142:143], v185 offset:896
    s_waitcnt lgkmcnt(4)
    v_mfma_f32_32x32x16_bf16 v[64:79], v[104:107], v[20:23], 0
    v_mfma_f32_32x32x16_bf16 v[64:79], v[108:111], v[16:19], v[64:79]
    s_nop 11
    v_exp_f32 v64, v64
    v_exp_f32 v65, v65
    v_exp_f32 v66, v66
    v_exp_f32 v67, v67
    v_exp_f32 v68, v68
    v_exp_f32 v69, v69
    v_exp_f32 v70, v70
    v_exp_f32 v71, v71
    v_exp_f32 v72, v72
    v_exp_f32 v73, v73
    v_exp_f32 v74, v74
    v_exp_f32 v75, v75
    v_exp_f32 v76, v76
    v_exp_f32 v77, v77
    v_exp_f32 v78, v78
    v_exp_f32 v79, v79
    v_cvt_pk_bf16_f32 v96, v64, v65
    v_cvt_pk_bf16_f32 v97, v66, v67
    v_cvt_pk_bf16_f32 v98, v68, v69
    v_cvt_pk_bf16_f32 v99, v70, v71
    v_cvt_pk_bf16_f32 v100, v72, v73
    v_cvt_pk_bf16_f32 v101, v74, v75
    v_cvt_pk_bf16_f32 v102, v76, v77
    v_cvt_pk_bf16_f32 v103, v78, v79
    s_waitcnt lgkmcnt(0)
    v_mfma_f32_32x32x16_bf16 v[80:95], v[136:139], v[96:99], v[80:95]
    v_mfma_f32_32x32x16_bf16 v[80:95], v[140:143], v[100:103], v[80:95]
    ds_read_b128 v[104:107], v184 offset:1024
    ds_read_b128 v[108:111], v183 offset:1024
    ds_read_b64_tr_b16 v[136:137], v185 offset:1024
    ds_read_b64_tr_b16 v[138:139], v185 offset:1152
    ds_read_b64_tr_b16 v[140:141], v185 offset:1280
    ds_read_b64_tr_b16 v[142:143], v185 offset:1408
    s_waitcnt lgkmcnt(4)
    v_mfma_f32_32x32x16_bf16 v[64:79], v[104:107], v[20:23], 0
    v_mfma_f32_32x32x16_bf16 v[64:79], v[108:111], v[16:19], v[64:79]
    s_nop 11
    v_exp_f32 v64, v64
    v_exp_f32 v65, v65
    v_exp_f32 v66, v66
    v_exp_f32 v67, v67
    v_exp_f32 v68, v68
    v_exp_f32 v69, v69
    v_exp_f32 v70, v70
    v_exp_f32 v71, v71
    v_exp_f32 v72, v72
    v_exp_f32 v73, v73
    v_exp_f32 v74, v74
    v_exp_f32 v75, v75
    v_exp_f32 v76, v76
    v_exp_f32 v77, v77
    v_exp_f32 v78, v78
    v_exp_f32 v79, v79
    v_cvt_pk_bf16_f32 v96, v64, v65
    v_cvt_pk_bf16_f32 v97, v66, v67
    v_cvt_pk_bf16_f32 v98, v68, v69
    v_cvt_pk_bf16_f32 v99, v70, v71
    v_cvt_pk_bf16_f32 v100, v72, v73
    v_cvt_pk_bf16_f32 v101, v74, v75
    v_cvt_pk_bf16_f32 v102, v76, v77
    v_cvt_pk_bf16_f32 v103, v78, v79
    s_waitcnt lgkmcnt(0)
    v_mfma_f32_32x32x16_bf16 v[80:95], v[136:139], v[96:99], v[80:95]
    v_mfma_f32_32x32x16_bf16 v[80:95], v[140:143], v[100:103], v[80:95]
    ds_read_b128 v[104:107], v184 offset:1536
    ds_read_b128 v[108:111], v183 offset:1536
    ds_read_b64_tr_b16 v[136:137], v185 offset:1536
    ds_read_b64_tr_b16 v[138:139], v185 offset:1664
    ds_read_b64_tr_b16 v[140:141], v185 offset:1792
    ds_read_b64_tr_b16 v[142:143], v185 offset:1920
    s_waitcnt lgkmcnt(4)
    v_mfma_f32_32x32x16_bf16 v[64:79], v[104:107], v[20:23], 0
    v_mfma_f32_32x32x16_bf16 v[64:79], v[108:111], v[16:19], v[64:79]
    s_nop 11
    v_exp_f32 v64, v64
    v_exp_f32 v65, v65
    v_exp_f32 v66, v66
    v_exp_f32 v67, v67
    v_exp_f32 v68, v68
    v_exp_f32 v69, v69
    v_exp_f32 v70, v70
    v_exp_f32 v71, v71
    v_exp_f32 v72, v72
    v_exp_f32 v73, v73
    v_exp_f32 v74, v74
    v_exp_f32 v75, v75
    v_exp_f32 v76, v76
    v_exp_f32 v77, v77
    v_exp_f32 v78, v78
    v_exp_f32 v79, v79
    v_cvt_pk_bf16_f32 v96, v64, v65
    v_cvt_pk_bf16_f32 v97, v66, v67
    v_cvt_pk_bf16_f32 v98, v68, v69
    v_cvt_pk_bf16_f32 v99, v70, v71
    v_cvt_pk_bf16_f32 v100, v72, v73
    v_cvt_pk_bf16_f32 v101, v74, v75
    v_cvt_pk_bf16_f32 v102, v76, v77
    v_cvt_pk_bf16_f32 v103, v78, v79
    s_waitcnt lgkmcnt(0)
    v_mfma_f32_32x32x16_bf16 v[80:95], v[136:139], v[96:99], v[80:95]
    v_mfma_f32_32x32x16_bf16 v[80:95], v[140:143], v[100:103], v[80:95]
    ds_read_b128 v[104:107], v187 offset:1536
    ds_read_b128 v[108:111], v186 offset:1536
    ds_read_b64_tr_b16 v[136:137], v188 offset:1536
    ds_read_b64_tr_b16 v[138:139], v188 offset:1664
    ds_read_b64_tr_b16 v[140:141], v188 offset:1792
    ds_read_b64_tr_b16 v[142:143], v188 offset:1920
    s_waitcnt lgkmcnt(4)
    v_mfma_f32_32x32x16_bf16 v[64:79], v[104:107], v[20:23], 0
    v_mfma_f32_32x32x16_bf16 v[64:79], v[108:111], v[16:19], v[64:79]
    s_nop 11
    v_exp_f32 v64, v64
    v_exp_f32 v65, v65
    v_exp_f32 v66, v66
    v_exp_f32 v67, v67
    v_exp_f32 v68, v68
    v_exp_f32 v69, v69
    v_exp_f32 v70, v70
    v_exp_f32 v71, v71
    v_exp_f32 v72, v72
    v_exp_f32 v73, v73
    v_exp_f32 v74, v74
    v_exp_f32 v75, v75
    v_exp_f32 v76, v76
    v_exp_f32 v77, v77
    v_exp_f32 v78, v78
    v_exp_f32 v79, v79
    v_cvt_pk_bf16_f32 v96, v64, v65
    v_cvt_pk_bf16_f32 v97, v66, v67
    v_cvt_pk_bf16_f32 v98, v68, v69
    v_cvt_pk_bf16_f32 v99, v70, v71
    v_cvt_pk_bf16_f32 v100, v72, v73
    v_cvt_pk_bf16_f32 v101, v74, v75
    v_cvt_pk_bf16_f32 v102, v76, v77
    v_cvt_pk_bf16_f32 v103, v78, v79
    s_waitcnt lgkmcnt(0)
    v_mfma_f32_32x32x16_bf16 v[80:95], v[136:139], v[96:99], v[80:95]
    v_mfma_f32_32x32x16_bf16 v[80:95], v[140:143], v[100:103], v[80:95]
    ds_read_b128 v[104:107], v187 offset:1024
    ds_read_b128 v[108:111], v186 offset:1024
    ds_read_b64_tr_b16 v[136:137], v188 offset:1024
    ds_read_b64_tr_b16 v[138:139], v188 offset:1152
    ds_read_b64_tr_b16 v[140:141], v188 offset:1280
    ds_read_b64_tr_b16 v[142:143], v188 offset:1408
    s_waitcnt lgkmcnt(4)
    v_mfma_f32_32x32x16_bf16 v[64:79], v[104:107], v[20:23], v[160:175]
    v_mfma_f32_32x32x16_bf16 v[64:79], v[108:111], v[16:19], v[64:79]
    s_nop 11
    v_exp_f32 v64, v64
    v_exp_f32 v65, v65
    v_exp_f32 v66, v66
    v_exp_f32 v67, v67
    v_exp_f32 v68, v68
    v_exp_f32 v69, v69
    v_exp_f32 v70, v70
    v_exp_f32 v71, v71
    v_exp_f32 v72, v72
    v_exp_f32 v73, v73
    v_exp_f32 v74, v74
    v_exp_f32 v75, v75
    v_exp_f32 v76, v76
    v_exp_f32 v77, v77
    v_exp_f32 v78, v78
    v_exp_f32 v79, v79
    v_cvt_pk_bf16_f32 v96, v64, v65
    v_cvt_pk_bf16_f32 v97, v66, v67
    v_cvt_pk_bf16_f32 v98, v68, v69
    v_cvt_pk_bf16_f32 v99, v70, v71
    v_cvt_pk_bf16_f32 v100, v72, v73
    v_cvt_pk_bf16_f32 v101, v74, v75
    v_cvt_pk_bf16_f32 v102, v76, v77
    v_cvt_pk_bf16_f32 v103, v78, v79
    s_waitcnt lgkmcnt(0)
    v_mfma_f32_32x32x16_bf16 v[80:95], v[136:139], v[96:99], v[80:95]
    v_mfma_f32_32x32x16_bf16 v[80:95], v[140:143], v[100:103], v[80:95]
    s_nop 11
    v_cndmask_b32 v32, v32, v80, s[64:65]
    v_cndmask_b32 v33, v33, v81, s[64:65]
    v_cndmask_b32 v34, v34, v82, s[64:65]
    v_cndmask_b32 v35, v35, v83, s[64:65]
    v_cndmask_b32 v36, v36, v84, s[64:65]
    v_cndmask_b32 v37, v37, v85, s[64:65]
    v_cndmask_b32 v38, v38, v86, s[64:65]
    v_cndmask_b32 v39, v39, v87, s[64:65]
    v_cndmask_b32 v40, v40, v88, s[64:65]
    v_cndmask_b32 v41, v41, v89, s[64:65]
    v_cndmask_b32 v42, v42, v90, s[64:65]
    v_cndmask_b32 v43, v43, v91, s[64:65]
    v_cndmask_b32 v44, v44, v92, s[64:65]
    v_rcp_f32 v177, v44
    s_add_u32 s40, s54, 81920
    s_add_u32 s41, s55, 81920
    v_mul_f32 v32, v32, v177
    v_mul_f32 v33, v33, v177
    v_mul_f32 v34, v34, v177
    v_mul_f32 v35, v35, v177
    v_mul_f32 v36, v36, v177
    v_mul_f32 v37, v37, v177
    v_mul_f32 v38, v38, v177
    v_mul_f32 v39, v39, v177
    v_mul_f32 v40, v40, v177
    v_mul_f32 v41, v41, v177
    v_mul_f32 v42, v42, v177
    v_mul_f32 v43, v43, v177
    v_cvt_pk_bf16_f32 v32, v32, v33
    v_cvt_pk_bf16_f32 v33, v34, v35
    v_cvt_pk_bf16_f32 v34, v36, v37
    v_cvt_pk_bf16_f32 v35, v38, v39
    v_cvt_pk_bf16_f32 v36, v40, v41
    v_cvt_pk_bf16_f32 v37, v42, v43
    v_min_u32 v32, 0xfffffffe, v32
    v_min_u32 v36, 0xfffffffe, v36
    buffer_store_dwordx4 v[32:35], v191, s[12:15], s40 offen sc1
    buffer_store_dwordx2 v[36:37], v2, s[12:15], s41 offen sc1
    s_nop 0
L_fxH0:
    s_cmp_eq_u64 s[66:67], 0
    s_cbranch_scc1 L_fxH1
    ds_read_b128 v[104:107], v184 offset:0
    ds_read_b128 v[108:111], v183 offset:0
    ds_read_b64_tr_b16 v[136:137], v185 offset:0
    ds_read_b64_tr_b16 v[138:139], v185 offset:128
    ds_read_b64_tr_b16 v[140:141], v185 offset:256
    ds_read_b64_tr_b16 v[142:143], v185 offset:384
    s_waitcnt lgkmcnt(4)
    v_mfma_f32_32x32x16_bf16 v[64:79], v[104:107], v[28:31], 0
    v_mfma_f32_32x32x16_bf16 v[64:79], v[108:111], v[24:27], v[64:79]
    s_nop 11
    v_exp_f32 v64, v64
    v_exp_f32 v65, v65
    v_exp_f32 v66, v66
    v_exp_f32 v67, v67
    v_exp_f32 v68, v68
    v_exp_f32 v69, v69
    v_exp_f32 v70, v70
    v_exp_f32 v71, v71
    v_exp_f32 v72, v72
    v_exp_f32 v73, v73
    v_exp_f32 v74, v74
    v_exp_f32 v75, v75
    v_exp_f32 v76, v76
    v_exp_f32 v77, v77
    v_exp_f32 v78, v78
    v_exp_f32 v79, v79
    v_cvt_pk_bf16_f32 v96, v64, v65
    v_cvt_pk_bf16_f32 v97, v66, v67
    v_cvt_pk_bf16_f32 v98, v68, v69
    v_cvt_pk_bf16_f32 v99, v70, v71
    v_cvt_pk_bf16_f32 v100, v72, v73
    v_cvt_pk_bf16_f32 v101, v74, v75
    v_cvt_pk_bf16_f32 v102, v76, v77
    v_cvt_pk_bf16_f32 v103, v78, v79
    s_waitcnt lgkmcnt(0)
    v_mfma_f32_32x32x16_bf16 v[80:95], v[136:139], v[96:99], 0
    v_mfma_f32_32x32x16_bf16 v[80:95], v[140:143], v[100:103], v[80:95]
    ds_read_b128 v[104:107], v184 offset:512
    ds_read_b128 v[108:111], v183 offset:512
    ds_read_b64_tr_b16 v[136:137], v185 offset:512
    ds_read_b64_tr_b16 v[138:139], v185 offset:640
    ds_read_b64_tr_b16 v[140:141], v185 offset:768
    ds_read_b64_tr_b16 v[142:143], v185 offset:896
    s_waitcnt lgkmcnt(4)
    v_mfma_f32_32x32x16_bf16 v[64:79], v[104:107], v[28:31], 0
    v_mfma_f32_32x32x16_bf16 v[64:79], v[108:111], v[24:27], v[64:79]
    s_nop 11
    v_exp_f32 v64, v64
    v_exp_f32 v65, v65
    v_exp_f32 v66, v66
    v_exp_f32 v67, v67
    v_exp_f32 v68, v68
    v_exp_f32 v69, v69
    v_exp_f32 v70, v70
    v_exp_f32 v71, v71
    v_exp_f32 v72, v72
    v_exp_f32 v73, v73
    v_exp_f32 v74, v74
    v_exp_f32 v75, v75
    v_exp_f32 v76, v76
    v_exp_f32 v77, v77
    v_exp_f32 v78, v78
    v_exp_f32 v79, v79
    v_cvt_pk_bf16_f32 v96, v64, v65
    v_cvt_pk_bf16_f32 v97, v66, v67
    v_cvt_pk_bf16_f32 v98, v68, v69
    v_cvt_pk_bf16_f32 v99, v70, v71
    v_cvt_pk_bf16_f32 v100, v72, v73
    v_cvt_pk_bf16_f32 v101, v74, v75
    v_cvt_pk_bf16_f32 v102, v76, v77
    v_cvt_pk_bf16_f32 v103, v78, v79
    s_waitcnt lgkmcnt(0)
    v_mfma_f32_32x32x16_bf16 v[80:95], v[136:139], v[96:99], v[80:95]
    v_mfma_f32_32x32x16_bf16 v[80:95], v[140:143], v[100:103], v[80:95]
    ds_read_b128 v[104:107], v184 offset:1024
    ds_read_b128 v[108:111], v183 offset:1024
    ds_read_b64_tr_b16 v[136:137], v185 offset:1024
    ds_read_b64_tr_b16 v[138:139], v185 offset:1152
    ds_read_b64_tr_b16 v[140:141], v185 offset:1280
    ds_read_b64_tr_b16 v[142:143], v185 offset:1408
    s_waitcnt lgkmcnt(4)
    v_mfma_f32_32x32x16_bf16 v[64:79], v[104:107], v[28:31], 0
    v_mfma_f32_32x32x16_bf16 v[64:79], v[108:111], v[24:27], v[64:79]
    s_nop 11
    v_exp_f32 v64, v64
    v_exp_f32 v65, v65
    v_exp_f32 v66, v66
    v_exp_f32 v67, v67
    v_exp_f32 v68, v68
    v_exp_f32 v69, v69
    v_exp_f32 v70, v70
    v_exp_f32 v71, v71
    v_exp_f32 v72, v72
    v_exp_f32 v73, v73
    v_exp_f32 v74, v74
    v_exp_f32 v75, v75
    v_exp_f32 v76, v76
    v_exp_f32 v77, v77
    v_exp_f32 v78, v78
    v_exp_f32 v79, v79
    v_cvt_pk_bf16_f32 v96, v64, v65
    v_cvt_pk_bf16_f32 v97, v66, v67
    v_cvt_pk_bf16_f32 v98, v68, v69
    v_cvt_pk_bf16_f32 v99, v70, v71
    v_cvt_pk_bf16_f32 v100, v72, v73
    v_cvt_pk_bf16_f32 v101, v74, v75
    v_cvt_pk_bf16_f32 v102, v76, v77
    v_cvt_pk_bf16_f32 v103, v78, v79
    s_waitcnt lgkmcnt(0)
    v_mfma_f32_32x32x16_bf16 v[80:95], v[136:139], v[96:99], v[80:95]
    v_mfma_f32_32x32x16_bf16 v[80:95], v[140:143], v[100:103], v[80:95]
    ds_read_b128 v[104:107], v184 offset:1536
    ds_read_b128 v[108:111], v183 offset:1536
    ds_read_b64_tr_b16 v[136:137], v185 offset:1536
    ds_read_b64_tr_b16 v[138:139], v185 offset:1664
    ds_read_b64_tr_b16 v[140:141], v185 offset:1792
    ds_read_b64_tr_b16 v[142:143], v185 offset:1920
    s_waitcnt lgkmcnt(4)
    v_mfma_f32_32x32x16_bf16 v[64:79], v[104:107], v[28:31], 0
    v_mfma_f32_32x32x16_bf16 v[64:79], v[108:111], v[24:27], v[64:79]
    s_nop 11
    v_exp_f32 v64, v64
    v_exp_f32 v65, v65
    v_exp_f32 v66, v66
    v_exp_f32 v67, v67
    v_exp_f32 v68, v68
    v_exp_f32 v69, v69
    v_exp_f32 v70, v70
    v_exp_f32 v71, v71
    v_exp_f32 v72, v72
    v_exp_f32 v73, v73
    v_exp_f32 v74, v74
    v_exp_f32 v75, v75
    v_exp_f32 v76, v76
    v_exp_f32 v77, v77
    v_exp_f32 v78, v78
    v_exp_f32 v79, v79
    v_cvt_pk_bf16_f32 v96, v64, v65
    v_cvt_pk_bf16_f32 v97, v66, v67
    v_cvt_pk_bf16_f32 v98, v68, v69
    v_cvt_pk_bf16_f32 v99, v70, v71
    v_cvt_pk_bf16_f32 v100, v72, v73
    v_cvt_pk_bf16_f32 v101, v74, v75
    v_cvt_pk_bf16_f32 v102, v76, v77
    v_cvt_pk_bf16_f32 v103, v78, v79
    s_waitcnt lgkmcnt(0)
    v_mfma_f32_32x32x16_bf16 v[80:95], v[136:139], v[96:99], v[80:95]
    v_mfma_f32_32x32x16_bf16 v[80:95], v[140:143], v[100:103], v[80:95]
    ds_read_b128 v[104:107], v187 offset:1536
    ds_read_b128 v[108:111], v186 offset:1536
    ds_read_b64_tr_b16 v[136:137], v188 offset:1536
    ds_read_b64_tr_b16 v[138:139], v188 offset:1664
    ds_read_b64_tr_b16 v[140:141], v188 offset:1792
    ds_read_b64_tr_b16 v[142:143], v188 offset:1920
    s_waitcnt lgkmcnt(4)
    v_mfma_f32_32x32x16_bf16 v[64:79], v[104:107], v[28:31], 0
    v_mfma_f32_32x32x16_bf16 v[64:79], v[108:111], v[24:27], v[64:79]
    s_nop 11
    v_exp_f32 v64, v64
    v_exp_f32 v65, v65
    v_exp_f32 v66, v66
    v_exp_f32 v67, v67
    v_exp_f32 v68, v68
    v_exp_f32 v69, v69
    v_exp_f32 v70, v70
    v_exp_f32 v71, v71
    v_exp_f32 v72, v72
    v_exp_f32 v73, v73
    v_exp_f32 v74, v74
    v_exp_f32 v75, v75
    v_exp_f32 v76, v76
    v_exp_f32 v77, v77
    v_exp_f32 v78, v78
    v_exp_f32 v79, v79
    v_cvt_pk_bf16_f32 v96, v64, v65
    v_cvt_pk_bf16_f32 v97, v66, v67
    v_cvt_pk_bf16_f32 v98, v68, v69
    v_cvt_pk_bf16_f32 v99, v70, v71
    v_cvt_pk_bf16_f32 v100, v72, v73
    v_cvt_pk_bf16_f32 v101, v74, v75
    v_cvt_pk_bf16_f32 v102, v76, v77
    v_cvt_pk_bf16_f32 v103, v78, v79
    s_waitcnt lgkmcnt(0)
    v_mfma_f32_32x32x16_bf16 v[80:95], v[136:139], v[96:99], v[80:95]
    v_mfma_f32_32x32x16_bf16 v[80:95], v[140:143], v[100:103], v[80:95]
    ds_read_b128 v[104:107], v187 offset:1024
    ds_read_b128 v[108:111], v186 offset:1024
    ds_read_b64_tr_b16 v[136:137], v188 offset:1024
    ds_read_b64_tr_b16 v[138:139], v188 offset:1152
    ds_read_b64_tr_b16 v[140:141], v188 offset:1280
    ds_read_b64_tr_b16 v[142:143], v188 offset:1408
    s_waitcnt lgkmcnt(4)
    v_mfma_f32_32x32x16_bf16 v[64:79], v[104:107], v[28:31], 0
    v_mfma_f32_32x32x16_bf16 v[64:79], v[108:111], v[24:27], v[64:79]
    s_nop 11
    v_exp_f32 v64, v64
    v_exp_f32 v65, v65
    v_exp_f32 v66, v66
    v_exp_f32 v67, v67
    v_exp_f32 v68, v68
    v_exp_f32 v69, v69
    v_exp_f32 v70, v70
    v_exp_f32 v71, v71
    v_exp_f32 v72, v72
    v_exp_f32 v73, v73
    v_exp_f32 v74, v74
    v_exp_f32 v75, v75
    v_exp_f32 v76, v76
    v_exp_f32 v77, v77
    v_exp_f32 v78, v78
    v_exp_f32 v79, v79
    v_cvt_pk_bf16_f32 v96, v64, v65
    v_cvt_pk_bf16_f32 v97, v66, v67
    v_cvt_pk_bf16_f32 v98, v68, v69
    v_cvt_pk_bf16_f32 v99, v70, v71
    v_cvt_pk_bf16_f32 v100, v72, v73
    v_cvt_pk_bf16_f32 v101, v74, v75
    v_cvt_pk_bf16_f32 v102, v76, v77
    v_cvt_pk_bf16_f32 v103, v78, v79
    s_waitcnt lgkmcnt(0)
    v_mfma_f32_32x32x16_bf16 v[80:95], v[136:139], v[96:99], v[80:95]
    v_mfma_f32_32x32x16_bf16 v[80:95], v[140:143], v[100:103], v[80:95]
    ds_read_b128 v[104:107], v187 offset:512
    ds_read_b128 v[108:111], v186 offset:512
    ds_read_b64_tr_b16 v[136:137], v188 offset:512
    ds_read_b64_tr_b16 v[138:139], v188 offset:640
    ds_read_b64_tr_b16 v[140:141], v188 offset:768
    ds_read_b64_tr_b16 v[142:143], v188 offset:896
    s_waitcnt lgkmcnt(4)
    v_mfma_f32_32x32x16_bf16 v[64:79], v[104:107], v[28:31], 0
    v_mfma_f32_32x32x16_bf16 v[64:79], v[108:111], v[24:27], v[64:79]
    s_nop 11
    v_exp_f32 v64, v64
    v_exp_f32 v65, v65
    v_exp_f32 v66, v66
    v_exp_f32 v67, v67
    v_exp_f32 v68, v68
    v_exp_f32 v69, v69
    v_exp_f32 v70, v70
    v_exp_f32 v71, v71
    v_exp_f32 v72, v72
    v_exp_f32 v73, v73
    v_exp_f32 v74, v74
    v_exp_f32 v75, v75
    v_exp_f32 v76, v76
    v_exp_f32 v77, v77
    v_exp_f32 v78, v78
    v_exp_f32 v79, v79
    v_cvt_pk_bf16_f32 v96, v64, v65
    v_cvt_pk_bf16_f32 v97, v66, v67
    v_cvt_pk_bf16_f32 v98, v68, v69
    v_cvt_pk_bf16_f32 v99, v70, v71
    v_cvt_pk_bf16_f32 v100, v72, v73
    v_cvt_pk_bf16_f32 v101, v74, v75
    v_cvt_pk_bf16_f32 v102, v76, v77
    v_cvt_pk_bf16_f32 v103, v78, v79
    s_waitcnt lgkmcnt(0)
    v_mfma_f32_32x32x16_bf16 v[80:95], v[136:139], v[96:99], v[80:95]
    v_mfma_f32_32x32x16_bf16 v[80:95], v[140:143], v[100:103], v[80:95]
    ds_read_b128 v[104:107], v187 offset:0
    ds_read_b128 v[108:111], v186 offset:0
    ds_read_b64_tr_b16 v[136:137], v188 offset:0
    ds_read_b64_tr_b16 v[138:139], v188 offset:128
    ds_read_b64_tr_b16 v[140:141], v188 offset:256
    ds_read_b64_tr_b16 v[142:143], v188 offset:384
    s_waitcnt lgkmcnt(4)
    v_mfma_f32_32x32x16_bf16 v[64:79], v[104:107], v[28:31], v[160:175]
    v_mfma_f32_32x32x16_bf16 v[64:79], v[108:111], v[24:27], v[64:79]
    s_nop 11
    v_exp_f32 v64, v64
    v_exp_f32 v65, v65
    v_exp_f32 v66, v66
    v_exp_f32 v67, v67
    v_exp_f32 v68, v68
    v_exp_f32 v69, v69
    v_exp_f32 v70, v70
    v_exp_f32 v71, v71
    v_exp_f32 v72, v72
    v_exp_f32 v73, v73
    v_exp_f32 v74, v74
    v_exp_f32 v75, v75
    v_exp_f32 v76, v76
    v_exp_f32 v77, v77
    v_exp_f32 v78, v78
    v_exp_f32 v79, v79
    v_cvt_pk_bf16_f32 v96, v64, v65
    v_cvt_pk_bf16_f32 v97, v66, v67
    v_cvt_pk_bf16_f32 v98, v68, v69
    v_cvt_pk_bf16_f32 v99, v70, v71
    v_cvt_pk_bf16_f32 v100, v72, v73
    v_cvt_pk_bf16_f32 v101, v74, v75
    v_cvt_pk_bf16_f32 v102, v76, v77
    v_cvt_pk_bf16_f32 v103, v78, v79
    s_waitcnt lgkmcnt(0)
    v_mfma_f32_32x32x16_bf16 v[80:95], v[136:139], v[96:99], v[80:95]
    v_mfma_f32_32x32x16_bf16 v[80:95], v[140:143], v[100:103], v[80:95]
    s_nop 11
    v_cndmask_b32 v48, v48, v80, s[66:67]
    v_cndmask_b32 v49, v49, v81, s[66:67]
    v_cndmask_b32 v50, v50, v82, s[66:67]
    v_cndmask_b32 v51, v51, v83, s[66:67]
    v_cndmask_b32 v52, v52, v84, s[66:67]
    v_cndmask_b32 v53, v53, v85, s[66:67]
    v_cndmask_b32 v54, v54, v86, s[66:67]
    v_cndmask_b32 v55, v55, v87, s[66:67]
    v_cndmask_b32 v56, v56, v88, s[66:67]
    v_cndmask_b32 v57, v57, v89, s[66:67]
    v_cndmask_b32 v58, v58, v90, s[66:67]
    v_cndmask_b32 v59, v59, v91, s[66:67]
    v_cndmask_b32 v60, v60, v92, s[66:67]
    v_rcp_f32 v177, v60
    s_add_u32 s40, s54, 0
    s_add_u32 s41, s55, 0
    v_mul_f32 v48, v48, v177
    v_mul_f32 v49, v49, v177
    v_mul_f32 v50, v50, v177
    v_mul_f32 v51, v51, v177
    v_mul_f32 v52, v52, v177
    v_mul_f32 v53, v53, v177
    v_mul_f32 v54, v54, v177
    v_mul_f32 v55, v55, v177
    v_mul_f32 v56, v56, v177
    v_mul_f32 v57, v57, v177
    v_mul_f32 v58, v58, v177
    v_mul_f32 v59, v59, v177
    v_cvt_pk_bf16_f32 v48, v48, v49
    v_cvt_pk_bf16_f32 v49, v50, v51
    v_cvt_pk_bf16_f32 v50, v52, v53
    v_cvt_pk_bf16_f32 v51, v54, v55
    v_cvt_pk_bf16_f32 v52, v56, v57
    v_cvt_pk_bf16_f32 v53, v58, v59
    v_min_u32 v48, 0xfffffffe, v48
    v_min_u32 v52, 0xfffffffe, v52
    buffer_store_dwordx4 v[48:51], v191, s[12:15], s40 offen sc1
    buffer_store_dwordx2 v[52:53], v2, s[12:15], s41 offen sc1
    s_nop 0
L_fxH1:
    s_waitcnt vmcnt(0)
    s_branch L_fixdH
    s_endpgm
.section .rodata,"a"
.p2align 6
.amdhsa_kernel concat_heads__linear_kernel_hedgehog__sliding_block__prompt_kernel
  .amdhsa_next_free_vgpr 256
  .amdhsa_next_free_sgpr 102
  .amdhsa_accum_offset 256
  .amdhsa_group_segment_fixed_size 0
  .amdhsa_kernarg_size 80
  .amdhsa_user_sgpr_count 2
  .amdhsa_user_sgpr_kernarg_segment_ptr 1
  .amdhsa_system_sgpr_workgroup_id_x 1
.end_amdhsa_kernel
.text
```
